```python
import torch

def _softmax(x, axis=-1):
    return torch.softmax(x, dim=axis)
def _gelu(x):
    return torch.nn.functional.gelu(x, approximate="tanh")
def _silu(x):
    return torch.nn.functional.silu(x)
def _sigmoid(x):
    return torch.sigmoid(x)
def _layernorm(x, axis=-1, eps=1e-5):
    m = x.mean(dim=axis, keepdim=True)
    v = x.var(dim=axis, keepdim=True, unbiased=False)
    return (x - m) / torch.sqrt(v + eps)
def _scatter_add(tgt, idx, src, axis=0):
    return tgt.clone().index_add_(axis, idx, src)
def _segment_sum(src, seg, n):
    out = torch.zeros((n,) + src.shape[1:], dtype=src.dtype)
    return out.index_add_(0, seg, src)
def _pad(x, pw):
    flat = tuple(v for pair in reversed(pw) for v in pair)
    return torch.nn.functional.pad(x, flat)

kernel_name = 'standalone__modern_conv_block_convnext_v2__vision'

def setup_inputs():

    _w = (lambda a: (lambda t: t.to(torch.bfloat16) if t.is_floating_point() else t)(torch.as_tensor(a)))
    H = W = 384
    C = 192
    K = 1
    return {
        "x": _w((lambda *s: torch.randn(*s, dtype=torch.bfloat16) * 0.05)(1, H, W, C)),
        "dw": _w((lambda *s: torch.randn(*s, dtype=torch.bfloat16) * 0.05)(K, K, C)),
        "w1": _w((lambda *s: torch.randn(*s, dtype=torch.bfloat16) * 0.05)(C, 4 * C)),
        "w2": _w((lambda *s: torch.randn(*s, dtype=torch.bfloat16) * 0.05)(4 * C, C)),
        "grn_gamma": _w((lambda *s: torch.randn(*s, dtype=torch.bfloat16) * 0.05)(4 * C)),
        "grn_beta": _w((lambda *s: torch.randn(*s, dtype=torch.bfloat16) * 0.05)(4 * C)),
    }

def reference(x, dw, w1, w2, grn_gamma, grn_beta):
    B, H, W, C = x.shape
    K = dw.shape[0]
    pad = K // 2
    xp = _pad(x, ((0,0),(pad,pad),(pad,pad),(0,0)))
    out = torch.zeros_like(x)
    for i in range(K):
        for j in range(K):
            out = out + xp[:, i:i+H, j:j+W, :] * dw[i, j][None, None, None, :]
    h = _layernorm(out, axis=-1)
    h = torch.einsum('bhwc,ce->bhwe', h, w1)
    h = _gelu(h)
    gx = torch.sqrt((h * h).sum(axis=(1, 2), keepdims=True) + 1e-6)
    nx = gx / (gx.mean(axis=-1, keepdims=True) + 1e-6)
    h = grn_gamma * (h * nx) + grn_beta + h
    h = torch.einsum('bhwe,ec->bhwc', h, w2)
    return x + h
```

```asm
; @launch grid=(256,1,1) block=(256,1,1) lds=162304
.amdgcn_target "amdgcn-amd-amdhsa--gfx950"
.text
.globl standalone__modern_conv_block_convnext_v2__vision_kernel
.p2align 8
.type standalone__modern_conv_block_convnext_v2__vision_kernel,@function
standalone__modern_conv_block_convnext_v2__vision_kernel:
    s_cmp_ge_u32 s2, 256
    s_cbranch_scc1 L_end
    s_load_dwordx16 s[32:47], s[0:1], 0
    s_load_dwordx2 s[48:49], s[0:1], 64
    s_getpc_b64 s[98:99]
L_pc:
    s_lshr_b32 s52, s2, 3
    s_mul_i32 s53, s52, 1408
    v_min_u32 v250, 31, v0
    v_lshl_add_u32 v250, v250, 7, s53
    v_min_u32 v250, L_fin-L_pc, v250
    global_load_dword v7, v250, s[98:99]
    s_mul_i32 s53, s52, 9216
    v_min_u32 v253, 127, v0
    v_lshl_add_u32 v253, v253, 7, s53
    v_subrev_u32 v251, 294912, v253
    v_min_u32 v253, v253, v251
    v_lshrrev_b32 v249, 6, v0
    v_and_b32 v248, 63, v0
    v_readfirstlane_b32 s3, v249
    v_lshrrev_b32 v36, 3, v248
    s_lshr_b32 s72, s3, 1
    v_lshrrev_b32 v37, 5, v248
    v_lshl_add_u32 v37, v37, 2, v36
    v_mul_u32_u24 v37, 1536, v37
    v_lshrrev_b32 v251, 4, v248
    v_lshlrev_b32 v38, 1, v251
    v_xor_b32 v38, v38, v248
    v_and_b32 v38, 7, v38
    v_lshl_add_u32 v32, v38, 4, v37
    v_add_u32 v33, 5120, v32
    v_add_u32 v34, 22528, v32
    v_add_u32 v35, 27648, v32
    s_lshl_b32 s53, s3, 15
    s_add_u32 s60, s53, 51712
    s_cmp_eq_u32 s3, 3
    s_cselect_b32 s60, 0, s60
    s_mul_i32 s64, s3, 384
    s_mul_i32 s53, s72, 49152
    s_add_u32 s58, s64, s53
    s_sub_u32 s53, 49152, s53
    s_add_u32 s59, s64, s53
    s_lshl_b32 s52, s3, 3
    v_add_u32 v36, s52, v36
    v_lshrrev_b32 v252, 1, v36
    v_xor_b32 v252, v252, v248
    v_and_b32 v252, 7, v252
    v_lshlrev_b32 v252, 4, v252
    v_mul_u32_u24 v37, 384, v36
    v_add_u32 v0, v37, v252
    s_mul_i32 s52, s2, 221184
    s_mov_b32 s22, 294912
    s_mov_b32 s23, 0x20000
    s_mov_b32 s6, 221184
    s_mov_b32 s7, 0x20000
    s_mov_b32 s26, 384
    s_mov_b32 s27, 0x20000
    s_mov_b32 s55, 0
    s_waitcnt lgkmcnt(0)
    s_mov_b64 s[20:21], s[36:37]
    buffer_load_dword v7, v253, s[20:23], 0 offen
    s_add_u32 s4, s32, s52
    s_addc_u32 s5, s33, 0
    buffer_load_dwordx4 v[192:195], v0, s[4:7], s55 offen offset:0
    buffer_load_dwordx4 v[196:199], v0, s[4:7], s55 offen offset:128
    buffer_load_dwordx4 v[200:203], v0, s[4:7], s55 offen offset:256
    s_mov_b64 s[24:25], s[34:35]
    buffer_load_dwordx4 v[216:219], v252, s[24:27], 0 offen offset:0
    buffer_load_dwordx4 v[220:223], v252, s[24:27], 0 offen offset:128
    buffer_load_dwordx4 v[224:227], v252, s[24:27], 0 offen offset:256
    s_add_u32 m0, s60, 0
    s_add_u32 s53, s58, 0
    buffer_load_dwordx4 v32, s[20:23], s53 offen offset:0 lds
    buffer_load_dwordx4 v33, s[20:23], s53 offen offset:1024 lds
    buffer_load_dwordx4 v34, s[20:23], s53 offen offset:2048 lds
    buffer_load_dwordx4 v35, s[20:23], s53 offen offset:3072 lds
    s_add_u32 m0, s60, 4096
    s_add_u32 s53, s58, 98304
    buffer_load_dwordx4 v32, s[20:23], s53 offen offset:0 lds
    buffer_load_dwordx4 v33, s[20:23], s53 offen offset:1024 lds
    buffer_load_dwordx4 v34, s[20:23], s53 offen offset:2048 lds
    buffer_load_dwordx4 v35, s[20:23], s53 offen offset:3072 lds
    v_lshlrev_b32 v1, 4, v248
    s_and_b32 s73, s3, 1
    v_lshlrev_b32 v9, 2, v36
    v_add_u32 v9, 49152, v9
    s_add_u32 s8, s44, s52
    s_addc_u32 s9, s45, 0
    s_mov_b32 s10, 0
    s_mov_b32 s11, 0x20000
    s_mul_i32 s52, s2, 663552
    s_add_u32 s52, s52, 0
    s_add_u32 s12, s48, s52
    s_addc_u32 s13, s49, 0
    s_mov_b32 s14, 663552
    s_mov_b32 s15, 0x20000
    s_add_u32 s16, s48, 234881024
    s_addc_u32 s17, s49, 0
    s_mov_b32 s18, 720896
    s_mov_b32 s19, 0x20000
    s_add_u32 s28, s48, 234881024
    s_addc_u32 s29, s49, 0
    s_mov_b32 s30, 0
    s_mov_b32 s31, 0x20000
    s_mov_b32 s77, 0xffff0000
    v_and_b32 v250, 15, v248
    v_mul_u32_u24 v10, 1536, v251
    v_lshl_add_u32 v10, v250, 1, v10
    s_and_b32 s52, s2, 0xf9
    s_cmp_eq_u32 s52, 96
    s_cbranch_scc1 L_j1a
L_j1a_ret:
    s_mul_i32 s52, s72, 6144
    s_lshl_b32 s53, s73, 10
    s_add_u32 s62, s52, s53
    v_add_u32 v8, s62, v1
    v_add_u32 v6, 150016, v8
    v_lshrrev_b32 v253, 1, v250
    v_xor_b32 v253, v253, v251
    s_lshl_b32 s52, s72, 2
    v_xor_b32 v253, s52, v253
    v_lshlrev_b32 v253, 4, v253
    v_lshl_add_u32 v2, v250, 7, v253
    v_xor_b32 v3, 64, v2
    v_add_u32 v4, 150016, v2
    v_add_u32 v5, 150016, v3
    v_bfe_u32 v36, v248, 2, 3
    v_lshrrev_b32 v37, 5, v248
    v_lshlrev_b32 v37, 11, v37
    v_lshl_add_u32 v37, v36, 7, v37
    v_and_b32 v38, 3, v248
    v_lshlrev_b32 v249, 2, v38
    v_lshl_add_u32 v37, v38, 3, v37
    v_add_u32 v37, s60, v37
    v_lshrrev_b32 v36, 1, v36
    v_xor_b32 v38, 0, v36
    v_lshl_add_u32 v28, v38, 5, v37
    v_xor_b32 v38, 1, v36
    v_lshl_add_u32 v29, v38, 5, v37
    v_xor_b32 v38, 2, v36
    v_lshl_add_u32 v30, v38, 5, v37
    v_xor_b32 v38, 3, v36
    v_lshl_add_u32 v31, v38, 5, v37
    v_mov_b32 v245, 0x3727c5ac
    s_mov_b32 s50, 0x409d30fc
    s_mov_b32 s51, 0x409d30fc
    s_mul_i32 s74, s3, 5120
    s_mul_i32 s75, s3, 4096
    s_mov_b32 s56, s74
    s_add_u32 s57, s75, 20480
    s_mov_b32 s82, 0x40000000
    s_mov_b32 s83, 51712
    s_mov_b32 s84, 0x40000000
    s_mov_b32 s85, 51712
    s_add_u32 s86, s74, 0
    s_add_u32 s87, s74, 68096
    s_add_u32 s88, s75, 20480
    s_add_u32 s89, s75, 88576
    s_add_u32 s90, s74, 36864
    s_add_u32 s91, s74, 109056
    s_add_u32 s92, s75, 57344
    s_add_u32 s93, s75, 129536
    s_mov_b32 s94, 0x40000000
    s_mov_b32 s95, 51712
    s_mov_b32 s96, 0x40000000
    s_mov_b32 s97, 51712
    s_lshr_b32 s52, s2, 3
    s_mul_i32 s53, s52, 768
    s_add_u32 s53, s53, L_last-L_pc
    v_lshl_add_u32 v250, v250, 7, s53
    v_min_u32 v250, L_fin-L_pc, v250
    s_lshl_b32 s53, s3, 13
    s_mul_i32 s52, s52, 12288
    s_add_u32 s52, s52, s53
    v_lshl_add_u32 v254, v1, 3, s52
    v_subrev_u32 v36, 393216, v254
    v_min_u32 v254, v254, v36
    s_mul_i32 s80, s3, 73728
    s_mul_i32 s81, s3, 24576
    s_add_u32 s81, s81, 294912
    s_lshl_b32 s52, s3, 2
    v_mov_b32 v252, s52
    v_mov_b32 v253, 0
    ds_write_b32 v252, v253 offset:51584
    s_add_u32 m0, s60, 8192
    s_add_u32 s53, s58, 196608
    buffer_load_dwordx4 v32, s[20:23], s53 offen offset:0 lds
    buffer_load_dwordx4 v33, s[20:23], s53 offen offset:1024 lds
    buffer_load_dwordx4 v34, s[20:23], s53 offen offset:2048 lds
    buffer_load_dwordx4 v35, s[20:23], s53 offen offset:3072 lds
    s_add_u32 m0, s60, 12288
    s_add_u32 s53, s59, 0
    buffer_load_dwordx4 v32, s[20:23], s53 offen offset:0 lds
    buffer_load_dwordx4 v33, s[20:23], s53 offen offset:1024 lds
    buffer_load_dwordx4 v34, s[20:23], s53 offen offset:2048 lds
    buffer_load_dwordx4 v35, s[20:23], s53 offen offset:3072 lds
    s_waitcnt vmcnt(16)
    v_and_b32 v169, s77, v216
    v_xor_b32 v168, v169, v216
    v_and_b32 v171, s77, v217
    v_xor_b32 v170, v171, v217
    v_and_b32 v173, s77, v218
    v_xor_b32 v172, v173, v218
    v_and_b32 v175, s77, v219
    v_xor_b32 v174, v175, v219
    v_and_b32 v177, s77, v220
    v_xor_b32 v176, v177, v220
    v_and_b32 v179, s77, v221
    v_xor_b32 v178, v179, v221
    v_and_b32 v181, s77, v222
    v_xor_b32 v180, v181, v222
    v_and_b32 v183, s77, v223
    v_xor_b32 v182, v183, v223
    v_and_b32 v185, s77, v224
    v_xor_b32 v184, v185, v224
    v_and_b32 v187, s77, v225
    v_xor_b32 v186, v187, v225
    v_and_b32 v189, s77, v226
    v_xor_b32 v188, v189, v226
    v_and_b32 v191, s77, v227
    v_xor_b32 v190, v191, v227
    v_dot2_f32_bf16 v216, v192, v168, 0
    v_dot2_f32_bf16 v217, v192, v169, 0
    v_dot2_f32_bf16 v218, v193, v170, 0
    v_dot2_f32_bf16 v219, v193, v171, 0
    v_dot2_f32_bf16 v220, v194, v172, 0
    v_dot2_f32_bf16 v221, v194, v173, 0
    v_dot2_f32_bf16 v222, v195, v174, 0
    v_dot2_f32_bf16 v223, v195, v175, 0
    v_dot2_f32_bf16 v224, v196, v176, 0
    v_dot2_f32_bf16 v225, v196, v177, 0
    v_dot2_f32_bf16 v226, v197, v178, 0
    v_dot2_f32_bf16 v227, v197, v179, 0
    v_dot2_f32_bf16 v228, v198, v180, 0
    v_dot2_f32_bf16 v229, v198, v181, 0
    v_dot2_f32_bf16 v230, v199, v182, 0
    v_dot2_f32_bf16 v231, v199, v183, 0
    v_dot2_f32_bf16 v232, v200, v184, 0
    v_dot2_f32_bf16 v233, v200, v185, 0
    v_dot2_f32_bf16 v234, v201, v186, 0
    v_dot2_f32_bf16 v235, v201, v187, 0
    v_dot2_f32_bf16 v236, v202, v188, 0
    v_dot2_f32_bf16 v237, v202, v189, 0
    v_dot2_f32_bf16 v238, v203, v190, 0
    v_dot2_f32_bf16 v239, v203, v191, 0
    s_add_u32 m0, s60, 16384
    s_add_u32 s53, s59, 98304
    buffer_load_dwordx4 v32, s[20:23], s53 offen offset:0 lds
    buffer_load_dwordx4 v33, s[20:23], s53 offen offset:1024 lds
    buffer_load_dwordx4 v34, s[20:23], s53 offen offset:2048 lds
    buffer_load_dwordx4 v35, s[20:23], s53 offen offset:3072 lds
    s_add_u32 m0, s60, 20480
    s_add_u32 s53, s59, 196608
    buffer_load_dwordx4 v32, s[20:23], s53 offen offset:0 lds
    buffer_load_dwordx4 v33, s[20:23], s53 offen offset:1024 lds
    buffer_load_dwordx4 v34, s[20:23], s53 offen offset:2048 lds
    buffer_load_dwordx4 v35, s[20:23], s53 offen offset:3072 lds
    v_pk_mul_f32 v[242:243], v[216:217], v[216:217]
    v_pk_add_f32 v[240:241], v[216:217], v[218:219]
    v_pk_fma_f32 v[242:243], v[218:219], v[218:219], v[242:243]
    v_pk_fma_f32 v[242:243], v[220:221], v[220:221], v[242:243]
    v_pk_add_f32 v[240:241], v[240:241], v[220:221]
    v_pk_fma_f32 v[242:243], v[222:223], v[222:223], v[242:243]
    v_pk_add_f32 v[240:241], v[240:241], v[222:223]
    v_pk_fma_f32 v[242:243], v[224:225], v[224:225], v[242:243]
    v_pk_add_f32 v[240:241], v[240:241], v[224:225]
    v_pk_fma_f32 v[242:243], v[226:227], v[226:227], v[242:243]
    v_pk_add_f32 v[240:241], v[240:241], v[226:227]
    v_pk_fma_f32 v[242:243], v[228:229], v[228:229], v[242:243]
    v_pk_add_f32 v[240:241], v[240:241], v[228:229]
    v_pk_fma_f32 v[242:243], v[230:231], v[230:231], v[242:243]
    v_pk_add_f32 v[240:241], v[240:241], v[230:231]
    v_pk_fma_f32 v[242:243], v[232:233], v[232:233], v[242:243]
    v_pk_add_f32 v[240:241], v[240:241], v[232:233]
    v_pk_fma_f32 v[242:243], v[234:235], v[234:235], v[242:243]
    v_pk_add_f32 v[240:241], v[240:241], v[234:235]
    v_pk_fma_f32 v[242:243], v[236:237], v[236:237], v[242:243]
    v_pk_add_f32 v[240:241], v[240:241], v[236:237]
    v_pk_fma_f32 v[242:243], v[238:239], v[238:239], v[242:243]
    v_pk_add_f32 v[240:241], v[240:241], v[238:239]
    v_add_f32 v240, v240, v241
    v_add_f32 v242, v242, v243
    s_nop 0
    v_add_f32_dpp v240, v240, v240 quad_perm:[1,0,3,2] row_mask:0xf bank_mask:0xf
    v_add_f32_dpp v242, v242, v242 quad_perm:[1,0,3,2] row_mask:0xf bank_mask:0xf
    s_nop 0
    v_add_f32_dpp v240, v240, v240 quad_perm:[2,3,0,1] row_mask:0xf bank_mask:0xf
    v_add_f32_dpp v242, v242, v242 quad_perm:[2,3,0,1] row_mask:0xf bank_mask:0xf
    s_nop 0
    v_add_f32_dpp v240, v240, v240 row_half_mirror row_mask:0xf bank_mask:0xf
    v_add_f32_dpp v242, v242, v242 row_half_mirror row_mask:0xf bank_mask:0xf
    s_nop 0
    v_mul_f32 v244, 0x3baaaaab, v240
    v_fma_f32 v240, -v244, v244, v245
    v_fmamk_f32 v242, v242, 0x3baaaaab, v240
    v_max_f32 v242, v242, v245
    v_rsq_f32 v242, v242
    s_nop 0
    v_mul_f32 v246, 0xbeeff558, v242
    v_mul_f32_e64 v247, -v244, v246
    s_add_u32 m0, s60, 24576
    s_add_u32 s53, s58, 128
    buffer_load_dwordx4 v32, s[20:23], s53 offen offset:0 lds
    buffer_load_dwordx4 v33, s[20:23], s53 offen offset:1024 lds
    buffer_load_dwordx4 v34, s[20:23], s53 offen offset:2048 lds
    buffer_load_dwordx4 v35, s[20:23], s53 offen offset:3072 lds
    s_add_u32 m0, s60, 28672
    s_add_u32 s53, s58, 98432
    buffer_load_dwordx4 v32, s[20:23], s53 offen offset:0 lds
    buffer_load_dwordx4 v33, s[20:23], s53 offen offset:1024 lds
    buffer_load_dwordx4 v34, s[20:23], s53 offen offset:2048 lds
    buffer_load_dwordx4 v35, s[20:23], s53 offen offset:3072 lds
    v_pk_fma_f32 v[216:217], v[216:217], v[246:247], v[246:247] op_sel:[0,0,1] op_sel_hi:[1,0,1]
    v_pk_fma_f32 v[218:219], v[218:219], v[246:247], v[246:247] op_sel:[0,0,1] op_sel_hi:[1,0,1]
    v_pk_fma_f32 v[220:221], v[220:221], v[246:247], v[246:247] op_sel:[0,0,1] op_sel_hi:[1,0,1]
    v_pk_fma_f32 v[222:223], v[222:223], v[246:247], v[246:247] op_sel:[0,0,1] op_sel_hi:[1,0,1]
    v_pk_fma_f32 v[224:225], v[224:225], v[246:247], v[246:247] op_sel:[0,0,1] op_sel_hi:[1,0,1]
    v_pk_fma_f32 v[226:227], v[226:227], v[246:247], v[246:247] op_sel:[0,0,1] op_sel_hi:[1,0,1]
    v_pk_fma_f32 v[228:229], v[228:229], v[246:247], v[246:247] op_sel:[0,0,1] op_sel_hi:[1,0,1]
    v_pk_fma_f32 v[230:231], v[230:231], v[246:247], v[246:247] op_sel:[0,0,1] op_sel_hi:[1,0,1]
    v_pk_fma_f32 v[232:233], v[232:233], v[246:247], v[246:247] op_sel:[0,0,1] op_sel_hi:[1,0,1]
    v_pk_fma_f32 v[234:235], v[234:235], v[246:247], v[246:247] op_sel:[0,0,1] op_sel_hi:[1,0,1]
    v_pk_fma_f32 v[236:237], v[236:237], v[246:247], v[246:247] op_sel:[0,0,1] op_sel_hi:[1,0,1]
    v_pk_fma_f32 v[238:239], v[238:239], v[246:247], v[246:247] op_sel:[0,0,1] op_sel_hi:[1,0,1]
    v_cvt_pk_bf16_f32 v216, v216, v217
    v_cvt_pk_bf16_f32 v217, v218, v219
    v_cvt_pk_bf16_f32 v218, v220, v221
    v_cvt_pk_bf16_f32 v219, v222, v223
    v_cvt_pk_bf16_f32 v220, v224, v225
    v_cvt_pk_bf16_f32 v221, v226, v227
    v_cvt_pk_bf16_f32 v222, v228, v229
    v_cvt_pk_bf16_f32 v223, v230, v231
    v_cvt_pk_bf16_f32 v224, v232, v233
    v_cvt_pk_bf16_f32 v225, v234, v235
    v_cvt_pk_bf16_f32 v226, v236, v237
    v_cvt_pk_bf16_f32 v227, v238, v239
    ds_write_b128 v8, v[216:219] offset:36864
    ds_write_b128 v8, v[220:223] offset:38912
    ds_write_b128 v8, v[224:227] offset:40960
    ds_write_b32 v9, v246 offset:0
    s_mov_b32 s55, 12288
    buffer_load_dwordx4 v[204:207], v0, s[4:7], s55 offen offset:0
    buffer_load_dwordx4 v[208:211], v0, s[4:7], s55 offen offset:128
    buffer_load_dwordx4 v[212:215], v0, s[4:7], s55 offen offset:256
    s_mov_b32 s55, 24576
    s_waitcnt vmcnt(31)
    ds_read_b64_tr_b16 a[0:1], v28 offset:0
    ds_read_b64_tr_b16 a[2:3], v28 offset:1024
    ds_read_b64_tr_b16 a[24:25], v29 offset:0
    ds_read_b64_tr_b16 a[26:27], v29 offset:1024
    ds_read_b64_tr_b16 a[48:49], v30 offset:0
    ds_read_b64_tr_b16 a[50:51], v30 offset:1024
    ds_read_b64_tr_b16 a[72:73], v31 offset:0
    ds_read_b64_tr_b16 a[74:75], v31 offset:1024
    s_waitcnt vmcnt(27)
    ds_read_b64_tr_b16 a[4:5], v28 offset:4096
    ds_read_b64_tr_b16 a[6:7], v28 offset:5120
    ds_read_b64_tr_b16 a[28:29], v29 offset:4096
    ds_read_b64_tr_b16 a[30:31], v29 offset:5120
    ds_read_b64_tr_b16 a[52:53], v30 offset:4096
    ds_read_b64_tr_b16 a[54:55], v30 offset:5120
    ds_read_b64_tr_b16 a[76:77], v31 offset:4096
    ds_read_b64_tr_b16 a[78:79], v31 offset:5120
    s_waitcnt lgkmcnt(8)
    s_add_u32 m0, s60, 0
    s_add_u32 s53, s58, 196736
    buffer_load_dwordx4 v32, s[20:23], s53 offen offset:0 lds
    buffer_load_dwordx4 v33, s[20:23], s53 offen offset:1024 lds
    buffer_load_dwordx4 v34, s[20:23], s53 offen offset:2048 lds
    buffer_load_dwordx4 v35, s[20:23], s53 offen offset:3072 lds
    s_waitcnt vmcnt(27)
    ds_read_b64_tr_b16 a[8:9], v28 offset:8192
    ds_read_b64_tr_b16 a[10:11], v28 offset:9216
    ds_read_b64_tr_b16 a[32:33], v29 offset:8192
    ds_read_b64_tr_b16 a[34:35], v29 offset:9216
    ds_read_b64_tr_b16 a[56:57], v30 offset:8192
    ds_read_b64_tr_b16 a[58:59], v30 offset:9216
    ds_read_b64_tr_b16 a[80:81], v31 offset:8192
    ds_read_b64_tr_b16 a[82:83], v31 offset:9216
    s_waitcnt lgkmcnt(8)
    s_add_u32 m0, s60, 4096
    s_add_u32 s53, s59, 128
    buffer_load_dwordx4 v32, s[20:23], s53 offen offset:0 lds
    buffer_load_dwordx4 v33, s[20:23], s53 offen offset:1024 lds
    buffer_load_dwordx4 v34, s[20:23], s53 offen offset:2048 lds
    buffer_load_dwordx4 v35, s[20:23], s53 offen offset:3072 lds
    s_waitcnt vmcnt(27)
    ds_read_b64_tr_b16 a[12:13], v28 offset:12288
    ds_read_b64_tr_b16 a[14:15], v28 offset:13312
    ds_read_b64_tr_b16 a[36:37], v29 offset:12288
    ds_read_b64_tr_b16 a[38:39], v29 offset:13312
    ds_read_b64_tr_b16 a[60:61], v30 offset:12288
    ds_read_b64_tr_b16 a[62:63], v30 offset:13312
    ds_read_b64_tr_b16 a[84:85], v31 offset:12288
    ds_read_b64_tr_b16 a[86:87], v31 offset:13312
    s_waitcnt lgkmcnt(15)
    s_barrier
    ds_read_b128 v[144:147], v2 offset:36864
    ds_read_b128 v[148:151], v2 offset:38912
    ds_read_b128 v[152:155], v2 offset:40960
    ds_read_b128 v[156:159], v3 offset:36864
    ds_read_b128 v[160:163], v3 offset:38912
    ds_read_b128 v[164:167], v3 offset:40960
    s_waitcnt vmcnt(23)
    ds_read_b64_tr_b16 a[16:17], v28 offset:16384
    ds_read_b64_tr_b16 a[18:19], v28 offset:17408
    ds_read_b64_tr_b16 a[40:41], v29 offset:16384
    ds_read_b64_tr_b16 a[42:43], v29 offset:17408
    ds_read_b64_tr_b16 a[64:65], v30 offset:16384
    ds_read_b64_tr_b16 a[66:67], v30 offset:17408
    ds_read_b64_tr_b16 a[88:89], v31 offset:16384
    ds_read_b64_tr_b16 a[90:91], v31 offset:17408
    s_waitcnt vmcnt(19)
    ds_read_b64_tr_b16 a[20:21], v28 offset:20480
    ds_read_b64_tr_b16 a[22:23], v28 offset:21504
    ds_read_b64_tr_b16 a[44:45], v29 offset:20480
    ds_read_b64_tr_b16 a[46:47], v29 offset:21504
    ds_read_b64_tr_b16 a[68:69], v30 offset:20480
    ds_read_b64_tr_b16 a[70:71], v30 offset:21504
    ds_read_b64_tr_b16 a[92:93], v31 offset:20480
    ds_read_b64_tr_b16 a[94:95], v31 offset:21504
    buffer_load_dwordx4 v[192:195], v0, s[4:7], s55 offen offset:0
    buffer_load_dwordx4 v[196:199], v0, s[4:7], s55 offen offset:128
    buffer_load_dwordx4 v[200:203], v0, s[4:7], s55 offen offset:256
    s_add_u32 s55, s55, 12288
    s_and_b32 s52, s2, 0xf9
    s_cmp_eq_u32 s52, 96
    s_cbranch_scc1 L_j1b
L_j1b_ret:
    s_mov_b32 s24, s38
    s_mov_b32 s25, s39
    s_mov_b32 s26, 0
    s_mov_b32 s27, 0x20000
    s_mov_b32 s54, 8
    s_mov_b32 s67, 0x40000000
    s_mov_b32 s79, 128
    s_mov_b32 s78, 2048
    s_waitcnt lgkmcnt(0)
    v_mfma_f32_16x16x32_bf16 v[60:63], a[0:3], v[144:147], 0
    s_add_u32 m0, s60, 8192
    s_add_u32 s53, s59, 98432
    s_waitcnt vmcnt(18)
    ds_read_b64_tr_b16 a[96:97], v28 offset:24576
    ds_read_b64_tr_b16 a[98:99], v28 offset:25600
    v_mfma_f32_16x16x32_bf16 v[60:63], a[4:7], v[148:151], v[60:63]
    ds_read_b64_tr_b16 a[120:121], v29 offset:24576
    ds_read_b64_tr_b16 a[122:123], v29 offset:25600
    buffer_load_dwordx4 v32, s[20:23], s53 offen offset:0 lds
    v_mfma_f32_16x16x32_bf16 v[60:63], a[8:11], v[152:155], v[60:63]
    ds_read_b64_tr_b16 a[144:145], v30 offset:24576
    ds_read_b64_tr_b16 a[146:147], v30 offset:25600
    v_mfma_f32_16x16x32_bf16 v[60:63], a[12:15], v[156:159], v[60:63]
    ds_read_b64_tr_b16 a[168:169], v31 offset:24576
    ds_read_b64_tr_b16 a[170:171], v31 offset:25600
    buffer_load_dwordx4 v33, s[20:23], s53 offen offset:1024 lds
    v_mfma_f32_16x16x32_bf16 v[60:63], a[16:19], v[160:163], v[60:63]
    v_mfma_f32_16x16x32_bf16 v[60:63], a[20:23], v[164:167], v[60:63]
    s_waitcnt vmcnt(16)
    ds_read_b64_tr_b16 a[100:101], v28 offset:28672
    ds_read_b64_tr_b16 a[102:103], v28 offset:29696
    v_mfma_f32_16x16x32_bf16 v[64:67], a[24:27], v[144:147], 0
    ds_read_b64_tr_b16 a[124:125], v29 offset:28672
    ds_read_b64_tr_b16 a[126:127], v29 offset:29696
    buffer_load_dwordx4 v34, s[20:23], s53 offen offset:2048 lds
    v_mfma_f32_16x16x32_bf16 v[64:67], a[28:31], v[148:151], v[64:67]
    ds_read_b64_tr_b16 a[148:149], v30 offset:28672
    ds_read_b64_tr_b16 a[150:151], v30 offset:29696
    v_mfma_f32_16x16x32_bf16 v[64:67], a[32:35], v[152:155], v[64:67]
    ds_read_b64_tr_b16 a[172:173], v31 offset:28672
    ds_read_b64_tr_b16 a[174:175], v31 offset:29696
    buffer_load_dwordx4 v35, s[20:23], s53 offen offset:3072 lds
    v_mfma_f32_16x16x32_bf16 v[64:67], a[36:39], v[156:159], v[64:67]
    s_add_u32 m0, s60, 12288
    s_add_u32 s53, s59, 196736
    v_mfma_f32_16x16x32_bf16 v[64:67], a[40:43], v[160:163], v[64:67]
    buffer_load_dwordx4 v32, s[20:23], s53 offen offset:0 lds
    v_mfma_f32_16x16x32_bf16 v[64:67], a[44:47], v[164:167], v[64:67]
    buffer_load_dwordx4 v33, s[20:23], s53 offen offset:1024 lds
    s_nop 7
    s_waitcnt vmcnt(17)
    v_dot2_f32_bf16 v216, v204, v168, 0
    v_dot2_f32_bf16 v217, v204, v169, 0
    v_dot2_f32_bf16 v218, v205, v170, 0
    v_dot2_f32_bf16 v219, v205, v171, 0
    v_dot2_f32_bf16 v220, v206, v172, 0
    v_dot2_f32_bf16 v221, v206, v173, 0
    v_dot2_f32_bf16 v222, v207, v174, 0
    v_dot2_f32_bf16 v223, v207, v175, 0
    v_dot2_f32_bf16 v224, v208, v176, 0
    v_dot2_f32_bf16 v225, v208, v177, 0
    v_dot2_f32_bf16 v226, v209, v178, 0
    v_dot2_f32_bf16 v227, v209, v179, 0
    v_dot2_f32_bf16 v228, v210, v180, 0
    v_dot2_f32_bf16 v229, v210, v181, 0
    v_dot2_f32_bf16 v230, v211, v182, 0
    v_dot2_f32_bf16 v231, v211, v183, 0
    v_dot2_f32_bf16 v232, v212, v184, 0
    v_dot2_f32_bf16 v233, v212, v185, 0
    v_dot2_f32_bf16 v234, v213, v186, 0
    v_dot2_f32_bf16 v235, v213, v187, 0
    v_dot2_f32_bf16 v236, v214, v188, 0
    v_dot2_f32_bf16 v237, v214, v189, 0
    v_dot2_f32_bf16 v238, v215, v190, 0
    v_dot2_f32_bf16 v239, v215, v191, 0
    v_pk_fma_f32 v[96:97], v[60:61], v[60:61], s[50:51]
    v_pk_fma_f32 v[98:99], v[62:63], v[62:63], s[50:51]
    v_pk_fma_f32 v[100:101], v[64:65], v[64:65], s[50:51]
    v_pk_fma_f32 v[102:103], v[66:67], v[66:67], s[50:51]
    v_pk_mul_f32 v[96:97], v[96:97], v[60:61]
    v_pk_mul_f32 v[98:99], v[98:99], v[62:63]
    v_pk_mul_f32 v[100:101], v[100:101], v[64:65]
    v_pk_mul_f32 v[102:103], v[102:103], v[66:67]
    v_mfma_f32_16x16x32_bf16 v[68:71], a[48:51], v[144:147], 0
    s_waitcnt vmcnt(13)
    ds_read_b64_tr_b16 a[104:105], v28 offset:0
    ds_read_b64_tr_b16 a[106:107], v28 offset:1024
    v_exp_f32 v96, v96
    v_mfma_f32_16x16x32_bf16 v[68:71], a[52:55], v[148:151], v[68:71]
    ds_read_b64_tr_b16 a[128:129], v29 offset:0
    ds_read_b64_tr_b16 a[130:131], v29 offset:1024
    buffer_load_dwordx4 v34, s[20:23], s53 offen offset:2048 lds
    v_exp_f32 v97, v97
    v_mfma_f32_16x16x32_bf16 v[68:71], a[56:59], v[152:155], v[68:71]
    ds_read_b64_tr_b16 a[152:153], v30 offset:0
    ds_read_b64_tr_b16 a[154:155], v30 offset:1024
    v_exp_f32 v98, v98
    v_mfma_f32_16x16x32_bf16 v[68:71], a[60:63], v[156:159], v[68:71]
    ds_read_b64_tr_b16 a[176:177], v31 offset:0
    ds_read_b64_tr_b16 a[178:179], v31 offset:1024
    buffer_load_dwordx4 v35, s[20:23], s53 offen offset:3072 lds
    v_exp_f32 v99, v99
    v_mfma_f32_16x16x32_bf16 v[68:71], a[64:67], v[160:163], v[68:71]
    v_mfma_f32_16x16x32_bf16 v[68:71], a[68:71], v[164:167], v[68:71]
    s_add_u32 m0, s60, 16384
    s_add_u32 s53, s58, 256
    v_mfma_f32_16x16x32_bf16 v[72:75], a[72:75], v[144:147], 0
    ds_read_b128 v[144:147], v2 offset:43008
    buffer_load_dwordx4 v32, s[20:23], s53 offen offset:0 lds
    v_mfma_f32_16x16x32_bf16 v[72:75], a[76:79], v[148:151], v[72:75]
    ds_read_b128 v[148:151], v2 offset:45056
    v_mfma_f32_16x16x32_bf16 v[72:75], a[80:83], v[152:155], v[72:75]
    ds_read_b128 v[152:155], v2 offset:47104
    buffer_load_dwordx4 v33, s[20:23], s53 offen offset:1024 lds
    v_mfma_f32_16x16x32_bf16 v[72:75], a[84:87], v[156:159], v[72:75]
    ds_read_b128 v[156:159], v3 offset:43008
    v_mfma_f32_16x16x32_bf16 v[72:75], a[88:91], v[160:163], v[72:75]
    ds_read_b128 v[160:163], v3 offset:45056
    buffer_load_dwordx4 v34, s[20:23], s53 offen offset:2048 lds
    v_mfma_f32_16x16x32_bf16 v[72:75], a[92:95], v[164:167], v[72:75]
    ds_read_b128 v[164:167], v3 offset:47104
    buffer_load_dwordx4 v35, s[20:23], s53 offen offset:3072 lds
    v_exp_f32 v100, v100
    v_exp_f32 v101, v101
    v_exp_f32 v102, v102
    v_exp_f32 v103, v103
    s_nop 7
    v_pk_add_f32 v[96:97], v[96:97], 1.0 op_sel_hi:[1,0]
    v_pk_add_f32 v[98:99], v[98:99], 1.0 op_sel_hi:[1,0]
    v_pk_add_f32 v[100:101], v[100:101], 1.0 op_sel_hi:[1,0]
    v_pk_add_f32 v[102:103], v[102:103], 1.0 op_sel_hi:[1,0]
    buffer_load_dwordx4 v[204:207], v0, s[4:7], s55 offen offset:0
    buffer_load_dwordx4 v[208:211], v0, s[4:7], s55 offen offset:128
    buffer_load_dwordx4 v[212:215], v0, s[4:7], s55 offen offset:256
    s_add_u32 s55, s55, 12288
    v_pk_mul_f32 v[242:243], v[216:217], v[216:217]
    v_pk_add_f32 v[240:241], v[216:217], v[218:219]
    v_pk_fma_f32 v[242:243], v[218:219], v[218:219], v[242:243]
    v_pk_fma_f32 v[242:243], v[220:221], v[220:221], v[242:243]
    v_pk_add_f32 v[240:241], v[240:241], v[220:221]
    v_pk_fma_f32 v[242:243], v[222:223], v[222:223], v[242:243]
    v_pk_add_f32 v[240:241], v[240:241], v[222:223]
    v_pk_fma_f32 v[242:243], v[224:225], v[224:225], v[242:243]
    v_pk_add_f32 v[240:241], v[240:241], v[224:225]
    v_pk_fma_f32 v[242:243], v[226:227], v[226:227], v[242:243]
    v_pk_add_f32 v[240:241], v[240:241], v[226:227]
    v_pk_fma_f32 v[242:243], v[228:229], v[228:229], v[242:243]
    v_pk_add_f32 v[240:241], v[240:241], v[228:229]
    v_pk_fma_f32 v[242:243], v[230:231], v[230:231], v[242:243]
    v_pk_add_f32 v[240:241], v[240:241], v[230:231]
    v_pk_fma_f32 v[242:243], v[232:233], v[232:233], v[242:243]
    v_pk_add_f32 v[240:241], v[240:241], v[232:233]
    v_pk_fma_f32 v[242:243], v[234:235], v[234:235], v[242:243]
    v_pk_add_f32 v[240:241], v[240:241], v[234:235]
    v_pk_fma_f32 v[242:243], v[236:237], v[236:237], v[242:243]
    v_pk_add_f32 v[240:241], v[240:241], v[236:237]
    v_pk_fma_f32 v[242:243], v[238:239], v[238:239], v[242:243]
    v_pk_add_f32 v[240:241], v[240:241], v[238:239]
    s_waitcnt lgkmcnt(5)
    v_pk_fma_f32 v[88:89], v[68:69], v[68:69], s[50:51]
    v_pk_fma_f32 v[90:91], v[70:71], v[70:71], s[50:51]
    v_pk_fma_f32 v[92:93], v[72:73], v[72:73], s[50:51]
    v_pk_fma_f32 v[94:95], v[74:75], v[74:75], s[50:51]
    v_pk_mul_f32 v[88:89], v[88:89], v[68:69]
    v_pk_mul_f32 v[90:91], v[90:91], v[70:71]
    v_pk_mul_f32 v[92:93], v[92:93], v[72:73]
    v_pk_mul_f32 v[94:95], v[94:95], v[74:75]
    v_mfma_f32_16x16x32_bf16 v[76:79], a[0:3], v[144:147], 0
    s_add_u32 m0, s60, 20480
    s_add_u32 s53, s58, 98560
    s_waitcnt vmcnt(18)
    s_waitcnt lgkmcnt(4)
    ds_read_b64_tr_b16 a[108:109], v28 offset:4096
    ds_read_b64_tr_b16 a[110:111], v28 offset:5120
    v_exp_f32 v88, v88
    v_mfma_f32_16x16x32_bf16 v[76:79], a[4:7], v[148:151], v[76:79]
    s_waitcnt lgkmcnt(5)
    ds_read_b64_tr_b16 a[132:133], v29 offset:4096
    ds_read_b64_tr_b16 a[134:135], v29 offset:5120
    buffer_load_dwordx4 v32, s[20:23], s53 offen offset:0 lds
    v_rcp_f32 v96, v96
    v_mfma_f32_16x16x32_bf16 v[76:79], a[8:11], v[152:155], v[76:79]
    s_waitcnt lgkmcnt(6)
    ds_read_b64_tr_b16 a[156:157], v30 offset:4096
    ds_read_b64_tr_b16 a[158:159], v30 offset:5120
    v_exp_f32 v89, v89
    v_mfma_f32_16x16x32_bf16 v[76:79], a[12:15], v[156:159], v[76:79]
    s_waitcnt lgkmcnt(6)
    ds_read_b64_tr_b16 a[180:181], v31 offset:4096
    ds_read_b64_tr_b16 a[182:183], v31 offset:5120
    buffer_load_dwordx4 v33, s[20:23], s53 offen offset:1024 lds
    v_rcp_f32 v97, v97
    v_mfma_f32_16x16x32_bf16 v[76:79], a[16:19], v[160:163], v[76:79]
    v_add_f32 v240, v240, v241
    v_add_f32 v242, v242, v243
    v_exp_f32 v90, v90
    v_mfma_f32_16x16x32_bf16 v[76:79], a[20:23], v[164:167], v[76:79]
    v_add_f32_dpp v240, v240, v240 quad_perm:[1,0,3,2] row_mask:0xf bank_mask:0xf
    v_add_f32_dpp v242, v242, v242 quad_perm:[1,0,3,2] row_mask:0xf bank_mask:0xf
    v_rcp_f32 v98, v98
    v_mfma_f32_16x16x32_bf16 v[80:83], a[24:27], v[144:147], 0
    buffer_load_dwordx4 v34, s[20:23], s53 offen offset:2048 lds
    v_add_f32_dpp v240, v240, v240 quad_perm:[2,3,0,1] row_mask:0xf bank_mask:0xf
    v_add_f32_dpp v242, v242, v242 quad_perm:[2,3,0,1] row_mask:0xf bank_mask:0xf
    v_exp_f32 v91, v91
    v_mfma_f32_16x16x32_bf16 v[80:83], a[28:31], v[148:151], v[80:83]
    v_add_f32_dpp v240, v240, v240 row_half_mirror row_mask:0xf bank_mask:0xf
    v_add_f32_dpp v242, v242, v242 row_half_mirror row_mask:0xf bank_mask:0xf
    v_rcp_f32 v99, v99
    v_mfma_f32_16x16x32_bf16 v[80:83], a[32:35], v[152:155], v[80:83]
    buffer_load_dwordx4 v35, s[20:23], s53 offen offset:3072 lds
    v_mul_f32 v244, 0x3baaaaab, v240
    v_fma_f32 v240, -v244, v244, v245
    v_exp_f32 v92, v92
    v_mfma_f32_16x16x32_bf16 v[80:83], a[36:39], v[156:159], v[80:83]
    s_waitcnt lgkmcnt(15)
    s_add_u32 m0, s60, 24576
    s_add_u32 s53, s58, 196864
    v_fmamk_f32 v242, v242, 0x3baaaaab, v240
    v_max_f32 v242, v242, v245
    v_rsq_f32 v242, v242
    v_rcp_f32 v100, v100
    v_mfma_f32_16x16x32_bf16 v[80:83], a[40:43], v[160:163], v[80:83]
    buffer_load_dwordx4 v32, s[20:23], s53 offen offset:0 lds
    v_mul_f32 v246, 0xbeeff558, v242
    v_mul_f32_e64 v247, -v244, v246
    v_exp_f32 v93, v93
    v_mfma_f32_16x16x32_bf16 v[80:83], a[44:47], v[164:167], v[80:83]
    buffer_load_dwordx4 v33, s[20:23], s53 offen offset:1024 lds
    v_rcp_f32 v101, v101
    v_exp_f32 v94, v94
    v_rcp_f32 v102, v102
    v_exp_f32 v95, v95
    v_rcp_f32 v103, v103
    v_pk_mul_f32 v[104:105], v[60:61], v[96:97]
    v_pk_mul_f32 v[106:107], v[62:63], v[98:99]
    v_pk_mul_f32 v[108:109], v[64:65], v[100:101]
    v_pk_mul_f32 v[110:111], v[66:67], v[102:103]
    v_pk_add_f32 v[88:89], v[88:89], 1.0 op_sel_hi:[1,0]
    v_pk_add_f32 v[90:91], v[90:91], 1.0 op_sel_hi:[1,0]
    v_pk_add_f32 v[92:93], v[92:93], 1.0 op_sel_hi:[1,0]
    v_pk_add_f32 v[94:95], v[94:95], 1.0 op_sel_hi:[1,0]
    v_pk_mul_f32 v[12:13], v[104:105], v[104:105]
    v_pk_mul_f32 v[14:15], v[106:107], v[106:107]
    v_pk_mul_f32 v[16:17], v[108:109], v[108:109]
    v_pk_mul_f32 v[18:19], v[110:111], v[110:111]
    v_pk_fma_f32 v[216:217], v[216:217], v[246:247], v[246:247] op_sel:[0,0,1] op_sel_hi:[1,0,1]
    v_pk_fma_f32 v[218:219], v[218:219], v[246:247], v[246:247] op_sel:[0,0,1] op_sel_hi:[1,0,1]
    v_pk_fma_f32 v[220:221], v[220:221], v[246:247], v[246:247] op_sel:[0,0,1] op_sel_hi:[1,0,1]
    v_pk_fma_f32 v[222:223], v[222:223], v[246:247], v[246:247] op_sel:[0,0,1] op_sel_hi:[1,0,1]
    v_pk_fma_f32 v[224:225], v[224:225], v[246:247], v[246:247] op_sel:[0,0,1] op_sel_hi:[1,0,1]
    v_pk_fma_f32 v[226:227], v[226:227], v[246:247], v[246:247] op_sel:[0,0,1] op_sel_hi:[1,0,1]
    v_pk_fma_f32 v[228:229], v[228:229], v[246:247], v[246:247] op_sel:[0,0,1] op_sel_hi:[1,0,1]
    v_pk_fma_f32 v[230:231], v[230:231], v[246:247], v[246:247] op_sel:[0,0,1] op_sel_hi:[1,0,1]
    v_pk_fma_f32 v[232:233], v[232:233], v[246:247], v[246:247] op_sel:[0,0,1] op_sel_hi:[1,0,1]
    v_pk_fma_f32 v[234:235], v[234:235], v[246:247], v[246:247] op_sel:[0,0,1] op_sel_hi:[1,0,1]
    v_pk_fma_f32 v[236:237], v[236:237], v[246:247], v[246:247] op_sel:[0,0,1] op_sel_hi:[1,0,1]
    v_pk_fma_f32 v[238:239], v[238:239], v[246:247], v[246:247] op_sel:[0,0,1] op_sel_hi:[1,0,1]
    v_pk_fma_f32 v[96:97], v[76:77], v[76:77], s[50:51]
    v_pk_fma_f32 v[98:99], v[78:79], v[78:79], s[50:51]
    v_pk_fma_f32 v[100:101], v[80:81], v[80:81], s[50:51]
    v_pk_fma_f32 v[102:103], v[82:83], v[82:83], s[50:51]
    v_pk_mul_f32 v[96:97], v[96:97], v[76:77]
    v_pk_mul_f32 v[98:99], v[98:99], v[78:79]
    v_pk_mul_f32 v[100:101], v[100:101], v[80:81]
    v_pk_mul_f32 v[102:103], v[102:103], v[82:83]
    v_mfma_f32_16x16x32_bf16 v[60:63], a[48:51], v[144:147], 0
    s_waitcnt vmcnt(17)
    ds_read_b64_tr_b16 a[112:113], v28 offset:8192
    ds_read_b64_tr_b16 a[114:115], v28 offset:9216
    v_exp_f32 v96, v96
    v_mfma_f32_16x16x32_bf16 v[60:63], a[52:55], v[148:151], v[60:63]
    s_lshl_b32 s64, s3, 8
    ds_read_b64_tr_b16 a[136:137], v29 offset:8192
    ds_read_b64_tr_b16 a[138:139], v29 offset:9216
    buffer_load_dwordx4 v34, s[20:23], s53 offen offset:2048 lds
    v_rcp_f32 v88, v88
    v_mfma_f32_16x16x32_bf16 v[60:63], a[56:59], v[152:155], v[60:63]
    s_add_u32 s64, s64, s2
    ds_read_b64_tr_b16 a[160:161], v30 offset:8192
    ds_read_b64_tr_b16 a[162:163], v30 offset:9216
    v_exp_f32 v97, v97
    v_mfma_f32_16x16x32_bf16 v[60:63], a[60:63], v[156:159], v[60:63]
    s_mul_i32 s65, s64, 911
    ds_read_b64_tr_b16 a[184:185], v31 offset:8192
    ds_read_b64_tr_b16 a[186:187], v31 offset:9216
    buffer_load_dwordx4 v35, s[20:23], s53 offen offset:3072 lds
    v_rcp_f32 v89, v89
    v_mfma_f32_16x16x32_bf16 v[60:63], a[64:67], v[160:163], v[60:63]
    v_exp_f32 v98, v98
    v_mfma_f32_16x16x32_bf16 v[60:63], a[68:71], v[164:167], v[60:63]
    s_waitcnt lgkmcnt(15)
    s_add_u32 m0, s60, 28672
    s_add_u32 s53, s59, 256
    s_waitcnt vmcnt(15)
    ds_read_b64_tr_b16 a[116:117], v28 offset:12288
    ds_read_b64_tr_b16 a[118:119], v28 offset:13312
    v_cvt_pk_bf16_f32 v216, v216, v217
    v_cvt_pk_bf16_f32 v217, v218, v219
    v_rcp_f32 v90, v90
    v_mfma_f32_16x16x32_bf16 v[64:67], a[72:75], v[144:147], 0
    s_lshr_b32 s65, s65, 16
    ds_read_b128 v[144:147], v2 offset:36864
    ds_read_b64_tr_b16 a[140:141], v29 offset:12288
    ds_read_b64_tr_b16 a[142:143], v29 offset:13312
    buffer_load_dwordx4 v32, s[20:23], s53 offen offset:0 lds
    v_cvt_pk_bf16_f32 v218, v220, v221
    v_cvt_pk_bf16_f32 v219, v222, v223
    v_exp_f32 v99, v99
    v_mfma_f32_16x16x32_bf16 v[64:67], a[76:79], v[148:151], v[64:67]
    s_mul_i32 s61, s65, 72
    ds_read_b128 v[148:151], v2 offset:38912
    ds_read_b64_tr_b16 a[164:165], v30 offset:12288
    ds_read_b64_tr_b16 a[166:167], v30 offset:13312
    v_cvt_pk_bf16_f32 v220, v224, v225
    v_cvt_pk_bf16_f32 v221, v226, v227
    v_rcp_f32 v91, v91
    v_mfma_f32_16x16x32_bf16 v[64:67], a[80:83], v[152:155], v[64:67]
    s_sub_u32 s61, s64, s61
    ds_read_b128 v[152:155], v2 offset:40960
    ds_read_b64_tr_b16 a[188:189], v31 offset:12288
    ds_read_b64_tr_b16 a[190:191], v31 offset:13312
    buffer_load_dwordx4 v33, s[20:23], s53 offen offset:1024 lds
    v_cvt_pk_bf16_f32 v222, v228, v229
    v_cvt_pk_bf16_f32 v223, v230, v231
    v_exp_f32 v100, v100
    v_mfma_f32_16x16x32_bf16 v[64:67], a[84:87], v[156:159], v[64:67]
    s_mul_i32 s63, s61, 21846
    ds_read_b128 v[156:159], v3 offset:36864
    v_cvt_pk_bf16_f32 v224, v232, v233
    v_cvt_pk_bf16_f32 v225, v234, v235
    v_rcp_f32 v92, v92
    v_mfma_f32_16x16x32_bf16 v[64:67], a[88:91], v[160:163], v[64:67]
    s_lshr_b32 s63, s63, 16
    ds_read_b128 v[160:163], v3 offset:38912
    buffer_load_dwordx4 v34, s[20:23], s53 offen offset:2048 lds
    v_cvt_pk_bf16_f32 v226, v236, v237
    v_cvt_pk_bf16_f32 v227, v238, v239
    v_exp_f32 v101, v101
    v_mfma_f32_16x16x32_bf16 v[64:67], a[92:95], v[164:167], v[64:67]
    ds_read_b128 v[164:167], v3 offset:40960
    buffer_load_dwordx4 v35, s[20:23], s53 offen offset:3072 lds
    v_rcp_f32 v93, v93
    v_exp_f32 v102, v102
    v_rcp_f32 v94, v94
    v_exp_f32 v103, v103
    v_rcp_f32 v95, v95
    v_pk_mul_f32 v[104:105], v[68:69], v[88:89]
    v_pk_mul_f32 v[106:107], v[70:71], v[90:91]
    v_pk_mul_f32 v[108:109], v[72:73], v[92:93]
    v_pk_mul_f32 v[110:111], v[74:75], v[94:95]
    v_pk_add_f32 v[96:97], v[96:97], 1.0 op_sel_hi:[1,0]
    v_pk_add_f32 v[98:99], v[98:99], 1.0 op_sel_hi:[1,0]
    v_pk_add_f32 v[100:101], v[100:101], 1.0 op_sel_hi:[1,0]
    v_pk_add_f32 v[102:103], v[102:103], 1.0 op_sel_hi:[1,0]
    v_pk_mul_f32 v[20:21], v[104:105], v[104:105]
    v_pk_mul_f32 v[22:23], v[106:107], v[106:107]
    v_pk_mul_f32 v[24:25], v[108:109], v[108:109]
    v_pk_mul_f32 v[26:27], v[110:111], v[110:111]
    s_waitcnt lgkmcnt(3)
    s_waitcnt lgkmcnt(11)
    v_pk_fma_f32 v[88:89], v[60:61], v[60:61], s[50:51]
    v_pk_fma_f32 v[90:91], v[62:63], v[62:63], s[50:51]
    v_pk_fma_f32 v[92:93], v[64:65], v[64:65], s[50:51]
    v_pk_fma_f32 v[94:95], v[66:67], v[66:67], s[50:51]
    v_pk_mul_f32 v[88:89], v[88:89], v[60:61]
    v_pk_mul_f32 v[90:91], v[90:91], v[62:63]
    v_pk_mul_f32 v[92:93], v[92:93], v[64:65]
    v_pk_mul_f32 v[94:95], v[94:95], v[66:67]
    v_mfma_f32_16x16x32_bf16 v[68:71], a[96:99], v[144:147], 0
    s_waitcnt lgkmcnt(15)
    s_add_u32 m0, s60, 0
    s_add_u32 s53, s59, 98560
    s_waitcnt vmcnt(15)
    s_waitcnt lgkmcnt(8)
    ds_read_b64_tr_b16 a[192:193], v28 offset:16384
    ds_read_b64_tr_b16 a[194:195], v28 offset:17408
    v_cvt_pk_bf16_f32 v84, v104, v105
    v_exp_f32 v88, v88
    v_mfma_f32_16x16x32_bf16 v[68:71], a[100:103], v[148:151], v[68:71]
    s_waitcnt lgkmcnt(7)
    ds_read_b64_tr_b16 a[216:217], v29 offset:16384
    ds_read_b64_tr_b16 a[218:219], v29 offset:17408
    buffer_load_dwordx4 v32, s[20:23], s53 offen offset:0 lds
    v_cvt_pk_bf16_f32 v85, v106, v107
    v_rcp_f32 v96, v96
    v_mfma_f32_16x16x32_bf16 v[68:71], a[104:107], v[152:155], v[68:71]
    s_waitcnt lgkmcnt(6)
    ds_read_b64_tr_b16 a[240:241], v30 offset:16384
    ds_read_b64_tr_b16 a[242:243], v30 offset:17408
    v_cvt_pk_bf16_f32 v86, v108, v109
    v_exp_f32 v89, v89
    v_mfma_f32_16x16x32_bf16 v[68:71], a[108:111], v[156:159], v[68:71]
    s_waitcnt lgkmcnt(6)
    ds_read_b64_tr_b16 v[120:121], v31 offset:16384
    ds_read_b64_tr_b16 v[122:123], v31 offset:17408
    buffer_load_dwordx4 v33, s[20:23], s53 offen offset:1024 lds
    v_cvt_pk_bf16_f32 v87, v110, v111
    v_rcp_f32 v97, v97
    v_mfma_f32_16x16x32_bf16 v[68:71], a[112:115], v[160:163], v[68:71]
    s_add_u32 s52, s56, 0
    buffer_store_dwordx4 v[84:87], v1, s[12:15], s52 offen sc1
    v_exp_f32 v90, v90
    v_rcp_f32 v98, v98
    v_mfma_f32_16x16x32_bf16 v[68:71], a[116:119], v[164:167], v[68:71]
    s_waitcnt vmcnt(11)
    ds_write_b128 v6, v[216:219] offset:0
    ds_read_b64_tr_b16 a[196:197], v28 offset:20480
    ds_read_b64_tr_b16 a[198:199], v28 offset:21504
    v_exp_f32 v91, v91
    v_mfma_f32_16x16x32_bf16 v[72:75], a[120:123], v[144:147], 0
    s_lshl_b32 s65, s65, 5
    ds_read_b64_tr_b16 a[220:221], v29 offset:20480
    ds_read_b64_tr_b16 a[222:223], v29 offset:21504
    buffer_load_dwordx4 v34, s[20:23], s53 offen offset:2048 lds
    v_rcp_f32 v99, v99
    v_mfma_f32_16x16x32_bf16 v[72:75], a[124:127], v[148:151], v[72:75]
    s_mul_i32 s66, s63, 11904
    ds_write_b128 v6, v[220:223] offset:2048
    ds_read_b64_tr_b16 a[244:245], v30 offset:20480
    ds_read_b64_tr_b16 a[246:247], v30 offset:21504
    v_exp_f32 v92, v92
    v_mfma_f32_16x16x32_bf16 v[72:75], a[128:131], v[152:155], v[72:75]
    s_lshl_b32 s61, s61, 7
    ds_read_b64_tr_b16 v[124:125], v31 offset:20480
    ds_read_b64_tr_b16 v[126:127], v31 offset:21504
    buffer_load_dwordx4 v35, s[20:23], s53 offen offset:3072 lds
    v_rcp_f32 v100, v100
    v_mfma_f32_16x16x32_bf16 v[72:75], a[132:135], v[156:159], v[72:75]
    s_add_u32 s65, s65, s66
    s_waitcnt lgkmcnt(15)
    s_add_u32 m0, s60, 4096
    s_add_u32 s53, s59, 196864
    ds_write_b128 v6, v[224:227] offset:4096
    v_exp_f32 v93, v93
    v_mfma_f32_16x16x32_bf16 v[72:75], a[136:139], v[160:163], v[72:75]
    s_add_u32 s65, s65, s61
    buffer_load_dwordx4 v32, s[20:23], s53 offen offset:0 lds
    v_add_u32 v236, 6144, v10
    v_rcp_f32 v101, v101
    v_mfma_f32_16x16x32_bf16 v[72:75], a[140:143], v[164:167], v[72:75]
    s_cmp_lt_u32 s64, 288
    ds_write_b32 v9, v246 offset:128
    buffer_load_dwordx4 v33, s[20:23], s53 offen offset:1024 lds
    v_exp_f32 v94, v94
    v_rcp_f32 v102, v102
    v_exp_f32 v95, v95
    v_rcp_f32 v103, v103
    v_pk_mul_f32 v[104:105], v[76:77], v[96:97]
    v_pk_mul_f32 v[106:107], v[78:79], v[98:99]
    v_pk_mul_f32 v[108:109], v[80:81], v[100:101]
    v_pk_mul_f32 v[110:111], v[82:83], v[102:103]
    v_pk_add_f32 v[88:89], v[88:89], 1.0 op_sel_hi:[1,0]
    v_pk_add_f32 v[90:91], v[90:91], 1.0 op_sel_hi:[1,0]
    v_pk_add_f32 v[92:93], v[92:93], 1.0 op_sel_hi:[1,0]
    v_pk_add_f32 v[94:95], v[94:95], 1.0 op_sel_hi:[1,0]
    v_pk_fma_f32 v[12:13], v[104:105], v[104:105], v[12:13]
    v_pk_fma_f32 v[14:15], v[106:107], v[106:107], v[14:15]
    v_pk_fma_f32 v[16:17], v[108:109], v[108:109], v[16:17]
    v_pk_fma_f32 v[18:19], v[110:111], v[110:111], v[18:19]
    v_pk_fma_f32 v[96:97], v[68:69], v[68:69], s[50:51]
    v_pk_fma_f32 v[98:99], v[70:71], v[70:71], s[50:51]
    v_pk_fma_f32 v[100:101], v[72:73], v[72:73], s[50:51]
    v_pk_fma_f32 v[102:103], v[74:75], v[74:75], s[50:51]
    v_pk_mul_f32 v[96:97], v[96:97], v[68:69]
    v_pk_mul_f32 v[98:99], v[98:99], v[70:71]
    v_pk_mul_f32 v[100:101], v[100:101], v[72:73]
    v_pk_mul_f32 v[102:103], v[102:103], v[74:75]
    v_mfma_f32_16x16x32_bf16 v[76:79], a[144:147], v[144:147], 0
    s_waitcnt vmcnt(11)
    ds_read_b64_tr_b16 a[200:201], v28 offset:24576
    ds_read_b64_tr_b16 a[202:203], v28 offset:25600
    v_exp_f32 v96, v96
    v_mfma_f32_16x16x32_bf16 v[76:79], a[148:151], v[148:151], v[76:79]
    s_cselect_b32 s26, 294912, 0
    ds_read_b64_tr_b16 a[224:225], v29 offset:24576
    ds_read_b64_tr_b16 a[226:227], v29 offset:25600
    buffer_load_dwordx4 v34, s[20:23], s53 offen offset:2048 lds
    v_rcp_f32 v88, v88
    v_mfma_f32_16x16x32_bf16 v[76:79], a[152:155], v[152:155], v[76:79]
    ds_read_b64_tr_b16 a[248:249], v30 offset:24576
    ds_read_b64_tr_b16 a[250:251], v30 offset:25600
    buffer_load_ushort v228, v10, s[24:27], s65 offen offset:0
    v_exp_f32 v97, v97
    v_mfma_f32_16x16x32_bf16 v[76:79], a[156:159], v[156:159], v[76:79]
    ds_read_b64_tr_b16 v[128:129], v31 offset:24576
    ds_read_b64_tr_b16 v[130:131], v31 offset:25600
    buffer_load_dwordx4 v35, s[20:23], s53 offen offset:3072 lds
    buffer_load_ushort v229, v10, s[24:27], s65 offen offset:384
    v_rcp_f32 v89, v89
    v_mfma_f32_16x16x32_bf16 v[76:79], a[160:163], v[160:163], v[76:79]
    v_exp_f32 v98, v98
    v_mfma_f32_16x16x32_bf16 v[76:79], a[164:167], v[164:167], v[76:79]
    s_waitcnt vmcnt(11)
    ds_read_b64_tr_b16 a[204:205], v28 offset:28672
    ds_read_b64_tr_b16 a[206:207], v28 offset:29696
    buffer_load_ushort v230, v10, s[24:27], s65 offen offset:768
    v_rcp_f32 v90, v90
    v_mfma_f32_16x16x32_bf16 v[80:83], a[168:171], v[144:147], 0
    ds_read_b128 v[144:147], v2 offset:43008
    ds_read_b64_tr_b16 a[228:229], v29 offset:28672
    ds_read_b64_tr_b16 a[230:231], v29 offset:29696
    buffer_load_ushort v231, v10, s[24:27], s65 offen offset:1152
    v_exp_f32 v99, v99
    v_mfma_f32_16x16x32_bf16 v[80:83], a[172:175], v[148:151], v[80:83]
    ds_read_b128 v[148:151], v2 offset:45056
    ds_read_b64_tr_b16 a[252:253], v30 offset:28672
    ds_read_b64_tr_b16 a[254:255], v30 offset:29696
    v_rcp_f32 v91, v91
    v_mfma_f32_16x16x32_bf16 v[80:83], a[176:179], v[152:155], v[80:83]
    ds_read_b128 v[152:155], v2 offset:47104
    ds_read_b64_tr_b16 v[132:133], v31 offset:28672
    ds_read_b64_tr_b16 v[134:135], v31 offset:29696
    buffer_load_ushort v232, v236, s[24:27], s65 offen offset:0
    v_exp_f32 v100, v100
    v_mfma_f32_16x16x32_bf16 v[80:83], a[180:183], v[156:159], v[80:83]
    ds_read_b128 v[156:159], v3 offset:43008
    buffer_load_ushort v233, v236, s[24:27], s65 offen offset:384
    v_rcp_f32 v92, v92
    v_mfma_f32_16x16x32_bf16 v[80:83], a[184:187], v[160:163], v[80:83]
    ds_read_b128 v[160:163], v3 offset:45056
    buffer_load_ushort v234, v236, s[24:27], s65 offen offset:768
    v_exp_f32 v101, v101
    v_mfma_f32_16x16x32_bf16 v[80:83], a[188:191], v[164:167], v[80:83]
    ds_read_b128 v[164:167], v3 offset:47104
    buffer_load_ushort v235, v236, s[24:27], s65 offen offset:1152
    v_rcp_f32 v93, v93
    v_exp_f32 v102, v102
    v_rcp_f32 v94, v94
    v_exp_f32 v103, v103
    v_rcp_f32 v95, v95
    v_pk_mul_f32 v[104:105], v[60:61], v[88:89]
    v_pk_mul_f32 v[106:107], v[62:63], v[90:91]
    v_pk_mul_f32 v[108:109], v[64:65], v[92:93]
    v_pk_mul_f32 v[110:111], v[66:67], v[94:95]
    v_pk_add_f32 v[96:97], v[96:97], 1.0 op_sel_hi:[1,0]
    v_pk_add_f32 v[98:99], v[98:99], 1.0 op_sel_hi:[1,0]
    v_pk_add_f32 v[100:101], v[100:101], 1.0 op_sel_hi:[1,0]
    v_pk_add_f32 v[102:103], v[102:103], 1.0 op_sel_hi:[1,0]
    v_pk_fma_f32 v[20:21], v[104:105], v[104:105], v[20:21]
    v_pk_fma_f32 v[22:23], v[106:107], v[106:107], v[22:23]
    v_pk_fma_f32 v[24:25], v[108:109], v[108:109], v[24:25]
    v_pk_fma_f32 v[26:27], v[110:111], v[110:111], v[26:27]
    s_waitcnt lgkmcnt(11)
    v_pk_fma_f32 v[88:89], v[76:77], v[76:77], s[50:51]
    v_pk_fma_f32 v[90:91], v[78:79], v[78:79], s[50:51]
    v_pk_fma_f32 v[92:93], v[80:81], v[80:81], s[50:51]
    v_pk_fma_f32 v[94:95], v[82:83], v[82:83], s[50:51]
    v_pk_mul_f32 v[88:89], v[88:89], v[76:77]
    v_pk_mul_f32 v[90:91], v[90:91], v[78:79]
    v_pk_mul_f32 v[92:93], v[92:93], v[80:81]
    v_pk_mul_f32 v[94:95], v[94:95], v[82:83]
    v_mfma_f32_16x16x32_bf16 v[60:63], a[96:99], v[144:147], 0
    s_waitcnt vmcnt(12)
    s_waitcnt lgkmcnt(8)
    ds_read_b64_tr_b16 a[208:209], v28 offset:0
    ds_read_b64_tr_b16 a[210:211], v28 offset:1024
    v_exp_f32 v88, v88
    v_mfma_f32_16x16x32_bf16 v[60:63], a[100:103], v[148:151], v[60:63]
    s_waitcnt lgkmcnt(7)
    ds_read_b64_tr_b16 a[232:233], v29 offset:0
    ds_read_b64_tr_b16 a[234:235], v29 offset:1024
    v_rcp_f32 v96, v96
    v_mfma_f32_16x16x32_bf16 v[60:63], a[104:107], v[152:155], v[60:63]
    s_waitcnt lgkmcnt(6)
    ds_read_b64_tr_b16 v[112:113], v30 offset:0
    ds_read_b64_tr_b16 v[114:115], v30 offset:1024
    v_exp_f32 v89, v89
    v_mfma_f32_16x16x32_bf16 v[60:63], a[108:111], v[156:159], v[60:63]
    s_waitcnt lgkmcnt(6)
    ds_read_b64_tr_b16 v[136:137], v31 offset:0
    ds_read_b64_tr_b16 v[138:139], v31 offset:1024
    v_rcp_f32 v97, v97
    v_mfma_f32_16x16x32_bf16 v[60:63], a[112:115], v[160:163], v[60:63]
    v_exp_f32 v90, v90
    v_mfma_f32_16x16x32_bf16 v[60:63], a[116:119], v[164:167], v[60:63]
    s_waitcnt vmcnt(7)
    ds_read_b64_tr_b16 a[212:213], v28 offset:4096
    ds_read_b64_tr_b16 a[214:215], v28 offset:5120
    v_rcp_f32 v98, v98
    v_mfma_f32_16x16x32_bf16 v[64:67], a[120:123], v[144:147], 0
    ds_read_b128 v[144:147], v2 offset:36864
    ds_read_b64_tr_b16 a[236:237], v29 offset:4096
    ds_read_b64_tr_b16 a[238:239], v29 offset:5120
    v_exp_f32 v91, v91
    v_mfma_f32_16x16x32_bf16 v[64:67], a[124:127], v[148:151], v[64:67]
    ds_read_b128 v[148:151], v2 offset:38912
    ds_read_b64_tr_b16 v[116:117], v30 offset:4096
    ds_read_b64_tr_b16 v[118:119], v30 offset:5120
    v_rcp_f32 v99, v99
    v_mfma_f32_16x16x32_bf16 v[64:67], a[128:131], v[152:155], v[64:67]
    ds_read_b128 v[152:155], v2 offset:40960
    ds_read_b64_tr_b16 v[140:141], v31 offset:4096
    ds_read_b64_tr_b16 v[142:143], v31 offset:5120
    v_exp_f32 v92, v92
    v_mfma_f32_16x16x32_bf16 v[64:67], a[132:135], v[156:159], v[64:67]
    ds_read_b128 v[156:159], v3 offset:36864
    v_rcp_f32 v100, v100
    v_mfma_f32_16x16x32_bf16 v[64:67], a[136:139], v[160:163], v[64:67]
    ds_read_b128 v[160:163], v3 offset:38912
    v_exp_f32 v93, v93
    v_mfma_f32_16x16x32_bf16 v[64:67], a[140:143], v[164:167], v[64:67]
    ds_read_b128 v[164:167], v3 offset:40960
    v_rcp_f32 v101, v101
    v_exp_f32 v94, v94
    v_rcp_f32 v102, v102
    v_exp_f32 v95, v95
    v_rcp_f32 v103, v103
    v_pk_mul_f32 v[104:105], v[68:69], v[96:97]
    v_pk_mul_f32 v[106:107], v[70:71], v[98:99]
    v_pk_mul_f32 v[108:109], v[72:73], v[100:101]
    v_pk_mul_f32 v[110:111], v[74:75], v[102:103]
    v_pk_add_f32 v[88:89], v[88:89], 1.0 op_sel_hi:[1,0]
    v_pk_add_f32 v[90:91], v[90:91], 1.0 op_sel_hi:[1,0]
    v_pk_add_f32 v[92:93], v[92:93], 1.0 op_sel_hi:[1,0]
    v_pk_add_f32 v[94:95], v[94:95], 1.0 op_sel_hi:[1,0]
    v_pk_mul_f32 v[28:29], v[104:105], v[104:105]
    v_pk_mul_f32 v[30:31], v[106:107], v[106:107]
    v_pk_mul_f32 v[32:33], v[108:109], v[108:109]
    v_pk_mul_f32 v[34:35], v[110:111], v[110:111]
    s_waitcnt lgkmcnt(3)
    s_waitcnt lgkmcnt(11)
    v_pk_fma_f32 v[96:97], v[60:61], v[60:61], s[50:51]
    v_pk_fma_f32 v[98:99], v[62:63], v[62:63], s[50:51]
    v_pk_fma_f32 v[100:101], v[64:65], v[64:65], s[50:51]
    v_pk_fma_f32 v[102:103], v[66:67], v[66:67], s[50:51]
    v_pk_mul_f32 v[96:97], v[96:97], v[60:61]
    v_pk_mul_f32 v[98:99], v[98:99], v[62:63]
    v_pk_mul_f32 v[100:101], v[100:101], v[64:65]
    v_pk_mul_f32 v[102:103], v[102:103], v[66:67]
    v_mfma_f32_16x16x32_bf16 v[68:71], a[192:195], v[144:147], 0
    s_waitcnt lgkmcnt(8)
    v_cvt_pk_bf16_f32 v84, v104, v105
    v_exp_f32 v96, v96
    v_mfma_f32_16x16x32_bf16 v[68:71], a[196:199], v[148:151], v[68:71]
    s_waitcnt lgkmcnt(5)
    v_cvt_pk_bf16_f32 v85, v106, v107
    v_rcp_f32 v88, v88
    v_mfma_f32_16x16x32_bf16 v[68:71], a[200:203], v[152:155], v[68:71]
    s_waitcnt lgkmcnt(2)
    v_cvt_pk_bf16_f32 v86, v108, v109
    v_exp_f32 v97, v97
    v_mfma_f32_16x16x32_bf16 v[68:71], a[204:207], v[156:159], v[68:71]
    s_waitcnt lgkmcnt(0)
    v_cvt_pk_bf16_f32 v87, v110, v111
    v_rcp_f32 v89, v89
    v_mfma_f32_16x16x32_bf16 v[68:71], a[208:211], v[160:163], v[68:71]
    s_add_u32 s52, s56, 1024
    buffer_store_dwordx4 v[84:87], v1, s[12:15], s52 offen sc1
    v_exp_f32 v98, v98
    v_rcp_f32 v90, v90
    v_mfma_f32_16x16x32_bf16 v[68:71], a[212:215], v[164:167], v[68:71]
    v_exp_f32 v99, v99
    v_mfma_f32_16x16x32_bf16 v[72:75], a[216:219], v[144:147], 0
    v_rcp_f32 v91, v91
    v_mfma_f32_16x16x32_bf16 v[72:75], a[220:223], v[148:151], v[72:75]
    v_exp_f32 v100, v100
    v_mfma_f32_16x16x32_bf16 v[72:75], a[224:227], v[152:155], v[72:75]
    v_rcp_f32 v92, v92
    v_mfma_f32_16x16x32_bf16 v[72:75], a[228:231], v[156:159], v[72:75]
    v_exp_f32 v101, v101
    v_mfma_f32_16x16x32_bf16 v[72:75], a[232:235], v[160:163], v[72:75]
    v_rcp_f32 v93, v93
    v_mfma_f32_16x16x32_bf16 v[72:75], a[236:239], v[164:167], v[72:75]
    v_exp_f32 v102, v102
    v_rcp_f32 v94, v94
    v_exp_f32 v103, v103
    v_rcp_f32 v95, v95
    v_pk_mul_f32 v[104:105], v[76:77], v[88:89]
    v_pk_mul_f32 v[106:107], v[78:79], v[90:91]
    v_pk_mul_f32 v[108:109], v[80:81], v[92:93]
    v_pk_mul_f32 v[110:111], v[82:83], v[94:95]
    v_pk_add_f32 v[96:97], v[96:97], 1.0 op_sel_hi:[1,0]
    v_pk_add_f32 v[98:99], v[98:99], 1.0 op_sel_hi:[1,0]
    v_pk_add_f32 v[100:101], v[100:101], 1.0 op_sel_hi:[1,0]
    v_pk_add_f32 v[102:103], v[102:103], 1.0 op_sel_hi:[1,0]
    v_pk_mul_f32 v[36:37], v[104:105], v[104:105]
    v_pk_mul_f32 v[38:39], v[106:107], v[106:107]
    v_pk_mul_f32 v[40:41], v[108:109], v[108:109]
    v_pk_mul_f32 v[42:43], v[110:111], v[110:111]
    v_pk_fma_f32 v[88:89], v[68:69], v[68:69], s[50:51]
    v_pk_fma_f32 v[90:91], v[70:71], v[70:71], s[50:51]
    v_pk_fma_f32 v[92:93], v[72:73], v[72:73], s[50:51]
    v_pk_fma_f32 v[94:95], v[74:75], v[74:75], s[50:51]
    v_pk_mul_f32 v[88:89], v[88:89], v[68:69]
    v_pk_mul_f32 v[90:91], v[90:91], v[70:71]
    v_pk_mul_f32 v[92:93], v[92:93], v[72:73]
    v_pk_mul_f32 v[94:95], v[94:95], v[74:75]
    v_mfma_f32_16x16x32_bf16 v[76:79], a[240:243], v[144:147], 0
    s_lshl_b32 s61, s64, 10
    v_cvt_pk_bf16_f32 v84, v104, v105
    v_exp_f32 v88, v88
    v_mfma_f32_16x16x32_bf16 v[76:79], a[244:247], v[148:151], v[76:79]
    s_sub_u32 s63, s64, 512
    v_cvt_pk_bf16_f32 v85, v106, v107
    v_rcp_f32 v96, v96
    v_mfma_f32_16x16x32_bf16 v[76:79], a[248:251], v[152:155], v[76:79]
    s_cmp_lt_u32 s63, 48
    v_cvt_pk_bf16_f32 v86, v108, v109
    v_exp_f32 v89, v89
    v_mfma_f32_16x16x32_bf16 v[76:79], a[252:255], v[156:159], v[76:79]
    s_cselect_b32 s63, -131072, s67
    v_cvt_pk_bf16_f32 v87, v110, v111
    v_rcp_f32 v97, v97
    v_mfma_f32_16x16x32_bf16 v[76:79], v[112:115], v[160:163], v[76:79]
    s_add_u32 s52, s56, 2048
    buffer_store_dwordx4 v[84:87], v1, s[12:15], s52 offen sc1
    v_exp_f32 v90, v90
    v_rcp_f32 v98, v98
    v_mfma_f32_16x16x32_bf16 v[76:79], v[116:119], v[164:167], v[76:79]
    s_cmp_lt_u32 s64, 288
    v_exp_f32 v91, v91
    v_mfma_f32_16x16x32_bf16 v[80:83], v[120:123], v[144:147], 0
    s_cselect_b32 s63, 0, s63
    ds_read_b128 v[144:147], v2 offset:43008
    v_rcp_f32 v99, v99
    v_mfma_f32_16x16x32_bf16 v[80:83], v[124:127], v[148:151], v[80:83]
    s_add_u32 s61, s61, s63
    ds_read_b128 v[148:151], v2 offset:45056
    v_exp_f32 v92, v92
    v_mfma_f32_16x16x32_bf16 v[80:83], v[128:131], v[152:155], v[80:83]
    ds_read_b128 v[152:155], v2 offset:47104
    v_rcp_f32 v100, v100
    v_mfma_f32_16x16x32_bf16 v[80:83], v[132:135], v[156:159], v[80:83]
    ds_read_b128 v[156:159], v3 offset:43008
    v_exp_f32 v93, v93
    v_mfma_f32_16x16x32_bf16 v[80:83], v[136:139], v[160:163], v[80:83]
    ds_read_b128 v[160:163], v3 offset:45056
    v_rcp_f32 v101, v101
    v_mfma_f32_16x16x32_bf16 v[80:83], v[140:143], v[164:167], v[80:83]
    ds_read_b128 v[164:167], v3 offset:47104
    v_exp_f32 v94, v94
    v_rcp_f32 v102, v102
    v_exp_f32 v95, v95
    v_rcp_f32 v103, v103
    v_pk_mul_f32 v[104:105], v[60:61], v[96:97]
    v_pk_mul_f32 v[106:107], v[62:63], v[98:99]
    v_pk_mul_f32 v[108:109], v[64:65], v[100:101]
    v_pk_mul_f32 v[110:111], v[66:67], v[102:103]
    v_pk_add_f32 v[88:89], v[88:89], 1.0 op_sel_hi:[1,0]
    v_pk_add_f32 v[90:91], v[90:91], 1.0 op_sel_hi:[1,0]
    v_pk_add_f32 v[92:93], v[92:93], 1.0 op_sel_hi:[1,0]
    v_pk_add_f32 v[94:95], v[94:95], 1.0 op_sel_hi:[1,0]
    v_pk_fma_f32 v[28:29], v[104:105], v[104:105], v[28:29]
    v_pk_fma_f32 v[30:31], v[106:107], v[106:107], v[30:31]
    v_pk_fma_f32 v[32:33], v[108:109], v[108:109], v[32:33]
    v_pk_fma_f32 v[34:35], v[110:111], v[110:111], v[34:35]
    s_waitcnt lgkmcnt(5)
    v_pk_fma_f32 v[96:97], v[76:77], v[76:77], s[50:51]
    v_pk_fma_f32 v[98:99], v[78:79], v[78:79], s[50:51]
    v_pk_fma_f32 v[100:101], v[80:81], v[80:81], s[50:51]
    v_pk_fma_f32 v[102:103], v[82:83], v[82:83], s[50:51]
    v_pk_mul_f32 v[96:97], v[96:97], v[76:77]
    v_pk_mul_f32 v[98:99], v[98:99], v[78:79]
    v_pk_mul_f32 v[100:101], v[100:101], v[80:81]
    v_pk_mul_f32 v[102:103], v[102:103], v[82:83]
    v_mfma_f32_16x16x32_bf16 v[60:63], a[144:147], v[144:147], 0
    s_waitcnt lgkmcnt(4)
    v_cvt_pk_bf16_f32 v84, v104, v105
    v_exp_f32 v96, v96
    v_mfma_f32_16x16x32_bf16 v[60:63], a[148:151], v[148:151], v[60:63]
    s_waitcnt lgkmcnt(3)
    v_cvt_pk_bf16_f32 v85, v106, v107
    v_rcp_f32 v88, v88
    v_mfma_f32_16x16x32_bf16 v[60:63], a[152:155], v[152:155], v[60:63]
    s_waitcnt lgkmcnt(2)
    v_cvt_pk_bf16_f32 v86, v108, v109
    v_exp_f32 v97, v97
    v_mfma_f32_16x16x32_bf16 v[60:63], a[156:159], v[156:159], v[60:63]
    s_waitcnt lgkmcnt(0)
    v_cvt_pk_bf16_f32 v87, v110, v111
    v_rcp_f32 v89, v89
    v_mfma_f32_16x16x32_bf16 v[60:63], a[160:163], v[160:163], v[60:63]
    s_add_u32 s52, s57, 0
    buffer_store_dwordx4 v[84:87], v1, s[12:15], s52 offen sc1
    v_exp_f32 v98, v98
    v_rcp_f32 v90, v90
    v_mfma_f32_16x16x32_bf16 v[60:63], a[164:167], v[164:167], v[60:63]
    v_exp_f32 v99, v99
    v_mfma_f32_16x16x32_bf16 v[64:67], a[168:171], v[144:147], 0
    v_rcp_f32 v91, v91
    v_mfma_f32_16x16x32_bf16 v[64:67], a[172:175], v[148:151], v[64:67]
    v_exp_f32 v100, v100
    v_mfma_f32_16x16x32_bf16 v[64:67], a[176:179], v[152:155], v[64:67]
    v_rcp_f32 v92, v92
    v_mfma_f32_16x16x32_bf16 v[64:67], a[180:183], v[156:159], v[64:67]
    v_add_u32 v253, 1, v253
    v_exp_f32 v101, v101
    v_mfma_f32_16x16x32_bf16 v[64:67], a[184:187], v[160:163], v[64:67]
    v_rcp_f32 v93, v93
    v_mfma_f32_16x16x32_bf16 v[64:67], a[188:191], v[164:167], v[64:67]
    ds_write_b32 v252, v253 offset:51584
    v_exp_f32 v102, v102
    v_rcp_f32 v94, v94
    v_exp_f32 v103, v103
    v_rcp_f32 v95, v95
    v_pk_mul_f32 v[104:105], v[68:69], v[88:89]
    v_pk_mul_f32 v[106:107], v[70:71], v[90:91]
    v_pk_mul_f32 v[108:109], v[72:73], v[92:93]
    v_pk_mul_f32 v[110:111], v[74:75], v[94:95]
    v_pk_add_f32 v[96:97], v[96:97], 1.0 op_sel_hi:[1,0]
    v_pk_add_f32 v[98:99], v[98:99], 1.0 op_sel_hi:[1,0]
    v_pk_add_f32 v[100:101], v[100:101], 1.0 op_sel_hi:[1,0]
    v_pk_add_f32 v[102:103], v[102:103], 1.0 op_sel_hi:[1,0]
    v_pk_mul_f32 v[44:45], v[104:105], v[104:105]
    v_pk_mul_f32 v[46:47], v[106:107], v[106:107]
    v_pk_mul_f32 v[48:49], v[108:109], v[108:109]
    v_pk_mul_f32 v[50:51], v[110:111], v[110:111]
    v_pk_fma_f32 v[88:89], v[60:61], v[60:61], s[50:51]
    v_pk_fma_f32 v[90:91], v[62:63], v[62:63], s[50:51]
    v_pk_fma_f32 v[92:93], v[64:65], v[64:65], s[50:51]
    v_pk_fma_f32 v[94:95], v[66:67], v[66:67], s[50:51]
    v_pk_mul_f32 v[88:89], v[88:89], v[60:61]
    v_pk_mul_f32 v[90:91], v[90:91], v[62:63]
    v_pk_mul_f32 v[92:93], v[92:93], v[64:65]
    v_pk_mul_f32 v[94:95], v[94:95], v[66:67]
    v_mfma_f32_16x16x32_bf16 v[68:71], a[192:195], v[144:147], 0
    s_mov_b64 s[24:25], s[46:47]
    v_cvt_pk_bf16_f32 v84, v104, v105
    v_exp_f32 v88, v88
    v_mfma_f32_16x16x32_bf16 v[68:71], a[196:199], v[148:151], v[68:71]
    s_and_b32 s65, s2, 0xf9
    v_cvt_pk_bf16_f32 v85, v106, v107
    v_rcp_f32 v96, v96
    v_mfma_f32_16x16x32_bf16 v[68:71], a[200:203], v[152:155], v[68:71]
    s_cmp_eq_u32 s65, 96
    v_cvt_pk_bf16_f32 v86, v108, v109
    v_exp_f32 v89, v89
    v_mfma_f32_16x16x32_bf16 v[68:71], a[204:207], v[156:159], v[68:71]
    s_cselect_b32 s65, 0, s61
    v_cvt_pk_bf16_f32 v87, v110, v111
    v_rcp_f32 v97, v97
    v_mfma_f32_16x16x32_bf16 v[68:71], a[208:211], v[160:163], v[68:71]
    s_add_u32 s52, s56, 3072
    buffer_store_dwordx4 v[84:87], v1, s[12:15], s52 offen sc1
    v_exp_f32 v90, v90
    v_rcp_f32 v98, v98
    v_mfma_f32_16x16x32_bf16 v[68:71], a[212:215], v[164:167], v[68:71]
    s_cmp_lt_u32 s65, 720896
    v_exp_f32 v91, v91
    v_mfma_f32_16x16x32_bf16 v[72:75], a[216:219], v[144:147], 0
    s_cselect_b32 s76, 4, 0
    v_rcp_f32 v99, v99
    v_mfma_f32_16x16x32_bf16 v[72:75], a[220:223], v[148:151], v[72:75]
    s_waitcnt vmcnt(4)
    v_lshl_or_b32 v228, v229, 16, v228
    v_lshl_or_b32 v229, v231, 16, v230
    v_lshl_or_b32 v230, v233, 16, v232
    v_lshl_or_b32 v231, v235, 16, v234
    v_exp_f32 v92, v92
    v_mfma_f32_16x16x32_bf16 v[72:75], a[224:227], v[152:155], v[72:75]
    v_mov_b32 v251, 1
    v_rcp_f32 v100, v100
    v_mfma_f32_16x16x32_bf16 v[72:75], a[228:231], v[156:159], v[72:75]
    ds_read_b32 v248, v249 offset:51584
    v_exp_f32 v93, v93
    v_mfma_f32_16x16x32_bf16 v[72:75], a[232:235], v[160:163], v[72:75]
    buffer_store_dwordx4 v[228:231], v1, s[16:19], s61 offen sc1
    v_rcp_f32 v101, v101
    v_mfma_f32_16x16x32_bf16 v[72:75], a[236:239], v[164:167], v[72:75]
    v_exp_f32 v94, v94
    v_rcp_f32 v102, v102
    v_exp_f32 v95, v95
    v_rcp_f32 v103, v103
    v_pk_mul_f32 v[104:105], v[76:77], v[96:97]
    v_pk_mul_f32 v[106:107], v[78:79], v[98:99]
    v_pk_mul_f32 v[108:109], v[80:81], v[100:101]
    v_pk_mul_f32 v[110:111], v[82:83], v[102:103]
    v_pk_add_f32 v[88:89], v[88:89], 1.0 op_sel_hi:[1,0]
    v_pk_add_f32 v[90:91], v[90:91], 1.0 op_sel_hi:[1,0]
    v_pk_add_f32 v[92:93], v[92:93], 1.0 op_sel_hi:[1,0]
    v_pk_add_f32 v[94:95], v[94:95], 1.0 op_sel_hi:[1,0]
    v_pk_mul_f32 v[52:53], v[104:105], v[104:105]
    v_pk_mul_f32 v[54:55], v[106:107], v[106:107]
    v_pk_mul_f32 v[56:57], v[108:109], v[108:109]
    v_pk_mul_f32 v[58:59], v[110:111], v[110:111]
    v_pk_fma_f32 v[96:97], v[68:69], v[68:69], s[50:51]
    v_pk_fma_f32 v[98:99], v[70:71], v[70:71], s[50:51]
    v_pk_fma_f32 v[100:101], v[72:73], v[72:73], s[50:51]
    v_pk_fma_f32 v[102:103], v[74:75], v[74:75], s[50:51]
    v_pk_mul_f32 v[96:97], v[96:97], v[68:69]
    v_pk_mul_f32 v[98:99], v[98:99], v[70:71]
    v_pk_mul_f32 v[100:101], v[100:101], v[72:73]
    v_pk_mul_f32 v[102:103], v[102:103], v[74:75]
    v_mfma_f32_16x16x32_bf16 v[76:79], a[240:243], v[144:147], 0
    v_cvt_pk_bf16_f32 v84, v104, v105
    v_exp_f32 v96, v96
    v_mfma_f32_16x16x32_bf16 v[76:79], a[244:247], v[148:151], v[76:79]
    s_waitcnt lgkmcnt(0)
    v_cvt_pk_bf16_f32 v85, v106, v107
    v_cmp_lt_u32 vcc, v248, v253
    v_rcp_f32 v88, v88
    v_mfma_f32_16x16x32_bf16 v[76:79], a[248:251], v[152:155], v[76:79]
    v_cvt_pk_bf16_f32 v86, v108, v109
    v_exp_f32 v97, v97
    v_mfma_f32_16x16x32_bf16 v[76:79], a[252:255], v[156:159], v[76:79]
    s_cbranch_vccnz L_flagf
L_flagf_ret:
    v_cvt_pk_bf16_f32 v87, v110, v111
    v_rcp_f32 v89, v89
    v_mfma_f32_16x16x32_bf16 v[76:79], v[112:115], v[160:163], v[76:79]
    s_add_u32 s52, s56, 4096
    buffer_store_dwordx4 v[84:87], v1, s[12:15], s52 offen sc1
    v_exp_f32 v98, v98
    v_rcp_f32 v90, v90
    v_mfma_f32_16x16x32_bf16 v[76:79], v[116:119], v[164:167], v[76:79]
    s_add_u32 s56, s56, 36864
    v_exp_f32 v99, v99
    v_mfma_f32_16x16x32_bf16 v[80:83], v[120:123], v[144:147], 0
    ds_read_b128 v[144:147], v4 offset:0
    v_rcp_f32 v91, v91
    v_mfma_f32_16x16x32_bf16 v[80:83], v[124:127], v[148:151], v[80:83]
    ds_read_b128 v[148:151], v4 offset:2048
    v_exp_f32 v100, v100
    v_mfma_f32_16x16x32_bf16 v[80:83], v[128:131], v[152:155], v[80:83]
    ds_read_b128 v[152:155], v4 offset:4096
    v_rcp_f32 v92, v92
    v_mfma_f32_16x16x32_bf16 v[80:83], v[132:135], v[156:159], v[80:83]
    ds_read_b128 v[156:159], v5 offset:0
    v_exp_f32 v101, v101
    v_mfma_f32_16x16x32_bf16 v[80:83], v[136:139], v[160:163], v[80:83]
    ds_read_b128 v[160:163], v5 offset:2048
    v_rcp_f32 v93, v93
    v_mfma_f32_16x16x32_bf16 v[80:83], v[140:143], v[164:167], v[80:83]
    ds_read_b128 v[164:167], v5 offset:4096
    v_exp_f32 v102, v102
    v_rcp_f32 v94, v94
    v_exp_f32 v103, v103
    v_rcp_f32 v95, v95
    v_pk_mul_f32 v[104:105], v[60:61], v[88:89]
    v_pk_mul_f32 v[106:107], v[62:63], v[90:91]
    v_pk_mul_f32 v[108:109], v[64:65], v[92:93]
    v_pk_mul_f32 v[110:111], v[66:67], v[94:95]
    v_pk_add_f32 v[96:97], v[96:97], 1.0 op_sel_hi:[1,0]
    v_pk_add_f32 v[98:99], v[98:99], 1.0 op_sel_hi:[1,0]
    v_pk_add_f32 v[100:101], v[100:101], 1.0 op_sel_hi:[1,0]
    v_pk_add_f32 v[102:103], v[102:103], 1.0 op_sel_hi:[1,0]
    v_pk_fma_f32 v[36:37], v[104:105], v[104:105], v[36:37]
    v_pk_fma_f32 v[38:39], v[106:107], v[106:107], v[38:39]
    v_pk_fma_f32 v[40:41], v[108:109], v[108:109], v[40:41]
    v_pk_fma_f32 v[42:43], v[110:111], v[110:111], v[42:43]
    s_waitcnt lgkmcnt(5)
    v_pk_fma_f32 v[88:89], v[76:77], v[76:77], s[50:51]
    v_pk_fma_f32 v[90:91], v[78:79], v[78:79], s[50:51]
    v_pk_fma_f32 v[92:93], v[80:81], v[80:81], s[50:51]
    v_pk_fma_f32 v[94:95], v[82:83], v[82:83], s[50:51]
    v_pk_mul_f32 v[88:89], v[88:89], v[76:77]
    v_pk_mul_f32 v[90:91], v[90:91], v[78:79]
    v_pk_mul_f32 v[92:93], v[92:93], v[80:81]
    v_pk_mul_f32 v[94:95], v[94:95], v[82:83]
    s_mov_b32 s58, 0
    s_mov_b32 s59, s62
    s_mov_b32 s60, 0
    s_branch L_p1_b
.p2align 6
L_p1:
    v_mfma_f32_16x16x32_bf16 v[60:63], a[0:3], v[144:147], 0
    s_waitcnt lgkmcnt(4)
    v_cvt_pk_bf16_f32 v84, v104, v105
    v_exp_f32 v88, v88
    v_mfma_f32_16x16x32_bf16 v[60:63], a[4:7], v[148:151], v[60:63]
    s_waitcnt lgkmcnt(3)
    v_cvt_pk_bf16_f32 v85, v106, v107
    v_rcp_f32 v96, v96
    v_mfma_f32_16x16x32_bf16 v[60:63], a[8:11], v[152:155], v[60:63]
    s_waitcnt lgkmcnt(2)
    v_cvt_pk_bf16_f32 v86, v108, v109
    v_exp_f32 v89, v89
    v_mfma_f32_16x16x32_bf16 v[60:63], a[12:15], v[156:159], v[60:63]
    s_waitcnt lgkmcnt(0)
    v_cvt_pk_bf16_f32 v87, v110, v111
    v_rcp_f32 v97, v97
    v_mfma_f32_16x16x32_bf16 v[60:63], a[16:19], v[160:163], v[60:63]
    s_add_u32 s52, s57, 1024
    buffer_store_dwordx4 v[84:87], v1, s[12:15], s52 offen sc1
    v_exp_f32 v90, v90
    v_rcp_f32 v98, v98
    v_mfma_f32_16x16x32_bf16 v[60:63], a[20:23], v[164:167], v[60:63]
    v_exp_f32 v91, v91
    v_mfma_f32_16x16x32_bf16 v[64:67], a[24:27], v[144:147], 0
    v_rcp_f32 v99, v99
    v_mfma_f32_16x16x32_bf16 v[64:67], a[28:31], v[148:151], v[64:67]
    v_exp_f32 v92, v92
    v_mfma_f32_16x16x32_bf16 v[64:67], a[32:35], v[152:155], v[64:67]
    v_rcp_f32 v100, v100
    v_mfma_f32_16x16x32_bf16 v[64:67], a[36:39], v[156:159], v[64:67]
    v_exp_f32 v93, v93
    v_mfma_f32_16x16x32_bf16 v[64:67], a[40:43], v[160:163], v[64:67]
    v_rcp_f32 v101, v101
    v_mfma_f32_16x16x32_bf16 v[64:67], a[44:47], v[164:167], v[64:67]
    s_waitcnt vmcnt(31)
    v_exp_f32 v94, v94
    v_rcp_f32 v102, v102
    v_exp_f32 v95, v95
    v_rcp_f32 v103, v103
    v_pk_mul_f32 v[104:105], v[68:69], v[96:97]
    v_pk_mul_f32 v[106:107], v[70:71], v[98:99]
    v_pk_mul_f32 v[108:109], v[72:73], v[100:101]
    v_pk_mul_f32 v[110:111], v[74:75], v[102:103]
    v_pk_add_f32 v[88:89], v[88:89], 1.0 op_sel_hi:[1,0]
    v_pk_add_f32 v[90:91], v[90:91], 1.0 op_sel_hi:[1,0]
    v_pk_add_f32 v[92:93], v[92:93], 1.0 op_sel_hi:[1,0]
    v_pk_add_f32 v[94:95], v[94:95], 1.0 op_sel_hi:[1,0]
    v_pk_fma_f32 v[44:45], v[104:105], v[104:105], v[44:45]
    v_pk_fma_f32 v[46:47], v[106:107], v[106:107], v[46:47]
    v_pk_fma_f32 v[48:49], v[108:109], v[108:109], v[48:49]
    v_pk_fma_f32 v[50:51], v[110:111], v[110:111], v[50:51]
    v_dot2_f32_bf16 v216, v204, v168, 0
    v_dot2_f32_bf16 v217, v204, v169, 0
    v_dot2_f32_bf16 v218, v205, v170, 0
    v_dot2_f32_bf16 v219, v205, v171, 0
    v_dot2_f32_bf16 v220, v206, v172, 0
    v_dot2_f32_bf16 v221, v206, v173, 0
    v_dot2_f32_bf16 v222, v207, v174, 0
    v_dot2_f32_bf16 v223, v207, v175, 0
    v_dot2_f32_bf16 v224, v208, v176, 0
    v_dot2_f32_bf16 v225, v208, v177, 0
    v_dot2_f32_bf16 v226, v209, v178, 0
    v_dot2_f32_bf16 v227, v209, v179, 0
    v_dot2_f32_bf16 v228, v210, v180, 0
    v_dot2_f32_bf16 v229, v210, v181, 0
    v_dot2_f32_bf16 v230, v211, v182, 0
    v_dot2_f32_bf16 v231, v211, v183, 0
    v_dot2_f32_bf16 v232, v212, v184, 0
    v_dot2_f32_bf16 v233, v212, v185, 0
    v_dot2_f32_bf16 v234, v213, v186, 0
    v_dot2_f32_bf16 v235, v213, v187, 0
    v_dot2_f32_bf16 v236, v214, v188, 0
    v_dot2_f32_bf16 v237, v214, v189, 0
    v_dot2_f32_bf16 v238, v215, v190, 0
    v_dot2_f32_bf16 v239, v215, v191, 0
    v_pk_fma_f32 v[96:97], v[60:61], v[60:61], s[50:51]
    v_pk_fma_f32 v[98:99], v[62:63], v[62:63], s[50:51]
    v_pk_fma_f32 v[100:101], v[64:65], v[64:65], s[50:51]
    v_pk_fma_f32 v[102:103], v[66:67], v[66:67], s[50:51]
    v_pk_mul_f32 v[96:97], v[96:97], v[60:61]
    v_pk_mul_f32 v[98:99], v[98:99], v[62:63]
    v_pk_mul_f32 v[100:101], v[100:101], v[64:65]
    v_pk_mul_f32 v[102:103], v[102:103], v[66:67]
    v_mfma_f32_16x16x32_bf16 v[68:71], a[48:51], v[144:147], 0
    v_cvt_pk_bf16_f32 v84, v104, v105
    v_exp_f32 v96, v96
    v_mfma_f32_16x16x32_bf16 v[68:71], a[52:55], v[148:151], v[68:71]
    v_cvt_pk_bf16_f32 v85, v106, v107
    v_rcp_f32 v88, v88
    v_mfma_f32_16x16x32_bf16 v[68:71], a[56:59], v[152:155], v[68:71]
    v_cvt_pk_bf16_f32 v86, v108, v109
    v_exp_f32 v97, v97
    v_mfma_f32_16x16x32_bf16 v[68:71], a[60:63], v[156:159], v[68:71]
    v_cvt_pk_bf16_f32 v87, v110, v111
    v_rcp_f32 v89, v89
    v_mfma_f32_16x16x32_bf16 v[68:71], a[64:67], v[160:163], v[68:71]
    s_add_u32 s52, s57, 2048
    buffer_store_dwordx4 v[84:87], v1, s[12:15], s52 offen sc1
    v_exp_f32 v98, v98
    v_rcp_f32 v90, v90
    v_mfma_f32_16x16x32_bf16 v[68:71], a[68:71], v[164:167], v[68:71]
    v_exp_f32 v99, v99
    v_mfma_f32_16x16x32_bf16 v[72:75], a[72:75], v[144:147], 0
    buffer_load_dwordx4 v[204:207], v0, s[4:7], s55 offen offset:0
    v_rcp_f32 v91, v91
    v_mfma_f32_16x16x32_bf16 v[72:75], a[76:79], v[148:151], v[72:75]
    v_exp_f32 v100, v100
    v_mfma_f32_16x16x32_bf16 v[72:75], a[80:83], v[152:155], v[72:75]
    buffer_load_dwordx4 v[208:211], v0, s[4:7], s55 offen offset:128
    v_rcp_f32 v92, v92
    v_mfma_f32_16x16x32_bf16 v[72:75], a[84:87], v[156:159], v[72:75]
    v_exp_f32 v101, v101
    v_mfma_f32_16x16x32_bf16 v[72:75], a[88:91], v[160:163], v[72:75]
    buffer_load_dwordx4 v[212:215], v0, s[4:7], s55 offen offset:256
    v_rcp_f32 v93, v93
    v_mfma_f32_16x16x32_bf16 v[72:75], a[92:95], v[164:167], v[72:75]
    s_add_u32 s55, s55, 12288
    v_exp_f32 v102, v102
    v_rcp_f32 v94, v94
    v_exp_f32 v103, v103
    v_rcp_f32 v95, v95
    v_pk_mul_f32 v[104:105], v[76:77], v[88:89]
    v_pk_mul_f32 v[106:107], v[78:79], v[90:91]
    v_pk_mul_f32 v[108:109], v[80:81], v[92:93]
    v_pk_mul_f32 v[110:111], v[82:83], v[94:95]
    v_pk_add_f32 v[96:97], v[96:97], 1.0 op_sel_hi:[1,0]
    v_pk_add_f32 v[98:99], v[98:99], 1.0 op_sel_hi:[1,0]
    v_pk_add_f32 v[100:101], v[100:101], 1.0 op_sel_hi:[1,0]
    v_pk_add_f32 v[102:103], v[102:103], 1.0 op_sel_hi:[1,0]
    v_pk_fma_f32 v[52:53], v[104:105], v[104:105], v[52:53]
    v_pk_fma_f32 v[54:55], v[106:107], v[106:107], v[54:55]
    v_pk_fma_f32 v[56:57], v[108:109], v[108:109], v[56:57]
    v_pk_fma_f32 v[58:59], v[110:111], v[110:111], v[58:59]
    v_pk_mul_f32 v[242:243], v[216:217], v[216:217]
    v_pk_add_f32 v[240:241], v[216:217], v[218:219]
    v_pk_fma_f32 v[242:243], v[218:219], v[218:219], v[242:243]
    v_pk_fma_f32 v[242:243], v[220:221], v[220:221], v[242:243]
    v_pk_add_f32 v[240:241], v[240:241], v[220:221]
    v_pk_fma_f32 v[242:243], v[222:223], v[222:223], v[242:243]
    v_pk_add_f32 v[240:241], v[240:241], v[222:223]
    v_pk_fma_f32 v[242:243], v[224:225], v[224:225], v[242:243]
    v_pk_add_f32 v[240:241], v[240:241], v[224:225]
    v_pk_fma_f32 v[242:243], v[226:227], v[226:227], v[242:243]
    v_pk_add_f32 v[240:241], v[240:241], v[226:227]
    v_pk_fma_f32 v[242:243], v[228:229], v[228:229], v[242:243]
    v_pk_add_f32 v[240:241], v[240:241], v[228:229]
    v_pk_fma_f32 v[242:243], v[230:231], v[230:231], v[242:243]
    v_pk_add_f32 v[240:241], v[240:241], v[230:231]
    v_pk_fma_f32 v[242:243], v[232:233], v[232:233], v[242:243]
    v_pk_add_f32 v[240:241], v[240:241], v[232:233]
    v_pk_fma_f32 v[242:243], v[234:235], v[234:235], v[242:243]
    v_pk_add_f32 v[240:241], v[240:241], v[234:235]
    v_pk_fma_f32 v[242:243], v[236:237], v[236:237], v[242:243]
    v_pk_add_f32 v[240:241], v[240:241], v[236:237]
    v_pk_fma_f32 v[242:243], v[238:239], v[238:239], v[242:243]
    v_pk_add_f32 v[240:241], v[240:241], v[238:239]
    v_pk_fma_f32 v[88:89], v[68:69], v[68:69], s[50:51]
    v_pk_fma_f32 v[90:91], v[70:71], v[70:71], s[50:51]
    v_pk_fma_f32 v[92:93], v[72:73], v[72:73], s[50:51]
    v_pk_fma_f32 v[94:95], v[74:75], v[74:75], s[50:51]
    v_pk_mul_f32 v[88:89], v[88:89], v[68:69]
    v_pk_mul_f32 v[90:91], v[90:91], v[70:71]
    v_pk_mul_f32 v[92:93], v[92:93], v[72:73]
    v_pk_mul_f32 v[94:95], v[94:95], v[74:75]
    v_mfma_f32_16x16x32_bf16 v[76:79], a[96:99], v[144:147], 0
    v_cvt_pk_bf16_f32 v84, v104, v105
    v_exp_f32 v88, v88
    v_mfma_f32_16x16x32_bf16 v[76:79], a[100:103], v[148:151], v[76:79]
    v_cvt_pk_bf16_f32 v85, v106, v107
    v_rcp_f32 v96, v96
    v_mfma_f32_16x16x32_bf16 v[76:79], a[104:107], v[152:155], v[76:79]
    v_cvt_pk_bf16_f32 v86, v108, v109
    v_exp_f32 v89, v89
    v_mfma_f32_16x16x32_bf16 v[76:79], a[108:111], v[156:159], v[76:79]
    v_cvt_pk_bf16_f32 v87, v110, v111
    v_rcp_f32 v97, v97
    v_mfma_f32_16x16x32_bf16 v[76:79], a[112:115], v[160:163], v[76:79]
    s_add_u32 s52, s57, 3072
    buffer_store_dwordx4 v[84:87], v1, s[12:15], s52 offen sc1
    v_add_f32 v240, v240, v241
    v_add_f32 v242, v242, v243
    v_exp_f32 v90, v90
    v_rcp_f32 v98, v98
    v_mfma_f32_16x16x32_bf16 v[76:79], a[116:119], v[164:167], v[76:79]
    v_add_f32_dpp v240, v240, v240 quad_perm:[1,0,3,2] row_mask:0xf bank_mask:0xf
    v_add_f32_dpp v242, v242, v242 quad_perm:[1,0,3,2] row_mask:0xf bank_mask:0xf
    v_exp_f32 v91, v91
    v_mfma_f32_16x16x32_bf16 v[80:83], a[120:123], v[144:147], 0
    s_add_u32 s57, s57, 36864
    v_add_f32_dpp v240, v240, v240 quad_perm:[2,3,0,1] row_mask:0xf bank_mask:0xf
    v_add_f32_dpp v242, v242, v242 quad_perm:[2,3,0,1] row_mask:0xf bank_mask:0xf
    v_rcp_f32 v99, v99
    v_mfma_f32_16x16x32_bf16 v[80:83], a[124:127], v[148:151], v[80:83]
    v_add_f32_dpp v240, v240, v240 row_half_mirror row_mask:0xf bank_mask:0xf
    v_add_f32_dpp v242, v242, v242 row_half_mirror row_mask:0xf bank_mask:0xf
    v_exp_f32 v92, v92
    v_mfma_f32_16x16x32_bf16 v[80:83], a[128:131], v[152:155], v[80:83]
    v_mul_f32 v244, 0x3baaaaab, v240
    v_fma_f32 v240, -v244, v244, v245
    v_rcp_f32 v100, v100
    v_mfma_f32_16x16x32_bf16 v[80:83], a[132:135], v[156:159], v[80:83]
    v_fmamk_f32 v242, v242, 0x3baaaaab, v240
    v_max_f32 v242, v242, v245
    v_rsq_f32 v242, v242
    v_exp_f32 v93, v93
    v_mfma_f32_16x16x32_bf16 v[80:83], a[136:139], v[160:163], v[80:83]
    v_mul_f32 v246, 0xbeeff558, v242
    v_mul_f32_e64 v247, -v244, v246
    v_rcp_f32 v101, v101
    v_mfma_f32_16x16x32_bf16 v[80:83], a[140:143], v[164:167], v[80:83]
    v_exp_f32 v94, v94
    v_rcp_f32 v102, v102
    v_exp_f32 v95, v95
    v_rcp_f32 v103, v103
    v_pk_mul_f32 v[104:105], v[60:61], v[96:97]
    v_pk_mul_f32 v[106:107], v[62:63], v[98:99]
    v_pk_mul_f32 v[108:109], v[64:65], v[100:101]
    v_pk_mul_f32 v[110:111], v[66:67], v[102:103]
    v_pk_add_f32 v[88:89], v[88:89], 1.0 op_sel_hi:[1,0]
    v_pk_add_f32 v[90:91], v[90:91], 1.0 op_sel_hi:[1,0]
    v_pk_add_f32 v[92:93], v[92:93], 1.0 op_sel_hi:[1,0]
    v_pk_add_f32 v[94:95], v[94:95], 1.0 op_sel_hi:[1,0]
    v_pk_fma_f32 v[12:13], v[104:105], v[104:105], v[12:13]
    v_pk_fma_f32 v[14:15], v[106:107], v[106:107], v[14:15]
    v_pk_fma_f32 v[16:17], v[108:109], v[108:109], v[16:17]
    v_pk_fma_f32 v[18:19], v[110:111], v[110:111], v[18:19]
    v_pk_fma_f32 v[216:217], v[216:217], v[246:247], v[246:247] op_sel:[0,0,1] op_sel_hi:[1,0,1]
    v_pk_fma_f32 v[218:219], v[218:219], v[246:247], v[246:247] op_sel:[0,0,1] op_sel_hi:[1,0,1]
    v_pk_fma_f32 v[220:221], v[220:221], v[246:247], v[246:247] op_sel:[0,0,1] op_sel_hi:[1,0,1]
    v_pk_fma_f32 v[222:223], v[222:223], v[246:247], v[246:247] op_sel:[0,0,1] op_sel_hi:[1,0,1]
    v_pk_fma_f32 v[224:225], v[224:225], v[246:247], v[246:247] op_sel:[0,0,1] op_sel_hi:[1,0,1]
    v_pk_fma_f32 v[226:227], v[226:227], v[246:247], v[246:247] op_sel:[0,0,1] op_sel_hi:[1,0,1]
    v_pk_fma_f32 v[228:229], v[228:229], v[246:247], v[246:247] op_sel:[0,0,1] op_sel_hi:[1,0,1]
    v_pk_fma_f32 v[230:231], v[230:231], v[246:247], v[246:247] op_sel:[0,0,1] op_sel_hi:[1,0,1]
    v_pk_fma_f32 v[232:233], v[232:233], v[246:247], v[246:247] op_sel:[0,0,1] op_sel_hi:[1,0,1]
    v_pk_fma_f32 v[234:235], v[234:235], v[246:247], v[246:247] op_sel:[0,0,1] op_sel_hi:[1,0,1]
    v_pk_fma_f32 v[236:237], v[236:237], v[246:247], v[246:247] op_sel:[0,0,1] op_sel_hi:[1,0,1]
    v_pk_fma_f32 v[238:239], v[238:239], v[246:247], v[246:247] op_sel:[0,0,1] op_sel_hi:[1,0,1]
    v_pk_fma_f32 v[96:97], v[76:77], v[76:77], s[50:51]
    v_pk_fma_f32 v[98:99], v[78:79], v[78:79], s[50:51]
    v_pk_fma_f32 v[100:101], v[80:81], v[80:81], s[50:51]
    v_pk_fma_f32 v[102:103], v[82:83], v[82:83], s[50:51]
    v_pk_mul_f32 v[96:97], v[96:97], v[76:77]
    v_pk_mul_f32 v[98:99], v[98:99], v[78:79]
    v_pk_mul_f32 v[100:101], v[100:101], v[80:81]
    v_pk_mul_f32 v[102:103], v[102:103], v[82:83]
    v_mfma_f32_16x16x32_bf16 v[60:63], a[144:147], v[144:147], 0
    s_mov_b32 m0, s59
    v_exp_f32 v96, v96
    v_mfma_f32_16x16x32_bf16 v[60:63], a[148:151], v[148:151], v[60:63]
    buffer_load_dwordx4 v0, s[4:7], s58 offen  lds
    v_rcp_f32 v88, v88
    v_mfma_f32_16x16x32_bf16 v[60:63], a[152:155], v[152:155], v[60:63]
    v_exp_f32 v97, v97
    v_mfma_f32_16x16x32_bf16 v[60:63], a[156:159], v[156:159], v[60:63]
    s_add_u32 s60, s60, 1
    v_rcp_f32 v89, v89
    v_mfma_f32_16x16x32_bf16 v[60:63], a[160:163], v[160:163], v[60:63]
    v_exp_f32 v98, v98
    v_mfma_f32_16x16x32_bf16 v[60:63], a[164:167], v[164:167], v[60:63]
    s_cmp_eq_u32 s60, 3
    v_cvt_pk_bf16_f32 v216, v216, v217
    v_cvt_pk_bf16_f32 v217, v218, v219
    v_rcp_f32 v90, v90
    v_mfma_f32_16x16x32_bf16 v[64:67], a[168:171], v[144:147], 0
    s_cselect_b32 s64, 0x2f00, s79
    v_cvt_pk_bf16_f32 v218, v220, v221
    v_cvt_pk_bf16_f32 v219, v222, v223
    v_exp_f32 v99, v99
    v_mfma_f32_16x16x32_bf16 v[64:67], a[172:175], v[148:151], v[64:67]
    s_cselect_b32 s65, 0x2000, s78
    v_cvt_pk_bf16_f32 v220, v224, v225
    v_cvt_pk_bf16_f32 v221, v226, v227
    v_rcp_f32 v91, v91
    v_mfma_f32_16x16x32_bf16 v[64:67], a[176:179], v[152:155], v[64:67]
    s_cselect_b32 s60, 0, s60
    v_cvt_pk_bf16_f32 v222, v228, v229
    v_cvt_pk_bf16_f32 v223, v230, v231
    v_exp_f32 v100, v100
    v_mfma_f32_16x16x32_bf16 v[64:67], a[180:183], v[156:159], v[64:67]
    s_add_u32 s59, s59, s65
    v_cvt_pk_bf16_f32 v224, v232, v233
    v_cvt_pk_bf16_f32 v225, v234, v235
    v_rcp_f32 v92, v92
    v_mfma_f32_16x16x32_bf16 v[64:67], a[184:187], v[160:163], v[64:67]
    s_add_u32 s58, s58, s64
    v_cvt_pk_bf16_f32 v226, v236, v237
    v_cvt_pk_bf16_f32 v227, v238, v239
    v_exp_f32 v101, v101
    v_mfma_f32_16x16x32_bf16 v[64:67], a[188:191], v[164:167], v[64:67]
    s_cmp_ge_u32 s58, 36864
    v_rcp_f32 v93, v93
    v_exp_f32 v102, v102
    v_rcp_f32 v94, v94
    v_exp_f32 v103, v103
    v_rcp_f32 v95, v95
    v_pk_mul_f32 v[104:105], v[68:69], v[88:89]
    v_pk_mul_f32 v[106:107], v[70:71], v[90:91]
    v_pk_mul_f32 v[108:109], v[72:73], v[92:93]
    v_pk_mul_f32 v[110:111], v[74:75], v[94:95]
    v_pk_add_f32 v[96:97], v[96:97], 1.0 op_sel_hi:[1,0]
    v_pk_add_f32 v[98:99], v[98:99], 1.0 op_sel_hi:[1,0]
    v_pk_add_f32 v[100:101], v[100:101], 1.0 op_sel_hi:[1,0]
    v_pk_add_f32 v[102:103], v[102:103], 1.0 op_sel_hi:[1,0]
    v_pk_fma_f32 v[20:21], v[104:105], v[104:105], v[20:21]
    v_pk_fma_f32 v[22:23], v[106:107], v[106:107], v[22:23]
    v_pk_fma_f32 v[24:25], v[108:109], v[108:109], v[24:25]
    v_pk_fma_f32 v[26:27], v[110:111], v[110:111], v[26:27]
    v_pk_fma_f32 v[88:89], v[60:61], v[60:61], s[50:51]
    v_pk_fma_f32 v[90:91], v[62:63], v[62:63], s[50:51]
    v_pk_fma_f32 v[92:93], v[64:65], v[64:65], s[50:51]
    v_pk_fma_f32 v[94:95], v[66:67], v[66:67], s[50:51]
    v_pk_mul_f32 v[88:89], v[88:89], v[60:61]
    v_pk_mul_f32 v[90:91], v[90:91], v[62:63]
    v_pk_mul_f32 v[92:93], v[92:93], v[64:65]
    v_pk_mul_f32 v[94:95], v[94:95], v[66:67]
    v_mfma_f32_16x16x32_bf16 v[68:71], a[192:195], v[144:147], 0
    ds_write_b128 v6, v[216:219] offset:0
    v_cvt_pk_bf16_f32 v84, v104, v105
    v_exp_f32 v88, v88
    v_mfma_f32_16x16x32_bf16 v[68:71], a[196:199], v[148:151], v[68:71]
    s_cselect_b32 s58, 0x40000000, s58
    v_cvt_pk_bf16_f32 v85, v106, v107
    v_rcp_f32 v96, v96
    v_mfma_f32_16x16x32_bf16 v[68:71], a[200:203], v[152:155], v[68:71]
    ds_write_b128 v6, v[220:223] offset:2048
    v_cvt_pk_bf16_f32 v86, v108, v109
    v_exp_f32 v89, v89
    v_mfma_f32_16x16x32_bf16 v[68:71], a[204:207], v[156:159], v[68:71]
    s_cselect_b32 s59, 51712, s59
    v_cvt_pk_bf16_f32 v87, v110, v111
    v_rcp_f32 v97, v97
    v_mfma_f32_16x16x32_bf16 v[68:71], a[208:211], v[160:163], v[68:71]
    s_add_u32 s52, s56, 0
    buffer_store_dwordx4 v[84:87], v1, s[12:15], s52 offen sc1
    v_exp_f32 v90, v90
    v_rcp_f32 v98, v98
    v_mfma_f32_16x16x32_bf16 v[68:71], a[212:215], v[164:167], v[68:71]
    v_exp_f32 v91, v91
    v_mfma_f32_16x16x32_bf16 v[72:75], a[216:219], v[144:147], 0
    ds_write_b128 v6, v[224:227] offset:4096
    v_rcp_f32 v99, v99
    v_mfma_f32_16x16x32_bf16 v[72:75], a[220:223], v[148:151], v[72:75]
    v_exp_f32 v92, v92
    v_mfma_f32_16x16x32_bf16 v[72:75], a[224:227], v[152:155], v[72:75]
    ds_write_b32 v9, v246 offset:128
    v_rcp_f32 v100, v100
    v_mfma_f32_16x16x32_bf16 v[72:75], a[228:231], v[156:159], v[72:75]
    v_exp_f32 v93, v93
    v_mfma_f32_16x16x32_bf16 v[72:75], a[232:235], v[160:163], v[72:75]
    v_rcp_f32 v101, v101
    v_mfma_f32_16x16x32_bf16 v[72:75], a[236:239], v[164:167], v[72:75]
    v_exp_f32 v94, v94
    v_rcp_f32 v102, v102
    v_exp_f32 v95, v95
    v_rcp_f32 v103, v103
    v_pk_mul_f32 v[104:105], v[76:77], v[96:97]
    v_pk_mul_f32 v[106:107], v[78:79], v[98:99]
    v_pk_mul_f32 v[108:109], v[80:81], v[100:101]
    v_pk_mul_f32 v[110:111], v[82:83], v[102:103]
    v_pk_add_f32 v[88:89], v[88:89], 1.0 op_sel_hi:[1,0]
    v_pk_add_f32 v[90:91], v[90:91], 1.0 op_sel_hi:[1,0]
    v_pk_add_f32 v[92:93], v[92:93], 1.0 op_sel_hi:[1,0]
    v_pk_add_f32 v[94:95], v[94:95], 1.0 op_sel_hi:[1,0]
    v_pk_fma_f32 v[28:29], v[104:105], v[104:105], v[28:29]
    v_pk_fma_f32 v[30:31], v[106:107], v[106:107], v[30:31]
    v_pk_fma_f32 v[32:33], v[108:109], v[108:109], v[32:33]
    v_pk_fma_f32 v[34:35], v[110:111], v[110:111], v[34:35]
    v_pk_fma_f32 v[96:97], v[68:69], v[68:69], s[50:51]
    v_pk_fma_f32 v[98:99], v[70:71], v[70:71], s[50:51]
    v_pk_fma_f32 v[100:101], v[72:73], v[72:73], s[50:51]
    v_pk_fma_f32 v[102:103], v[74:75], v[74:75], s[50:51]
    v_pk_mul_f32 v[96:97], v[96:97], v[68:69]
    v_pk_mul_f32 v[98:99], v[98:99], v[70:71]
    v_pk_mul_f32 v[100:101], v[100:101], v[72:73]
    v_pk_mul_f32 v[102:103], v[102:103], v[74:75]
    v_mfma_f32_16x16x32_bf16 v[76:79], a[240:243], v[144:147], 0
    v_cvt_pk_bf16_f32 v84, v104, v105
    v_exp_f32 v96, v96
    v_mfma_f32_16x16x32_bf16 v[76:79], a[244:247], v[148:151], v[76:79]
    v_cvt_pk_bf16_f32 v85, v106, v107
    v_rcp_f32 v88, v88
    v_mfma_f32_16x16x32_bf16 v[76:79], a[248:251], v[152:155], v[76:79]
    v_cvt_pk_bf16_f32 v86, v108, v109
    v_exp_f32 v97, v97
    v_mfma_f32_16x16x32_bf16 v[76:79], a[252:255], v[156:159], v[76:79]
    v_cvt_pk_bf16_f32 v87, v110, v111
    v_rcp_f32 v89, v89
    v_mfma_f32_16x16x32_bf16 v[76:79], v[112:115], v[160:163], v[76:79]
    s_add_u32 s52, s56, 1024
    buffer_store_dwordx4 v[84:87], v1, s[12:15], s52 offen sc1
    v_exp_f32 v98, v98
    v_rcp_f32 v90, v90
    v_mfma_f32_16x16x32_bf16 v[76:79], v[116:119], v[164:167], v[76:79]
    v_exp_f32 v99, v99
    v_mfma_f32_16x16x32_bf16 v[80:83], v[120:123], v[144:147], 0
    ds_read_b128 v[144:147], v2 offset:43008
    v_rcp_f32 v91, v91
    v_mfma_f32_16x16x32_bf16 v[80:83], v[124:127], v[148:151], v[80:83]
    ds_read_b128 v[148:151], v2 offset:45056
    v_exp_f32 v100, v100
    v_mfma_f32_16x16x32_bf16 v[80:83], v[128:131], v[152:155], v[80:83]
    ds_read_b128 v[152:155], v2 offset:47104
    v_rcp_f32 v92, v92
    v_mfma_f32_16x16x32_bf16 v[80:83], v[132:135], v[156:159], v[80:83]
    ds_read_b128 v[156:159], v3 offset:43008
    v_exp_f32 v101, v101
    v_mfma_f32_16x16x32_bf16 v[80:83], v[136:139], v[160:163], v[80:83]
    ds_read_b128 v[160:163], v3 offset:45056
    v_rcp_f32 v93, v93
    v_mfma_f32_16x16x32_bf16 v[80:83], v[140:143], v[164:167], v[80:83]
    ds_read_b128 v[164:167], v3 offset:47104
    v_exp_f32 v102, v102
    v_rcp_f32 v94, v94
    v_exp_f32 v103, v103
    v_rcp_f32 v95, v95
    v_pk_mul_f32 v[104:105], v[60:61], v[88:89]
    v_pk_mul_f32 v[106:107], v[62:63], v[90:91]
    v_pk_mul_f32 v[108:109], v[64:65], v[92:93]
    v_pk_mul_f32 v[110:111], v[66:67], v[94:95]
    v_pk_add_f32 v[96:97], v[96:97], 1.0 op_sel_hi:[1,0]
    v_pk_add_f32 v[98:99], v[98:99], 1.0 op_sel_hi:[1,0]
    v_pk_add_f32 v[100:101], v[100:101], 1.0 op_sel_hi:[1,0]
    v_pk_add_f32 v[102:103], v[102:103], 1.0 op_sel_hi:[1,0]
    v_pk_fma_f32 v[36:37], v[104:105], v[104:105], v[36:37]
    v_pk_fma_f32 v[38:39], v[106:107], v[106:107], v[38:39]
    v_pk_fma_f32 v[40:41], v[108:109], v[108:109], v[40:41]
    v_pk_fma_f32 v[42:43], v[110:111], v[110:111], v[42:43]
    s_waitcnt lgkmcnt(5)
    v_pk_fma_f32 v[88:89], v[76:77], v[76:77], s[50:51]
    v_pk_fma_f32 v[90:91], v[78:79], v[78:79], s[50:51]
    v_pk_fma_f32 v[92:93], v[80:81], v[80:81], s[50:51]
    v_pk_fma_f32 v[94:95], v[82:83], v[82:83], s[50:51]
    v_pk_mul_f32 v[88:89], v[88:89], v[76:77]
    v_pk_mul_f32 v[90:91], v[90:91], v[78:79]
    v_pk_mul_f32 v[92:93], v[92:93], v[80:81]
    v_pk_mul_f32 v[94:95], v[94:95], v[82:83]
L_p1_mid:
    v_mfma_f32_16x16x32_bf16 v[60:63], a[0:3], v[144:147], 0
    s_waitcnt lgkmcnt(4)
    v_cvt_pk_bf16_f32 v84, v104, v105
    v_exp_f32 v88, v88
    v_mfma_f32_16x16x32_bf16 v[60:63], a[4:7], v[148:151], v[60:63]
    s_waitcnt lgkmcnt(3)
    v_cvt_pk_bf16_f32 v85, v106, v107
    v_rcp_f32 v96, v96
    v_mfma_f32_16x16x32_bf16 v[60:63], a[8:11], v[152:155], v[60:63]
    s_waitcnt lgkmcnt(2)
    v_cvt_pk_bf16_f32 v86, v108, v109
    v_exp_f32 v89, v89
    v_mfma_f32_16x16x32_bf16 v[60:63], a[12:15], v[156:159], v[60:63]
    s_waitcnt lgkmcnt(0)
    v_cvt_pk_bf16_f32 v87, v110, v111
    v_rcp_f32 v97, v97
    v_mfma_f32_16x16x32_bf16 v[60:63], a[16:19], v[160:163], v[60:63]
    s_add_u32 s52, s56, 2048
    buffer_store_dwordx4 v[84:87], v1, s[12:15], s52 offen sc1
    v_exp_f32 v90, v90
    v_rcp_f32 v98, v98
    v_mfma_f32_16x16x32_bf16 v[60:63], a[20:23], v[164:167], v[60:63]
    v_exp_f32 v91, v91
    v_mfma_f32_16x16x32_bf16 v[64:67], a[24:27], v[144:147], 0
    v_rcp_f32 v99, v99
    v_mfma_f32_16x16x32_bf16 v[64:67], a[28:31], v[148:151], v[64:67]
    v_exp_f32 v92, v92
    v_mfma_f32_16x16x32_bf16 v[64:67], a[32:35], v[152:155], v[64:67]
    v_rcp_f32 v100, v100
    v_mfma_f32_16x16x32_bf16 v[64:67], a[36:39], v[156:159], v[64:67]
    v_add_u32 v253, 1, v253
    v_exp_f32 v93, v93
    v_mfma_f32_16x16x32_bf16 v[64:67], a[40:43], v[160:163], v[64:67]
    v_rcp_f32 v101, v101
    v_mfma_f32_16x16x32_bf16 v[64:67], a[44:47], v[164:167], v[64:67]
    ds_write_b32 v252, v253 offset:51584
    v_exp_f32 v94, v94
    v_rcp_f32 v102, v102
    v_exp_f32 v95, v95
    v_rcp_f32 v103, v103
    v_pk_mul_f32 v[104:105], v[68:69], v[96:97]
    v_pk_mul_f32 v[106:107], v[70:71], v[98:99]
    v_pk_mul_f32 v[108:109], v[72:73], v[100:101]
    v_pk_mul_f32 v[110:111], v[74:75], v[102:103]
    v_pk_add_f32 v[88:89], v[88:89], 1.0 op_sel_hi:[1,0]
    v_pk_add_f32 v[90:91], v[90:91], 1.0 op_sel_hi:[1,0]
    v_pk_add_f32 v[92:93], v[92:93], 1.0 op_sel_hi:[1,0]
    v_pk_add_f32 v[94:95], v[94:95], 1.0 op_sel_hi:[1,0]
    v_pk_fma_f32 v[44:45], v[104:105], v[104:105], v[44:45]
    v_pk_fma_f32 v[46:47], v[106:107], v[106:107], v[46:47]
    v_pk_fma_f32 v[48:49], v[108:109], v[108:109], v[48:49]
    v_pk_fma_f32 v[50:51], v[110:111], v[110:111], v[50:51]
    v_pk_fma_f32 v[96:97], v[60:61], v[60:61], s[50:51]
    v_pk_fma_f32 v[98:99], v[62:63], v[62:63], s[50:51]
    v_pk_fma_f32 v[100:101], v[64:65], v[64:65], s[50:51]
    v_pk_fma_f32 v[102:103], v[66:67], v[66:67], s[50:51]
    v_pk_mul_f32 v[96:97], v[96:97], v[60:61]
    v_pk_mul_f32 v[98:99], v[98:99], v[62:63]
    v_pk_mul_f32 v[100:101], v[100:101], v[64:65]
    v_pk_mul_f32 v[102:103], v[102:103], v[66:67]
    v_mfma_f32_16x16x32_bf16 v[68:71], a[48:51], v[144:147], 0
    v_cvt_pk_bf16_f32 v84, v104, v105
    v_exp_f32 v96, v96
    v_mfma_f32_16x16x32_bf16 v[68:71], a[52:55], v[148:151], v[68:71]
    v_cvt_pk_bf16_f32 v85, v106, v107
    v_rcp_f32 v88, v88
    v_mfma_f32_16x16x32_bf16 v[68:71], a[56:59], v[152:155], v[68:71]
    v_cvt_pk_bf16_f32 v86, v108, v109
    v_exp_f32 v97, v97
    v_mfma_f32_16x16x32_bf16 v[68:71], a[60:63], v[156:159], v[68:71]
    v_cvt_pk_bf16_f32 v87, v110, v111
    v_rcp_f32 v89, v89
    v_mfma_f32_16x16x32_bf16 v[68:71], a[64:67], v[160:163], v[68:71]
    s_add_u32 s52, s56, 3072
    buffer_store_dwordx4 v[84:87], v1, s[12:15], s52 offen sc1
    v_exp_f32 v98, v98
    v_rcp_f32 v90, v90
    v_mfma_f32_16x16x32_bf16 v[68:71], a[68:71], v[164:167], v[68:71]
    s_cmp_le_u32 s54, 2
    v_exp_f32 v99, v99
    v_mfma_f32_16x16x32_bf16 v[72:75], a[72:75], v[144:147], 0
    s_cselect_b32 s26, 256, 0
    v_rcp_f32 v91, v91
    v_mfma_f32_16x16x32_bf16 v[72:75], a[76:79], v[148:151], v[72:75]
    v_exp_f32 v100, v100
    v_mfma_f32_16x16x32_bf16 v[72:75], a[80:83], v[152:155], v[72:75]
    buffer_load_dword v7, v1, s[24:27], 0 offen sc1
    v_rcp_f32 v92, v92
    v_mfma_f32_16x16x32_bf16 v[72:75], a[84:87], v[156:159], v[72:75]
    v_exp_f32 v101, v101
    v_mfma_f32_16x16x32_bf16 v[72:75], a[88:91], v[160:163], v[72:75]
    global_load_dword v255, v250, s[98:99]
    v_rcp_f32 v93, v93
    v_mfma_f32_16x16x32_bf16 v[72:75], a[92:95], v[164:167], v[72:75]
    v_exp_f32 v102, v102
    v_rcp_f32 v94, v94
    v_exp_f32 v103, v103
    v_rcp_f32 v95, v95
    v_pk_mul_f32 v[104:105], v[76:77], v[88:89]
    v_pk_mul_f32 v[106:107], v[78:79], v[90:91]
    v_pk_mul_f32 v[108:109], v[80:81], v[92:93]
    v_pk_mul_f32 v[110:111], v[82:83], v[94:95]
    v_pk_add_f32 v[96:97], v[96:97], 1.0 op_sel_hi:[1,0]
    v_pk_add_f32 v[98:99], v[98:99], 1.0 op_sel_hi:[1,0]
    v_pk_add_f32 v[100:101], v[100:101], 1.0 op_sel_hi:[1,0]
    v_pk_add_f32 v[102:103], v[102:103], 1.0 op_sel_hi:[1,0]
    v_pk_fma_f32 v[52:53], v[104:105], v[104:105], v[52:53]
    v_pk_fma_f32 v[54:55], v[106:107], v[106:107], v[54:55]
    v_pk_fma_f32 v[56:57], v[108:109], v[108:109], v[56:57]
    v_pk_fma_f32 v[58:59], v[110:111], v[110:111], v[58:59]
    v_pk_fma_f32 v[88:89], v[68:69], v[68:69], s[50:51]
    v_pk_fma_f32 v[90:91], v[70:71], v[70:71], s[50:51]
    v_pk_fma_f32 v[92:93], v[72:73], v[72:73], s[50:51]
    v_pk_fma_f32 v[94:95], v[74:75], v[74:75], s[50:51]
    v_pk_mul_f32 v[88:89], v[88:89], v[68:69]
    v_pk_mul_f32 v[90:91], v[90:91], v[70:71]
    v_pk_mul_f32 v[92:93], v[92:93], v[72:73]
    v_pk_mul_f32 v[94:95], v[94:95], v[74:75]
    v_mfma_f32_16x16x32_bf16 v[76:79], a[96:99], v[144:147], 0
    v_cvt_pk_bf16_f32 v84, v104, v105
    v_exp_f32 v88, v88
    v_mfma_f32_16x16x32_bf16 v[76:79], a[100:103], v[148:151], v[76:79]
    v_cvt_pk_bf16_f32 v85, v106, v107
    v_rcp_f32 v96, v96
    v_mfma_f32_16x16x32_bf16 v[76:79], a[104:107], v[152:155], v[76:79]
    v_cvt_pk_bf16_f32 v86, v108, v109
    v_exp_f32 v89, v89
    v_mfma_f32_16x16x32_bf16 v[76:79], a[108:111], v[156:159], v[76:79]
    v_cvt_pk_bf16_f32 v87, v110, v111
    v_rcp_f32 v97, v97
    v_mfma_f32_16x16x32_bf16 v[76:79], a[112:115], v[160:163], v[76:79]
    s_add_u32 s52, s56, 4096
    buffer_store_dwordx4 v[84:87], v1, s[12:15], s52 offen sc1
    v_exp_f32 v90, v90
    v_rcp_f32 v98, v98
    v_mfma_f32_16x16x32_bf16 v[76:79], a[116:119], v[164:167], v[76:79]
    v_exp_f32 v91, v91
    v_mfma_f32_16x16x32_bf16 v[80:83], a[120:123], v[144:147], 0
    s_add_u32 s56, s56, 36864
    v_rcp_f32 v99, v99
    v_mfma_f32_16x16x32_bf16 v[80:83], a[124:127], v[148:151], v[80:83]
    v_exp_f32 v92, v92
    v_mfma_f32_16x16x32_bf16 v[80:83], a[128:131], v[152:155], v[80:83]
    v_rcp_f32 v100, v100
    v_mfma_f32_16x16x32_bf16 v[80:83], a[132:135], v[156:159], v[80:83]
    v_exp_f32 v93, v93
    v_mfma_f32_16x16x32_bf16 v[80:83], a[136:139], v[160:163], v[80:83]
    v_rcp_f32 v101, v101
    v_mfma_f32_16x16x32_bf16 v[80:83], a[140:143], v[164:167], v[80:83]
    v_exp_f32 v94, v94
    v_rcp_f32 v102, v102
    v_exp_f32 v95, v95
    v_rcp_f32 v103, v103
    v_pk_mul_f32 v[104:105], v[60:61], v[96:97]
    v_pk_mul_f32 v[106:107], v[62:63], v[98:99]
    v_pk_mul_f32 v[108:109], v[64:65], v[100:101]
    v_pk_mul_f32 v[110:111], v[66:67], v[102:103]
    v_pk_add_f32 v[88:89], v[88:89], 1.0 op_sel_hi:[1,0]
    v_pk_add_f32 v[90:91], v[90:91], 1.0 op_sel_hi:[1,0]
    v_pk_add_f32 v[92:93], v[92:93], 1.0 op_sel_hi:[1,0]
    v_pk_add_f32 v[94:95], v[94:95], 1.0 op_sel_hi:[1,0]
    v_pk_fma_f32 v[12:13], v[104:105], v[104:105], v[12:13]
    v_pk_fma_f32 v[14:15], v[106:107], v[106:107], v[14:15]
    v_pk_fma_f32 v[16:17], v[108:109], v[108:109], v[16:17]
    v_pk_fma_f32 v[18:19], v[110:111], v[110:111], v[18:19]
    v_pk_fma_f32 v[96:97], v[76:77], v[76:77], s[50:51]
    v_pk_fma_f32 v[98:99], v[78:79], v[78:79], s[50:51]
    v_pk_fma_f32 v[100:101], v[80:81], v[80:81], s[50:51]
    v_pk_fma_f32 v[102:103], v[82:83], v[82:83], s[50:51]
    v_pk_mul_f32 v[96:97], v[96:97], v[76:77]
    v_pk_mul_f32 v[98:99], v[98:99], v[78:79]
    v_pk_mul_f32 v[100:101], v[100:101], v[80:81]
    v_pk_mul_f32 v[102:103], v[102:103], v[82:83]
    v_mfma_f32_16x16x32_bf16 v[60:63], a[144:147], v[144:147], 0
    v_exp_f32 v96, v96
    v_mfma_f32_16x16x32_bf16 v[60:63], a[148:151], v[148:151], v[60:63]
    v_rcp_f32 v88, v88
    v_mfma_f32_16x16x32_bf16 v[60:63], a[152:155], v[152:155], v[60:63]
    v_exp_f32 v97, v97
    v_mfma_f32_16x16x32_bf16 v[60:63], a[156:159], v[156:159], v[60:63]
    v_rcp_f32 v89, v89
    v_mfma_f32_16x16x32_bf16 v[60:63], a[160:163], v[160:163], v[60:63]
    v_exp_f32 v98, v98
    v_mfma_f32_16x16x32_bf16 v[60:63], a[164:167], v[164:167], v[60:63]
    v_rcp_f32 v90, v90
    v_mfma_f32_16x16x32_bf16 v[64:67], a[168:171], v[144:147], 0
    v_exp_f32 v99, v99
    v_mfma_f32_16x16x32_bf16 v[64:67], a[172:175], v[148:151], v[64:67]
    v_rcp_f32 v91, v91
    v_mfma_f32_16x16x32_bf16 v[64:67], a[176:179], v[152:155], v[64:67]
    v_exp_f32 v100, v100
    v_mfma_f32_16x16x32_bf16 v[64:67], a[180:183], v[156:159], v[64:67]
    v_rcp_f32 v92, v92
    v_mfma_f32_16x16x32_bf16 v[64:67], a[184:187], v[160:163], v[64:67]
    v_exp_f32 v101, v101
    v_mfma_f32_16x16x32_bf16 v[64:67], a[188:191], v[164:167], v[64:67]
    v_rcp_f32 v93, v93
    v_exp_f32 v102, v102
    v_rcp_f32 v94, v94
    v_exp_f32 v103, v103
    v_rcp_f32 v95, v95
    v_pk_mul_f32 v[104:105], v[68:69], v[88:89]
    v_pk_mul_f32 v[106:107], v[70:71], v[90:91]
    v_pk_mul_f32 v[108:109], v[72:73], v[92:93]
    v_pk_mul_f32 v[110:111], v[74:75], v[94:95]
    v_pk_add_f32 v[96:97], v[96:97], 1.0 op_sel_hi:[1,0]
    v_pk_add_f32 v[98:99], v[98:99], 1.0 op_sel_hi:[1,0]
    v_pk_add_f32 v[100:101], v[100:101], 1.0 op_sel_hi:[1,0]
    v_pk_add_f32 v[102:103], v[102:103], 1.0 op_sel_hi:[1,0]
    v_pk_fma_f32 v[20:21], v[104:105], v[104:105], v[20:21]
    v_pk_fma_f32 v[22:23], v[106:107], v[106:107], v[22:23]
    v_pk_fma_f32 v[24:25], v[108:109], v[108:109], v[24:25]
    v_pk_fma_f32 v[26:27], v[110:111], v[110:111], v[26:27]
    v_pk_fma_f32 v[88:89], v[60:61], v[60:61], s[50:51]
    v_pk_fma_f32 v[90:91], v[62:63], v[62:63], s[50:51]
    v_pk_fma_f32 v[92:93], v[64:65], v[64:65], s[50:51]
    v_pk_fma_f32 v[94:95], v[66:67], v[66:67], s[50:51]
    v_pk_mul_f32 v[88:89], v[88:89], v[60:61]
    v_pk_mul_f32 v[90:91], v[90:91], v[62:63]
    v_pk_mul_f32 v[92:93], v[92:93], v[64:65]
    v_pk_mul_f32 v[94:95], v[94:95], v[66:67]
    v_mfma_f32_16x16x32_bf16 v[68:71], a[192:195], v[144:147], 0
    v_exp_f32 v88, v88
    v_mfma_f32_16x16x32_bf16 v[68:71], a[196:199], v[148:151], v[68:71]
    v_rcp_f32 v96, v96
    v_mfma_f32_16x16x32_bf16 v[68:71], a[200:203], v[152:155], v[68:71]
    v_exp_f32 v89, v89
    v_mfma_f32_16x16x32_bf16 v[68:71], a[204:207], v[156:159], v[68:71]
    v_rcp_f32 v97, v97
    v_mfma_f32_16x16x32_bf16 v[68:71], a[208:211], v[160:163], v[68:71]
    v_exp_f32 v90, v90
    v_mfma_f32_16x16x32_bf16 v[68:71], a[212:215], v[164:167], v[68:71]
    v_rcp_f32 v98, v98
    v_mfma_f32_16x16x32_bf16 v[72:75], a[216:219], v[144:147], 0
    v_exp_f32 v91, v91
    v_mfma_f32_16x16x32_bf16 v[72:75], a[220:223], v[148:151], v[72:75]
    v_rcp_f32 v99, v99
    v_mfma_f32_16x16x32_bf16 v[72:75], a[224:227], v[152:155], v[72:75]
    v_exp_f32 v92, v92
    v_mfma_f32_16x16x32_bf16 v[72:75], a[228:231], v[156:159], v[72:75]
    ds_read_b32 v248, v249 offset:51584
    v_rcp_f32 v100, v100
    v_mfma_f32_16x16x32_bf16 v[72:75], a[232:235], v[160:163], v[72:75]
    v_exp_f32 v93, v93
    v_mfma_f32_16x16x32_bf16 v[72:75], a[236:239], v[164:167], v[72:75]
    v_rcp_f32 v101, v101
    v_exp_f32 v94, v94
    v_rcp_f32 v102, v102
    v_exp_f32 v95, v95
    v_rcp_f32 v103, v103
    v_pk_mul_f32 v[104:105], v[76:77], v[96:97]
    v_pk_mul_f32 v[106:107], v[78:79], v[98:99]
    v_pk_mul_f32 v[108:109], v[80:81], v[100:101]
    v_pk_mul_f32 v[110:111], v[82:83], v[102:103]
    v_pk_add_f32 v[88:89], v[88:89], 1.0 op_sel_hi:[1,0]
    v_pk_add_f32 v[90:91], v[90:91], 1.0 op_sel_hi:[1,0]
    v_pk_add_f32 v[92:93], v[92:93], 1.0 op_sel_hi:[1,0]
    v_pk_add_f32 v[94:95], v[94:95], 1.0 op_sel_hi:[1,0]
    v_pk_fma_f32 v[28:29], v[104:105], v[104:105], v[28:29]
    v_pk_fma_f32 v[30:31], v[106:107], v[106:107], v[30:31]
    v_pk_fma_f32 v[32:33], v[108:109], v[108:109], v[32:33]
    v_pk_fma_f32 v[34:35], v[110:111], v[110:111], v[34:35]
    v_pk_fma_f32 v[96:97], v[68:69], v[68:69], s[50:51]
    v_pk_fma_f32 v[98:99], v[70:71], v[70:71], s[50:51]
    v_pk_fma_f32 v[100:101], v[72:73], v[72:73], s[50:51]
    v_pk_fma_f32 v[102:103], v[74:75], v[74:75], s[50:51]
    v_pk_mul_f32 v[96:97], v[96:97], v[68:69]
    v_pk_mul_f32 v[98:99], v[98:99], v[70:71]
    v_pk_mul_f32 v[100:101], v[100:101], v[72:73]
    v_pk_mul_f32 v[102:103], v[102:103], v[74:75]
    v_mfma_f32_16x16x32_bf16 v[76:79], a[240:243], v[144:147], 0
    s_sub_u32 s54, s54, 1
    v_cvt_pk_bf16_f32 v84, v104, v105
    v_exp_f32 v96, v96
    v_mfma_f32_16x16x32_bf16 v[76:79], a[244:247], v[148:151], v[76:79]
    s_waitcnt lgkmcnt(0)
    v_cvt_pk_bf16_f32 v85, v106, v107
    v_cmp_lt_u32 vcc, v248, v253
    v_rcp_f32 v88, v88
    v_mfma_f32_16x16x32_bf16 v[76:79], a[248:251], v[152:155], v[76:79]
    v_cvt_pk_bf16_f32 v86, v108, v109
    v_exp_f32 v97, v97
    v_mfma_f32_16x16x32_bf16 v[76:79], a[252:255], v[156:159], v[76:79]
    s_cbranch_vccnz L_flag0
L_flag0_ret:
    v_cvt_pk_bf16_f32 v87, v110, v111
    v_rcp_f32 v89, v89
    v_mfma_f32_16x16x32_bf16 v[76:79], v[112:115], v[160:163], v[76:79]
    s_add_u32 s52, s57, 0
    buffer_store_dwordx4 v[84:87], v1, s[12:15], s52 offen sc1
    v_exp_f32 v98, v98
    v_rcp_f32 v90, v90
    v_mfma_f32_16x16x32_bf16 v[76:79], v[116:119], v[164:167], v[76:79]
    v_exp_f32 v99, v99
    v_mfma_f32_16x16x32_bf16 v[80:83], v[120:123], v[144:147], 0
    ds_read_b128 v[144:147], v4 offset:0
    v_rcp_f32 v91, v91
    v_mfma_f32_16x16x32_bf16 v[80:83], v[124:127], v[148:151], v[80:83]
    ds_read_b128 v[148:151], v4 offset:2048
    v_exp_f32 v100, v100
    v_mfma_f32_16x16x32_bf16 v[80:83], v[128:131], v[152:155], v[80:83]
    ds_read_b128 v[152:155], v4 offset:4096
    v_rcp_f32 v92, v92
    v_mfma_f32_16x16x32_bf16 v[80:83], v[132:135], v[156:159], v[80:83]
    ds_read_b128 v[156:159], v5 offset:0
    v_exp_f32 v101, v101
    v_mfma_f32_16x16x32_bf16 v[80:83], v[136:139], v[160:163], v[80:83]
    ds_read_b128 v[160:163], v5 offset:2048
    v_rcp_f32 v93, v93
    v_mfma_f32_16x16x32_bf16 v[80:83], v[140:143], v[164:167], v[80:83]
    ds_read_b128 v[164:167], v5 offset:4096
    v_exp_f32 v102, v102
    v_rcp_f32 v94, v94
    v_exp_f32 v103, v103
    v_rcp_f32 v95, v95
    v_pk_mul_f32 v[104:105], v[60:61], v[88:89]
    v_pk_mul_f32 v[106:107], v[62:63], v[90:91]
    v_pk_mul_f32 v[108:109], v[64:65], v[92:93]
    v_pk_mul_f32 v[110:111], v[66:67], v[94:95]
    v_pk_add_f32 v[96:97], v[96:97], 1.0 op_sel_hi:[1,0]
    v_pk_add_f32 v[98:99], v[98:99], 1.0 op_sel_hi:[1,0]
    v_pk_add_f32 v[100:101], v[100:101], 1.0 op_sel_hi:[1,0]
    v_pk_add_f32 v[102:103], v[102:103], 1.0 op_sel_hi:[1,0]
    v_pk_fma_f32 v[36:37], v[104:105], v[104:105], v[36:37]
    v_pk_fma_f32 v[38:39], v[106:107], v[106:107], v[38:39]
    v_pk_fma_f32 v[40:41], v[108:109], v[108:109], v[40:41]
    v_pk_fma_f32 v[42:43], v[110:111], v[110:111], v[42:43]
    s_waitcnt lgkmcnt(5)
    v_pk_fma_f32 v[88:89], v[76:77], v[76:77], s[50:51]
    v_pk_fma_f32 v[90:91], v[78:79], v[78:79], s[50:51]
    v_pk_fma_f32 v[92:93], v[80:81], v[80:81], s[50:51]
    v_pk_fma_f32 v[94:95], v[82:83], v[82:83], s[50:51]
    v_pk_mul_f32 v[88:89], v[88:89], v[76:77]
    v_pk_mul_f32 v[90:91], v[90:91], v[78:79]
    v_pk_mul_f32 v[92:93], v[92:93], v[80:81]
    v_pk_mul_f32 v[94:95], v[94:95], v[82:83]
    s_cmp_eq_u32 s54, 0
    s_cbranch_scc1 L_last
L_p1_b:
    v_mfma_f32_16x16x32_bf16 v[60:63], a[0:3], v[144:147], 0
    s_waitcnt lgkmcnt(4)
    v_cvt_pk_bf16_f32 v84, v104, v105
    v_exp_f32 v88, v88
    v_mfma_f32_16x16x32_bf16 v[60:63], a[4:7], v[148:151], v[60:63]
    s_waitcnt lgkmcnt(3)
    v_cvt_pk_bf16_f32 v85, v106, v107
    v_rcp_f32 v96, v96
    v_mfma_f32_16x16x32_bf16 v[60:63], a[8:11], v[152:155], v[60:63]
    s_waitcnt lgkmcnt(2)
    v_cvt_pk_bf16_f32 v86, v108, v109
    v_exp_f32 v89, v89
    v_mfma_f32_16x16x32_bf16 v[60:63], a[12:15], v[156:159], v[60:63]
    s_waitcnt lgkmcnt(0)
    v_cvt_pk_bf16_f32 v87, v110, v111
    v_rcp_f32 v97, v97
    v_mfma_f32_16x16x32_bf16 v[60:63], a[16:19], v[160:163], v[60:63]
    s_add_u32 s52, s57, 1024
    buffer_store_dwordx4 v[84:87], v1, s[12:15], s52 offen sc1
    v_exp_f32 v90, v90
    v_rcp_f32 v98, v98
    v_mfma_f32_16x16x32_bf16 v[60:63], a[20:23], v[164:167], v[60:63]
    v_exp_f32 v91, v91
    v_mfma_f32_16x16x32_bf16 v[64:67], a[24:27], v[144:147], 0
    v_rcp_f32 v99, v99
    v_mfma_f32_16x16x32_bf16 v[64:67], a[28:31], v[148:151], v[64:67]
    v_exp_f32 v92, v92
    v_mfma_f32_16x16x32_bf16 v[64:67], a[32:35], v[152:155], v[64:67]
    v_rcp_f32 v100, v100
    v_mfma_f32_16x16x32_bf16 v[64:67], a[36:39], v[156:159], v[64:67]
    v_exp_f32 v93, v93
    v_mfma_f32_16x16x32_bf16 v[64:67], a[40:43], v[160:163], v[64:67]
    v_rcp_f32 v101, v101
    v_mfma_f32_16x16x32_bf16 v[64:67], a[44:47], v[164:167], v[64:67]
    s_waitcnt vmcnt(31)
    v_exp_f32 v94, v94
    v_rcp_f32 v102, v102
    v_exp_f32 v95, v95
    v_rcp_f32 v103, v103
    v_pk_mul_f32 v[104:105], v[68:69], v[96:97]
    v_pk_mul_f32 v[106:107], v[70:71], v[98:99]
    v_pk_mul_f32 v[108:109], v[72:73], v[100:101]
    v_pk_mul_f32 v[110:111], v[74:75], v[102:103]
    v_pk_add_f32 v[88:89], v[88:89], 1.0 op_sel_hi:[1,0]
    v_pk_add_f32 v[90:91], v[90:91], 1.0 op_sel_hi:[1,0]
    v_pk_add_f32 v[92:93], v[92:93], 1.0 op_sel_hi:[1,0]
    v_pk_add_f32 v[94:95], v[94:95], 1.0 op_sel_hi:[1,0]
    v_pk_fma_f32 v[44:45], v[104:105], v[104:105], v[44:45]
    v_pk_fma_f32 v[46:47], v[106:107], v[106:107], v[46:47]
    v_pk_fma_f32 v[48:49], v[108:109], v[108:109], v[48:49]
    v_pk_fma_f32 v[50:51], v[110:111], v[110:111], v[50:51]
    v_dot2_f32_bf16 v216, v192, v168, 0
    v_dot2_f32_bf16 v217, v192, v169, 0
    v_dot2_f32_bf16 v218, v193, v170, 0
    v_dot2_f32_bf16 v219, v193, v171, 0
    v_dot2_f32_bf16 v220, v194, v172, 0
    v_dot2_f32_bf16 v221, v194, v173, 0
    v_dot2_f32_bf16 v222, v195, v174, 0
    v_dot2_f32_bf16 v223, v195, v175, 0
    v_dot2_f32_bf16 v224, v196, v176, 0
    v_dot2_f32_bf16 v225, v196, v177, 0
    v_dot2_f32_bf16 v226, v197, v178, 0
    v_dot2_f32_bf16 v227, v197, v179, 0
    v_dot2_f32_bf16 v228, v198, v180, 0
    v_dot2_f32_bf16 v229, v198, v181, 0
    v_dot2_f32_bf16 v230, v199, v182, 0
    v_dot2_f32_bf16 v231, v199, v183, 0
    v_dot2_f32_bf16 v232, v200, v184, 0
    v_dot2_f32_bf16 v233, v200, v185, 0
    v_dot2_f32_bf16 v234, v201, v186, 0
    v_dot2_f32_bf16 v235, v201, v187, 0
    v_dot2_f32_bf16 v236, v202, v188, 0
    v_dot2_f32_bf16 v237, v202, v189, 0
    v_dot2_f32_bf16 v238, v203, v190, 0
    v_dot2_f32_bf16 v239, v203, v191, 0
    v_pk_fma_f32 v[96:97], v[60:61], v[60:61], s[50:51]
    v_pk_fma_f32 v[98:99], v[62:63], v[62:63], s[50:51]
    v_pk_fma_f32 v[100:101], v[64:65], v[64:65], s[50:51]
    v_pk_fma_f32 v[102:103], v[66:67], v[66:67], s[50:51]
    v_pk_mul_f32 v[96:97], v[96:97], v[60:61]
    v_pk_mul_f32 v[98:99], v[98:99], v[62:63]
    v_pk_mul_f32 v[100:101], v[100:101], v[64:65]
    v_pk_mul_f32 v[102:103], v[102:103], v[66:67]
    v_mfma_f32_16x16x32_bf16 v[68:71], a[48:51], v[144:147], 0
    v_cvt_pk_bf16_f32 v84, v104, v105
    v_exp_f32 v96, v96
    v_mfma_f32_16x16x32_bf16 v[68:71], a[52:55], v[148:151], v[68:71]
    v_cvt_pk_bf16_f32 v85, v106, v107
    v_rcp_f32 v88, v88
    v_mfma_f32_16x16x32_bf16 v[68:71], a[56:59], v[152:155], v[68:71]
    v_cvt_pk_bf16_f32 v86, v108, v109
    v_exp_f32 v97, v97
    v_mfma_f32_16x16x32_bf16 v[68:71], a[60:63], v[156:159], v[68:71]
    v_cvt_pk_bf16_f32 v87, v110, v111
    v_rcp_f32 v89, v89
    v_mfma_f32_16x16x32_bf16 v[68:71], a[64:67], v[160:163], v[68:71]
    s_add_u32 s52, s57, 2048
    buffer_store_dwordx4 v[84:87], v1, s[12:15], s52 offen sc1
    v_exp_f32 v98, v98
    v_rcp_f32 v90, v90
    v_mfma_f32_16x16x32_bf16 v[68:71], a[68:71], v[164:167], v[68:71]
    v_exp_f32 v99, v99
    v_mfma_f32_16x16x32_bf16 v[72:75], a[72:75], v[144:147], 0
    buffer_load_dwordx4 v[192:195], v0, s[4:7], s55 offen offset:0
    v_rcp_f32 v91, v91
    v_mfma_f32_16x16x32_bf16 v[72:75], a[76:79], v[148:151], v[72:75]
    v_exp_f32 v100, v100
    v_mfma_f32_16x16x32_bf16 v[72:75], a[80:83], v[152:155], v[72:75]
    buffer_load_dwordx4 v[196:199], v0, s[4:7], s55 offen offset:128
    v_rcp_f32 v92, v92
    v_mfma_f32_16x16x32_bf16 v[72:75], a[84:87], v[156:159], v[72:75]
    v_exp_f32 v101, v101
    v_mfma_f32_16x16x32_bf16 v[72:75], a[88:91], v[160:163], v[72:75]
    buffer_load_dwordx4 v[200:203], v0, s[4:7], s55 offen offset:256
    v_rcp_f32 v93, v93
    v_mfma_f32_16x16x32_bf16 v[72:75], a[92:95], v[164:167], v[72:75]
    s_add_u32 s55, s55, 12288
    v_exp_f32 v102, v102
    v_rcp_f32 v94, v94
    v_exp_f32 v103, v103
    v_rcp_f32 v95, v95
    v_pk_mul_f32 v[104:105], v[76:77], v[88:89]
    v_pk_mul_f32 v[106:107], v[78:79], v[90:91]
    v_pk_mul_f32 v[108:109], v[80:81], v[92:93]
    v_pk_mul_f32 v[110:111], v[82:83], v[94:95]
    v_pk_add_f32 v[96:97], v[96:97], 1.0 op_sel_hi:[1,0]
    v_pk_add_f32 v[98:99], v[98:99], 1.0 op_sel_hi:[1,0]
    v_pk_add_f32 v[100:101], v[100:101], 1.0 op_sel_hi:[1,0]
    v_pk_add_f32 v[102:103], v[102:103], 1.0 op_sel_hi:[1,0]
    v_pk_fma_f32 v[52:53], v[104:105], v[104:105], v[52:53]
    v_pk_fma_f32 v[54:55], v[106:107], v[106:107], v[54:55]
    v_pk_fma_f32 v[56:57], v[108:109], v[108:109], v[56:57]
    v_pk_fma_f32 v[58:59], v[110:111], v[110:111], v[58:59]
    v_pk_mul_f32 v[242:243], v[216:217], v[216:217]
    v_pk_add_f32 v[240:241], v[216:217], v[218:219]
    v_pk_fma_f32 v[242:243], v[218:219], v[218:219], v[242:243]
    v_pk_fma_f32 v[242:243], v[220:221], v[220:221], v[242:243]
    v_pk_add_f32 v[240:241], v[240:241], v[220:221]
    v_pk_fma_f32 v[242:243], v[222:223], v[222:223], v[242:243]
    v_pk_add_f32 v[240:241], v[240:241], v[222:223]
    v_pk_fma_f32 v[242:243], v[224:225], v[224:225], v[242:243]
    v_pk_add_f32 v[240:241], v[240:241], v[224:225]
    v_pk_fma_f32 v[242:243], v[226:227], v[226:227], v[242:243]
    v_pk_add_f32 v[240:241], v[240:241], v[226:227]
    v_pk_fma_f32 v[242:243], v[228:229], v[228:229], v[242:243]
    v_pk_add_f32 v[240:241], v[240:241], v[228:229]
    v_pk_fma_f32 v[242:243], v[230:231], v[230:231], v[242:243]
    v_pk_add_f32 v[240:241], v[240:241], v[230:231]
    v_pk_fma_f32 v[242:243], v[232:233], v[232:233], v[242:243]
    v_pk_add_f32 v[240:241], v[240:241], v[232:233]
    v_pk_fma_f32 v[242:243], v[234:235], v[234:235], v[242:243]
    v_pk_add_f32 v[240:241], v[240:241], v[234:235]
    v_pk_fma_f32 v[242:243], v[236:237], v[236:237], v[242:243]
    v_pk_add_f32 v[240:241], v[240:241], v[236:237]
    v_pk_fma_f32 v[242:243], v[238:239], v[238:239], v[242:243]
    v_pk_add_f32 v[240:241], v[240:241], v[238:239]
    v_pk_fma_f32 v[88:89], v[68:69], v[68:69], s[50:51]
    v_pk_fma_f32 v[90:91], v[70:71], v[70:71], s[50:51]
    v_pk_fma_f32 v[92:93], v[72:73], v[72:73], s[50:51]
    v_pk_fma_f32 v[94:95], v[74:75], v[74:75], s[50:51]
    v_pk_mul_f32 v[88:89], v[88:89], v[68:69]
    v_pk_mul_f32 v[90:91], v[90:91], v[70:71]
    v_pk_mul_f32 v[92:93], v[92:93], v[72:73]
    v_pk_mul_f32 v[94:95], v[94:95], v[74:75]
    v_mfma_f32_16x16x32_bf16 v[76:79], a[96:99], v[144:147], 0
    s_waitcnt vmcnt(8)
    v_cvt_pk_bf16_f32 v84, v104, v105
    v_readfirstlane_b32 s64, v7
    v_exp_f32 v88, v88
    v_mfma_f32_16x16x32_bf16 v[76:79], a[100:103], v[148:151], v[76:79]
    v_cvt_pk_bf16_f32 v85, v106, v107
    v_rcp_f32 v96, v96
    v_mfma_f32_16x16x32_bf16 v[76:79], a[104:107], v[152:155], v[76:79]
    s_cmp_ge_u32 s64, 348
    v_cvt_pk_bf16_f32 v86, v108, v109
    v_exp_f32 v89, v89
    v_mfma_f32_16x16x32_bf16 v[76:79], a[108:111], v[156:159], v[76:79]
    s_cselect_b32 s64, 393216, 0
    v_cvt_pk_bf16_f32 v87, v110, v111
    v_rcp_f32 v97, v97
    v_mfma_f32_16x16x32_bf16 v[76:79], a[112:115], v[160:163], v[76:79]
    s_add_u32 s52, s57, 3072
    buffer_store_dwordx4 v[84:87], v1, s[12:15], s52 offen sc1
    v_add_f32 v240, v240, v241
    v_add_f32 v242, v242, v243
    v_exp_f32 v90, v90
    v_rcp_f32 v98, v98
    v_mfma_f32_16x16x32_bf16 v[76:79], a[116:119], v[164:167], v[76:79]
    v_add_f32_dpp v240, v240, v240 quad_perm:[1,0,3,2] row_mask:0xf bank_mask:0xf
    v_add_f32_dpp v242, v242, v242 quad_perm:[1,0,3,2] row_mask:0xf bank_mask:0xf
    v_exp_f32 v91, v91
    v_mfma_f32_16x16x32_bf16 v[80:83], a[120:123], v[144:147], 0
    s_add_u32 s57, s57, 36864
    v_add_f32_dpp v240, v240, v240 quad_perm:[2,3,0,1] row_mask:0xf bank_mask:0xf
    v_add_f32_dpp v242, v242, v242 quad_perm:[2,3,0,1] row_mask:0xf bank_mask:0xf
    v_rcp_f32 v99, v99
    v_mfma_f32_16x16x32_bf16 v[80:83], a[124:127], v[148:151], v[80:83]
    v_add_f32_dpp v240, v240, v240 row_half_mirror row_mask:0xf bank_mask:0xf
    v_add_f32_dpp v242, v242, v242 row_half_mirror row_mask:0xf bank_mask:0xf
    v_exp_f32 v92, v92
    v_mfma_f32_16x16x32_bf16 v[80:83], a[128:131], v[152:155], v[80:83]
    s_cmp_eq_u32 s54, 1
    v_mul_f32 v244, 0x3baaaaab, v240
    v_fma_f32 v240, -v244, v244, v245
    v_rcp_f32 v100, v100
    v_mfma_f32_16x16x32_bf16 v[80:83], a[132:135], v[156:159], v[80:83]
    s_cselect_b32 s30, s64, 0
    v_fmamk_f32 v242, v242, 0x3baaaaab, v240
    v_max_f32 v242, v242, v245
    v_rsq_f32 v242, v242
    v_exp_f32 v93, v93
    v_mfma_f32_16x16x32_bf16 v[80:83], a[136:139], v[160:163], v[80:83]
    v_mul_f32 v246, 0xbeeff558, v242
    v_mul_f32_e64 v247, -v244, v246
    v_rcp_f32 v101, v101
    v_mfma_f32_16x16x32_bf16 v[80:83], a[140:143], v[164:167], v[80:83]
    buffer_load_dword v255, v254, s[28:31], 0 offen sc1
    v_exp_f32 v94, v94
    v_rcp_f32 v102, v102
    v_exp_f32 v95, v95
    v_rcp_f32 v103, v103
    v_pk_mul_f32 v[104:105], v[60:61], v[96:97]
    v_pk_mul_f32 v[106:107], v[62:63], v[98:99]
    v_pk_mul_f32 v[108:109], v[64:65], v[100:101]
    v_pk_mul_f32 v[110:111], v[66:67], v[102:103]
    v_pk_add_f32 v[88:89], v[88:89], 1.0 op_sel_hi:[1,0]
    v_pk_add_f32 v[90:91], v[90:91], 1.0 op_sel_hi:[1,0]
    v_pk_add_f32 v[92:93], v[92:93], 1.0 op_sel_hi:[1,0]
    v_pk_add_f32 v[94:95], v[94:95], 1.0 op_sel_hi:[1,0]
    v_pk_fma_f32 v[12:13], v[104:105], v[104:105], v[12:13]
    v_pk_fma_f32 v[14:15], v[106:107], v[106:107], v[14:15]
    v_pk_fma_f32 v[16:17], v[108:109], v[108:109], v[16:17]
    v_pk_fma_f32 v[18:19], v[110:111], v[110:111], v[18:19]
    v_pk_fma_f32 v[216:217], v[216:217], v[246:247], v[246:247] op_sel:[0,0,1] op_sel_hi:[1,0,1]
    v_pk_fma_f32 v[218:219], v[218:219], v[246:247], v[246:247] op_sel:[0,0,1] op_sel_hi:[1,0,1]
    v_pk_fma_f32 v[220:221], v[220:221], v[246:247], v[246:247] op_sel:[0,0,1] op_sel_hi:[1,0,1]
    v_pk_fma_f32 v[222:223], v[222:223], v[246:247], v[246:247] op_sel:[0,0,1] op_sel_hi:[1,0,1]
    v_pk_fma_f32 v[224:225], v[224:225], v[246:247], v[246:247] op_sel:[0,0,1] op_sel_hi:[1,0,1]
    v_pk_fma_f32 v[226:227], v[226:227], v[246:247], v[246:247] op_sel:[0,0,1] op_sel_hi:[1,0,1]
    v_pk_fma_f32 v[228:229], v[228:229], v[246:247], v[246:247] op_sel:[0,0,1] op_sel_hi:[1,0,1]
    v_pk_fma_f32 v[230:231], v[230:231], v[246:247], v[246:247] op_sel:[0,0,1] op_sel_hi:[1,0,1]
    v_pk_fma_f32 v[232:233], v[232:233], v[246:247], v[246:247] op_sel:[0,0,1] op_sel_hi:[1,0,1]
    v_pk_fma_f32 v[234:235], v[234:235], v[246:247], v[246:247] op_sel:[0,0,1] op_sel_hi:[1,0,1]
    v_pk_fma_f32 v[236:237], v[236:237], v[246:247], v[246:247] op_sel:[0,0,1] op_sel_hi:[1,0,1]
    v_pk_fma_f32 v[238:239], v[238:239], v[246:247], v[246:247] op_sel:[0,0,1] op_sel_hi:[1,0,1]
    v_pk_fma_f32 v[96:97], v[76:77], v[76:77], s[50:51]
    v_pk_fma_f32 v[98:99], v[78:79], v[78:79], s[50:51]
    v_pk_fma_f32 v[100:101], v[80:81], v[80:81], s[50:51]
    v_pk_fma_f32 v[102:103], v[82:83], v[82:83], s[50:51]
    v_pk_mul_f32 v[96:97], v[96:97], v[76:77]
    v_pk_mul_f32 v[98:99], v[98:99], v[78:79]
    v_pk_mul_f32 v[100:101], v[100:101], v[80:81]
    v_pk_mul_f32 v[102:103], v[102:103], v[82:83]
    v_mfma_f32_16x16x32_bf16 v[60:63], a[144:147], v[144:147], 0
    s_mov_b32 m0, s59
    v_exp_f32 v96, v96
    v_mfma_f32_16x16x32_bf16 v[60:63], a[148:151], v[148:151], v[60:63]
    buffer_load_dwordx4 v0, s[4:7], s58 offen  lds
    v_rcp_f32 v88, v88
    v_mfma_f32_16x16x32_bf16 v[60:63], a[152:155], v[152:155], v[60:63]
    v_exp_f32 v97, v97
    v_mfma_f32_16x16x32_bf16 v[60:63], a[156:159], v[156:159], v[60:63]
    s_add_u32 s60, s60, 1
    v_rcp_f32 v89, v89
    v_mfma_f32_16x16x32_bf16 v[60:63], a[160:163], v[160:163], v[60:63]
    v_exp_f32 v98, v98
    v_mfma_f32_16x16x32_bf16 v[60:63], a[164:167], v[164:167], v[60:63]
    s_cmp_eq_u32 s60, 3
    v_cvt_pk_bf16_f32 v216, v216, v217
    v_cvt_pk_bf16_f32 v217, v218, v219
    v_rcp_f32 v90, v90
    v_mfma_f32_16x16x32_bf16 v[64:67], a[168:171], v[144:147], 0
    s_cselect_b32 s64, 0x2f00, s79
    v_cvt_pk_bf16_f32 v218, v220, v221
    v_cvt_pk_bf16_f32 v219, v222, v223
    v_exp_f32 v99, v99
    v_mfma_f32_16x16x32_bf16 v[64:67], a[172:175], v[148:151], v[64:67]
    s_cselect_b32 s65, 0x2000, s78
    v_cvt_pk_bf16_f32 v220, v224, v225
    v_cvt_pk_bf16_f32 v221, v226, v227
    v_rcp_f32 v91, v91
    v_mfma_f32_16x16x32_bf16 v[64:67], a[176:179], v[152:155], v[64:67]
    s_cselect_b32 s60, 0, s60
    v_cvt_pk_bf16_f32 v222, v228, v229
    v_cvt_pk_bf16_f32 v223, v230, v231
    v_exp_f32 v100, v100
    v_mfma_f32_16x16x32_bf16 v[64:67], a[180:183], v[156:159], v[64:67]
    s_add_u32 s59, s59, s65
    v_cvt_pk_bf16_f32 v224, v232, v233
    v_cvt_pk_bf16_f32 v225, v234, v235
    v_rcp_f32 v92, v92
    v_mfma_f32_16x16x32_bf16 v[64:67], a[184:187], v[160:163], v[64:67]
    s_add_u32 s58, s58, s64
    v_cvt_pk_bf16_f32 v226, v236, v237
    v_cvt_pk_bf16_f32 v227, v238, v239
    v_exp_f32 v101, v101
    v_mfma_f32_16x16x32_bf16 v[64:67], a[188:191], v[164:167], v[64:67]
    s_cmp_ge_u32 s58, 36864
    v_rcp_f32 v93, v93
    v_exp_f32 v102, v102
    v_rcp_f32 v94, v94
    v_exp_f32 v103, v103
    v_rcp_f32 v95, v95
    v_pk_mul_f32 v[104:105], v[68:69], v[88:89]
    v_pk_mul_f32 v[106:107], v[70:71], v[90:91]
    v_pk_mul_f32 v[108:109], v[72:73], v[92:93]
    v_pk_mul_f32 v[110:111], v[74:75], v[94:95]
    v_pk_add_f32 v[96:97], v[96:97], 1.0 op_sel_hi:[1,0]
    v_pk_add_f32 v[98:99], v[98:99], 1.0 op_sel_hi:[1,0]
    v_pk_add_f32 v[100:101], v[100:101], 1.0 op_sel_hi:[1,0]
    v_pk_add_f32 v[102:103], v[102:103], 1.0 op_sel_hi:[1,0]
    v_pk_fma_f32 v[20:21], v[104:105], v[104:105], v[20:21]
    v_pk_fma_f32 v[22:23], v[106:107], v[106:107], v[22:23]
    v_pk_fma_f32 v[24:25], v[108:109], v[108:109], v[24:25]
    v_pk_fma_f32 v[26:27], v[110:111], v[110:111], v[26:27]
    v_pk_fma_f32 v[88:89], v[60:61], v[60:61], s[50:51]
    v_pk_fma_f32 v[90:91], v[62:63], v[62:63], s[50:51]
    v_pk_fma_f32 v[92:93], v[64:65], v[64:65], s[50:51]
    v_pk_fma_f32 v[94:95], v[66:67], v[66:67], s[50:51]
    v_pk_mul_f32 v[88:89], v[88:89], v[60:61]
    v_pk_mul_f32 v[90:91], v[90:91], v[62:63]
    v_pk_mul_f32 v[92:93], v[92:93], v[64:65]
    v_pk_mul_f32 v[94:95], v[94:95], v[66:67]
    v_mfma_f32_16x16x32_bf16 v[68:71], a[192:195], v[144:147], 0
    ds_write_b128 v8, v[216:219] offset:36864
    v_cvt_pk_bf16_f32 v84, v104, v105
    v_exp_f32 v88, v88
    v_mfma_f32_16x16x32_bf16 v[68:71], a[196:199], v[148:151], v[68:71]
    s_cselect_b32 s58, 0x40000000, s58
    v_cvt_pk_bf16_f32 v85, v106, v107
    v_rcp_f32 v96, v96
    v_mfma_f32_16x16x32_bf16 v[68:71], a[200:203], v[152:155], v[68:71]
    ds_write_b128 v8, v[220:223] offset:38912
    v_cvt_pk_bf16_f32 v86, v108, v109
    v_exp_f32 v89, v89
    v_mfma_f32_16x16x32_bf16 v[68:71], a[204:207], v[156:159], v[68:71]
    s_cselect_b32 s59, 51712, s59
    v_cvt_pk_bf16_f32 v87, v110, v111
    v_rcp_f32 v97, v97
    v_mfma_f32_16x16x32_bf16 v[68:71], a[208:211], v[160:163], v[68:71]
    s_add_u32 s52, s56, 0
    buffer_store_dwordx4 v[84:87], v1, s[12:15], s52 offen sc1
    v_exp_f32 v90, v90
    v_rcp_f32 v98, v98
    v_mfma_f32_16x16x32_bf16 v[68:71], a[212:215], v[164:167], v[68:71]
    v_exp_f32 v91, v91
    v_mfma_f32_16x16x32_bf16 v[72:75], a[216:219], v[144:147], 0
    ds_write_b128 v8, v[224:227] offset:40960
    v_rcp_f32 v99, v99
    v_mfma_f32_16x16x32_bf16 v[72:75], a[220:223], v[148:151], v[72:75]
    v_exp_f32 v92, v92
    v_mfma_f32_16x16x32_bf16 v[72:75], a[224:227], v[152:155], v[72:75]
    ds_write_b32 v9, v246 offset:256
    v_rcp_f32 v100, v100
    v_mfma_f32_16x16x32_bf16 v[72:75], a[228:231], v[156:159], v[72:75]
    v_exp_f32 v93, v93
    v_mfma_f32_16x16x32_bf16 v[72:75], a[232:235], v[160:163], v[72:75]
    v_rcp_f32 v101, v101
    v_mfma_f32_16x16x32_bf16 v[72:75], a[236:239], v[164:167], v[72:75]
    v_exp_f32 v94, v94
    v_rcp_f32 v102, v102
    v_exp_f32 v95, v95
    v_rcp_f32 v103, v103
    v_pk_mul_f32 v[104:105], v[76:77], v[96:97]
    v_pk_mul_f32 v[106:107], v[78:79], v[98:99]
    v_pk_mul_f32 v[108:109], v[80:81], v[100:101]
    v_pk_mul_f32 v[110:111], v[82:83], v[102:103]
    v_pk_add_f32 v[88:89], v[88:89], 1.0 op_sel_hi:[1,0]
    v_pk_add_f32 v[90:91], v[90:91], 1.0 op_sel_hi:[1,0]
    v_pk_add_f32 v[92:93], v[92:93], 1.0 op_sel_hi:[1,0]
    v_pk_add_f32 v[94:95], v[94:95], 1.0 op_sel_hi:[1,0]
    v_pk_fma_f32 v[28:29], v[104:105], v[104:105], v[28:29]
    v_pk_fma_f32 v[30:31], v[106:107], v[106:107], v[30:31]
    v_pk_fma_f32 v[32:33], v[108:109], v[108:109], v[32:33]
    v_pk_fma_f32 v[34:35], v[110:111], v[110:111], v[34:35]
    v_pk_fma_f32 v[96:97], v[68:69], v[68:69], s[50:51]
    v_pk_fma_f32 v[98:99], v[70:71], v[70:71], s[50:51]
    v_pk_fma_f32 v[100:101], v[72:73], v[72:73], s[50:51]
    v_pk_fma_f32 v[102:103], v[74:75], v[74:75], s[50:51]
    v_pk_mul_f32 v[96:97], v[96:97], v[68:69]
    v_pk_mul_f32 v[98:99], v[98:99], v[70:71]
    v_pk_mul_f32 v[100:101], v[100:101], v[72:73]
    v_pk_mul_f32 v[102:103], v[102:103], v[74:75]
    v_mfma_f32_16x16x32_bf16 v[76:79], a[240:243], v[144:147], 0
    v_cvt_pk_bf16_f32 v84, v104, v105
    v_exp_f32 v96, v96
    v_mfma_f32_16x16x32_bf16 v[76:79], a[244:247], v[148:151], v[76:79]
    v_cvt_pk_bf16_f32 v85, v106, v107
    v_rcp_f32 v88, v88
    v_mfma_f32_16x16x32_bf16 v[76:79], a[248:251], v[152:155], v[76:79]
    v_cvt_pk_bf16_f32 v86, v108, v109
    v_exp_f32 v97, v97
    v_mfma_f32_16x16x32_bf16 v[76:79], a[252:255], v[156:159], v[76:79]
    v_cvt_pk_bf16_f32 v87, v110, v111
    v_rcp_f32 v89, v89
    v_mfma_f32_16x16x32_bf16 v[76:79], v[112:115], v[160:163], v[76:79]
    s_add_u32 s52, s56, 1024
    buffer_store_dwordx4 v[84:87], v1, s[12:15], s52 offen sc1
    v_exp_f32 v98, v98
    v_rcp_f32 v90, v90
    v_mfma_f32_16x16x32_bf16 v[76:79], v[116:119], v[164:167], v[76:79]
    v_exp_f32 v99, v99
    v_mfma_f32_16x16x32_bf16 v[80:83], v[120:123], v[144:147], 0
    ds_read_b128 v[144:147], v4 offset:6144
    v_rcp_f32 v91, v91
    v_mfma_f32_16x16x32_bf16 v[80:83], v[124:127], v[148:151], v[80:83]
    ds_read_b128 v[148:151], v4 offset:8192
    v_exp_f32 v100, v100
    v_mfma_f32_16x16x32_bf16 v[80:83], v[128:131], v[152:155], v[80:83]
    ds_read_b128 v[152:155], v4 offset:10240
    v_rcp_f32 v92, v92
    v_mfma_f32_16x16x32_bf16 v[80:83], v[132:135], v[156:159], v[80:83]
    ds_read_b128 v[156:159], v5 offset:6144
    v_exp_f32 v101, v101
    v_mfma_f32_16x16x32_bf16 v[80:83], v[136:139], v[160:163], v[80:83]
    ds_read_b128 v[160:163], v5 offset:8192
    v_rcp_f32 v93, v93
    v_mfma_f32_16x16x32_bf16 v[80:83], v[140:143], v[164:167], v[80:83]
    ds_read_b128 v[164:167], v5 offset:10240
    v_exp_f32 v102, v102
    v_rcp_f32 v94, v94
    v_exp_f32 v103, v103
    v_rcp_f32 v95, v95
    v_pk_mul_f32 v[104:105], v[60:61], v[88:89]
    v_pk_mul_f32 v[106:107], v[62:63], v[90:91]
    v_pk_mul_f32 v[108:109], v[64:65], v[92:93]
    v_pk_mul_f32 v[110:111], v[66:67], v[94:95]
    v_pk_add_f32 v[96:97], v[96:97], 1.0 op_sel_hi:[1,0]
    v_pk_add_f32 v[98:99], v[98:99], 1.0 op_sel_hi:[1,0]
    v_pk_add_f32 v[100:101], v[100:101], 1.0 op_sel_hi:[1,0]
    v_pk_add_f32 v[102:103], v[102:103], 1.0 op_sel_hi:[1,0]
    v_pk_fma_f32 v[36:37], v[104:105], v[104:105], v[36:37]
    v_pk_fma_f32 v[38:39], v[106:107], v[106:107], v[38:39]
    v_pk_fma_f32 v[40:41], v[108:109], v[108:109], v[40:41]
    v_pk_fma_f32 v[42:43], v[110:111], v[110:111], v[42:43]
    s_waitcnt lgkmcnt(5)
    v_pk_fma_f32 v[88:89], v[76:77], v[76:77], s[50:51]
    v_pk_fma_f32 v[90:91], v[78:79], v[78:79], s[50:51]
    v_pk_fma_f32 v[92:93], v[80:81], v[80:81], s[50:51]
    v_pk_fma_f32 v[94:95], v[82:83], v[82:83], s[50:51]
    v_pk_mul_f32 v[88:89], v[88:89], v[76:77]
    v_pk_mul_f32 v[90:91], v[90:91], v[78:79]
    v_pk_mul_f32 v[92:93], v[92:93], v[80:81]
    v_pk_mul_f32 v[94:95], v[94:95], v[82:83]
    v_mfma_f32_16x16x32_bf16 v[60:63], a[0:3], v[144:147], 0
    s_waitcnt lgkmcnt(4)
    v_cvt_pk_bf16_f32 v84, v104, v105
    v_exp_f32 v88, v88
    v_mfma_f32_16x16x32_bf16 v[60:63], a[4:7], v[148:151], v[60:63]
    s_waitcnt lgkmcnt(3)
    v_cvt_pk_bf16_f32 v85, v106, v107
    v_rcp_f32 v96, v96
    v_mfma_f32_16x16x32_bf16 v[60:63], a[8:11], v[152:155], v[60:63]
    s_waitcnt lgkmcnt(2)
    v_cvt_pk_bf16_f32 v86, v108, v109
    v_exp_f32 v89, v89
    v_mfma_f32_16x16x32_bf16 v[60:63], a[12:15], v[156:159], v[60:63]
    s_waitcnt lgkmcnt(0)
    v_cvt_pk_bf16_f32 v87, v110, v111
    v_rcp_f32 v97, v97
    v_mfma_f32_16x16x32_bf16 v[60:63], a[16:19], v[160:163], v[60:63]
    s_add_u32 s52, s56, 2048
    buffer_store_dwordx4 v[84:87], v1, s[12:15], s52 offen sc1
    v_exp_f32 v90, v90
    v_rcp_f32 v98, v98
    v_mfma_f32_16x16x32_bf16 v[60:63], a[20:23], v[164:167], v[60:63]
    v_exp_f32 v91, v91
    v_mfma_f32_16x16x32_bf16 v[64:67], a[24:27], v[144:147], 0
    v_rcp_f32 v99, v99
    v_mfma_f32_16x16x32_bf16 v[64:67], a[28:31], v[148:151], v[64:67]
    v_exp_f32 v92, v92
    v_mfma_f32_16x16x32_bf16 v[64:67], a[32:35], v[152:155], v[64:67]
    v_rcp_f32 v100, v100
    v_mfma_f32_16x16x32_bf16 v[64:67], a[36:39], v[156:159], v[64:67]
    v_add_u32 v253, 1, v253
    v_exp_f32 v93, v93
    v_mfma_f32_16x16x32_bf16 v[64:67], a[40:43], v[160:163], v[64:67]
    v_rcp_f32 v101, v101
    v_mfma_f32_16x16x32_bf16 v[64:67], a[44:47], v[164:167], v[64:67]
    ds_write_b32 v252, v253 offset:51584
    v_exp_f32 v94, v94
    v_rcp_f32 v102, v102
    v_exp_f32 v95, v95
    v_rcp_f32 v103, v103
    v_pk_mul_f32 v[104:105], v[68:69], v[96:97]
    v_pk_mul_f32 v[106:107], v[70:71], v[98:99]
    v_pk_mul_f32 v[108:109], v[72:73], v[100:101]
    v_pk_mul_f32 v[110:111], v[74:75], v[102:103]
    v_pk_add_f32 v[88:89], v[88:89], 1.0 op_sel_hi:[1,0]
    v_pk_add_f32 v[90:91], v[90:91], 1.0 op_sel_hi:[1,0]
    v_pk_add_f32 v[92:93], v[92:93], 1.0 op_sel_hi:[1,0]
    v_pk_add_f32 v[94:95], v[94:95], 1.0 op_sel_hi:[1,0]
    v_pk_fma_f32 v[44:45], v[104:105], v[104:105], v[44:45]
    v_pk_fma_f32 v[46:47], v[106:107], v[106:107], v[46:47]
    v_pk_fma_f32 v[48:49], v[108:109], v[108:109], v[48:49]
    v_pk_fma_f32 v[50:51], v[110:111], v[110:111], v[50:51]
    v_pk_fma_f32 v[96:97], v[60:61], v[60:61], s[50:51]
    v_pk_fma_f32 v[98:99], v[62:63], v[62:63], s[50:51]
    v_pk_fma_f32 v[100:101], v[64:65], v[64:65], s[50:51]
    v_pk_fma_f32 v[102:103], v[66:67], v[66:67], s[50:51]
    v_pk_mul_f32 v[96:97], v[96:97], v[60:61]
    v_pk_mul_f32 v[98:99], v[98:99], v[62:63]
    v_pk_mul_f32 v[100:101], v[100:101], v[64:65]
    v_pk_mul_f32 v[102:103], v[102:103], v[66:67]
    v_mfma_f32_16x16x32_bf16 v[68:71], a[48:51], v[144:147], 0
    s_mov_b32 m0, s83
    v_cvt_pk_bf16_f32 v84, v104, v105
    v_exp_f32 v96, v96
    v_mfma_f32_16x16x32_bf16 v[68:71], a[52:55], v[148:151], v[68:71]
    buffer_load_dwordx4 v1, s[12:15], s82 offen offset:0  lds
    v_cvt_pk_bf16_f32 v85, v106, v107
    v_rcp_f32 v88, v88
    v_mfma_f32_16x16x32_bf16 v[68:71], a[56:59], v[152:155], v[68:71]
    v_cvt_pk_bf16_f32 v86, v108, v109
    v_exp_f32 v97, v97
    v_mfma_f32_16x16x32_bf16 v[68:71], a[60:63], v[156:159], v[68:71]
    v_cvt_pk_bf16_f32 v87, v110, v111
    v_rcp_f32 v89, v89
    v_mfma_f32_16x16x32_bf16 v[68:71], a[64:67], v[160:163], v[68:71]
    s_add_u32 s52, s56, 3072
    buffer_store_dwordx4 v[84:87], v1, s[12:15], s52 offen sc1
    v_exp_f32 v98, v98
    v_rcp_f32 v90, v90
    v_mfma_f32_16x16x32_bf16 v[68:71], a[68:71], v[164:167], v[68:71]
    v_exp_f32 v99, v99
    v_mfma_f32_16x16x32_bf16 v[72:75], a[72:75], v[144:147], 0
    buffer_load_dwordx4 v1, s[12:15], s82 offen offset:1024  lds
    v_rcp_f32 v91, v91
    v_mfma_f32_16x16x32_bf16 v[72:75], a[76:79], v[148:151], v[72:75]
    v_exp_f32 v100, v100
    v_mfma_f32_16x16x32_bf16 v[72:75], a[80:83], v[152:155], v[72:75]
    v_rcp_f32 v92, v92
    v_mfma_f32_16x16x32_bf16 v[72:75], a[84:87], v[156:159], v[72:75]
    buffer_load_dwordx4 v1, s[12:15], s82 offen offset:2048  lds
    v_exp_f32 v101, v101
    v_mfma_f32_16x16x32_bf16 v[72:75], a[88:91], v[160:163], v[72:75]
    s_add_u32 m0, m0, 3072
    v_rcp_f32 v93, v93
    v_mfma_f32_16x16x32_bf16 v[72:75], a[92:95], v[164:167], v[72:75]
    s_add_u32 s82, s82, 3072
    v_exp_f32 v102, v102
    v_rcp_f32 v94, v94
    v_exp_f32 v103, v103
    v_rcp_f32 v95, v95
    v_pk_mul_f32 v[104:105], v[76:77], v[88:89]
    v_pk_mul_f32 v[106:107], v[78:79], v[90:91]
    v_pk_mul_f32 v[108:109], v[80:81], v[92:93]
    v_pk_mul_f32 v[110:111], v[82:83], v[94:95]
    v_pk_add_f32 v[96:97], v[96:97], 1.0 op_sel_hi:[1,0]
    v_pk_add_f32 v[98:99], v[98:99], 1.0 op_sel_hi:[1,0]
    v_pk_add_f32 v[100:101], v[100:101], 1.0 op_sel_hi:[1,0]
    v_pk_add_f32 v[102:103], v[102:103], 1.0 op_sel_hi:[1,0]
    v_pk_fma_f32 v[52:53], v[104:105], v[104:105], v[52:53]
    v_pk_fma_f32 v[54:55], v[106:107], v[106:107], v[54:55]
    v_pk_fma_f32 v[56:57], v[108:109], v[108:109], v[56:57]
    v_pk_fma_f32 v[58:59], v[110:111], v[110:111], v[58:59]
    v_pk_fma_f32 v[88:89], v[68:69], v[68:69], s[50:51]
    v_pk_fma_f32 v[90:91], v[70:71], v[70:71], s[50:51]
    v_pk_fma_f32 v[92:93], v[72:73], v[72:73], s[50:51]
    v_pk_fma_f32 v[94:95], v[74:75], v[74:75], s[50:51]
    v_pk_mul_f32 v[88:89], v[88:89], v[68:69]
    v_pk_mul_f32 v[90:91], v[90:91], v[70:71]
    v_pk_mul_f32 v[92:93], v[92:93], v[72:73]
    v_pk_mul_f32 v[94:95], v[94:95], v[74:75]
    v_mfma_f32_16x16x32_bf16 v[76:79], a[96:99], v[144:147], 0
    v_cvt_pk_bf16_f32 v84, v104, v105
    v_exp_f32 v88, v88
    v_mfma_f32_16x16x32_bf16 v[76:79], a[100:103], v[148:151], v[76:79]
    buffer_load_dwordx4 v1, s[12:15], s82 offen offset:0  lds
    v_cvt_pk_bf16_f32 v85, v106, v107
    v_rcp_f32 v96, v96
    v_mfma_f32_16x16x32_bf16 v[76:79], a[104:107], v[152:155], v[76:79]
    v_cvt_pk_bf16_f32 v86, v108, v109
    v_exp_f32 v89, v89
    v_mfma_f32_16x16x32_bf16 v[76:79], a[108:111], v[156:159], v[76:79]
    v_cvt_pk_bf16_f32 v87, v110, v111
    v_rcp_f32 v97, v97
    v_mfma_f32_16x16x32_bf16 v[76:79], a[112:115], v[160:163], v[76:79]
    s_add_u32 s52, s56, 4096
    buffer_store_dwordx4 v[84:87], v1, s[12:15], s52 offen sc1
    v_exp_f32 v90, v90
    v_rcp_f32 v98, v98
    v_mfma_f32_16x16x32_bf16 v[76:79], a[116:119], v[164:167], v[76:79]
    v_exp_f32 v91, v91
    v_mfma_f32_16x16x32_bf16 v[80:83], a[120:123], v[144:147], 0
    s_add_u32 s56, s56, 36864
    v_rcp_f32 v99, v99
    v_mfma_f32_16x16x32_bf16 v[80:83], a[124:127], v[148:151], v[80:83]
    v_exp_f32 v92, v92
    v_mfma_f32_16x16x32_bf16 v[80:83], a[128:131], v[152:155], v[80:83]
    buffer_load_dwordx4 v1, s[12:15], s82 offen offset:1024  lds
    v_rcp_f32 v100, v100
    v_mfma_f32_16x16x32_bf16 v[80:83], a[132:135], v[156:159], v[80:83]
    v_exp_f32 v93, v93
    v_mfma_f32_16x16x32_bf16 v[80:83], a[136:139], v[160:163], v[80:83]
    v_rcp_f32 v101, v101
    v_mfma_f32_16x16x32_bf16 v[80:83], a[140:143], v[164:167], v[80:83]
    v_exp_f32 v94, v94
    v_rcp_f32 v102, v102
    v_exp_f32 v95, v95
    v_rcp_f32 v103, v103
    v_pk_mul_f32 v[104:105], v[60:61], v[96:97]
    v_pk_mul_f32 v[106:107], v[62:63], v[98:99]
    v_pk_mul_f32 v[108:109], v[64:65], v[100:101]
    v_pk_mul_f32 v[110:111], v[66:67], v[102:103]
    v_pk_add_f32 v[88:89], v[88:89], 1.0 op_sel_hi:[1,0]
    v_pk_add_f32 v[90:91], v[90:91], 1.0 op_sel_hi:[1,0]
    v_pk_add_f32 v[92:93], v[92:93], 1.0 op_sel_hi:[1,0]
    v_pk_add_f32 v[94:95], v[94:95], 1.0 op_sel_hi:[1,0]
    v_pk_fma_f32 v[12:13], v[104:105], v[104:105], v[12:13]
    v_pk_fma_f32 v[14:15], v[106:107], v[106:107], v[14:15]
    v_pk_fma_f32 v[16:17], v[108:109], v[108:109], v[16:17]
    v_pk_fma_f32 v[18:19], v[110:111], v[110:111], v[18:19]
    v_pk_fma_f32 v[96:97], v[76:77], v[76:77], s[50:51]
    v_pk_fma_f32 v[98:99], v[78:79], v[78:79], s[50:51]
    v_pk_fma_f32 v[100:101], v[80:81], v[80:81], s[50:51]
    v_pk_fma_f32 v[102:103], v[82:83], v[82:83], s[50:51]
    v_pk_mul_f32 v[96:97], v[96:97], v[76:77]
    v_pk_mul_f32 v[98:99], v[98:99], v[78:79]
    v_pk_mul_f32 v[100:101], v[100:101], v[80:81]
    v_pk_mul_f32 v[102:103], v[102:103], v[82:83]
    v_mfma_f32_16x16x32_bf16 v[60:63], a[144:147], v[144:147], 0
    s_cmp_eq_u32 s54, 8
    v_exp_f32 v96, v96
    v_mfma_f32_16x16x32_bf16 v[60:63], a[148:151], v[148:151], v[60:63]
    s_cselect_b32 s26, s76, 0
    v_rcp_f32 v88, v88
    v_mfma_f32_16x16x32_bf16 v[60:63], a[152:155], v[152:155], v[60:63]
    s_waitcnt vmcnt(19)
    buffer_atomic_add v251, v1, s[24:27], 0 offen
    v_exp_f32 v97, v97
    v_mfma_f32_16x16x32_bf16 v[60:63], a[156:159], v[156:159], v[60:63]
    v_rcp_f32 v89, v89
    v_mfma_f32_16x16x32_bf16 v[60:63], a[160:163], v[160:163], v[60:63]
    v_exp_f32 v98, v98
    v_mfma_f32_16x16x32_bf16 v[60:63], a[164:167], v[164:167], v[60:63]
    v_rcp_f32 v90, v90
    v_mfma_f32_16x16x32_bf16 v[64:67], a[168:171], v[144:147], 0
    v_exp_f32 v99, v99
    v_mfma_f32_16x16x32_bf16 v[64:67], a[172:175], v[148:151], v[64:67]
    v_rcp_f32 v91, v91
    v_mfma_f32_16x16x32_bf16 v[64:67], a[176:179], v[152:155], v[64:67]
    v_exp_f32 v100, v100
    v_mfma_f32_16x16x32_bf16 v[64:67], a[180:183], v[156:159], v[64:67]
    v_rcp_f32 v92, v92
    v_mfma_f32_16x16x32_bf16 v[64:67], a[184:187], v[160:163], v[64:67]
    v_exp_f32 v101, v101
    v_mfma_f32_16x16x32_bf16 v[64:67], a[188:191], v[164:167], v[64:67]
    v_rcp_f32 v93, v93
    v_exp_f32 v102, v102
    v_rcp_f32 v94, v94
    v_exp_f32 v103, v103
    v_rcp_f32 v95, v95
    v_pk_mul_f32 v[104:105], v[68:69], v[88:89]
    v_pk_mul_f32 v[106:107], v[70:71], v[90:91]
    v_pk_mul_f32 v[108:109], v[72:73], v[92:93]
    v_pk_mul_f32 v[110:111], v[74:75], v[94:95]
    v_pk_add_f32 v[96:97], v[96:97], 1.0 op_sel_hi:[1,0]
    v_pk_add_f32 v[98:99], v[98:99], 1.0 op_sel_hi:[1,0]
    v_pk_add_f32 v[100:101], v[100:101], 1.0 op_sel_hi:[1,0]
    v_pk_add_f32 v[102:103], v[102:103], 1.0 op_sel_hi:[1,0]
    v_pk_fma_f32 v[20:21], v[104:105], v[104:105], v[20:21]
    v_pk_fma_f32 v[22:23], v[106:107], v[106:107], v[22:23]
    v_pk_fma_f32 v[24:25], v[108:109], v[108:109], v[24:25]
    v_pk_fma_f32 v[26:27], v[110:111], v[110:111], v[26:27]
    v_pk_fma_f32 v[88:89], v[60:61], v[60:61], s[50:51]
    v_pk_fma_f32 v[90:91], v[62:63], v[62:63], s[50:51]
    v_pk_fma_f32 v[92:93], v[64:65], v[64:65], s[50:51]
    v_pk_fma_f32 v[94:95], v[66:67], v[66:67], s[50:51]
    v_pk_mul_f32 v[88:89], v[88:89], v[60:61]
    v_pk_mul_f32 v[90:91], v[90:91], v[62:63]
    v_pk_mul_f32 v[92:93], v[92:93], v[64:65]
    v_pk_mul_f32 v[94:95], v[94:95], v[66:67]
    v_mfma_f32_16x16x32_bf16 v[68:71], a[192:195], v[144:147], 0
    v_exp_f32 v88, v88
    v_mfma_f32_16x16x32_bf16 v[68:71], a[196:199], v[148:151], v[68:71]
    v_rcp_f32 v96, v96
    v_mfma_f32_16x16x32_bf16 v[68:71], a[200:203], v[152:155], v[68:71]
    s_mov_b64 s[82:83], s[84:85]
    v_exp_f32 v89, v89
    v_mfma_f32_16x16x32_bf16 v[68:71], a[204:207], v[156:159], v[68:71]
    s_mov_b64 s[84:85], s[86:87]
    v_rcp_f32 v97, v97
    v_mfma_f32_16x16x32_bf16 v[68:71], a[208:211], v[160:163], v[68:71]
    v_exp_f32 v90, v90
    v_mfma_f32_16x16x32_bf16 v[68:71], a[212:215], v[164:167], v[68:71]
    s_mov_b64 s[86:87], s[88:89]
    v_rcp_f32 v98, v98
    v_mfma_f32_16x16x32_bf16 v[72:75], a[216:219], v[144:147], 0
    s_mov_b64 s[88:89], s[90:91]
    v_exp_f32 v91, v91
    v_mfma_f32_16x16x32_bf16 v[72:75], a[220:223], v[148:151], v[72:75]
    s_mov_b64 s[90:91], s[92:93]
    v_rcp_f32 v99, v99
    v_mfma_f32_16x16x32_bf16 v[72:75], a[224:227], v[152:155], v[72:75]
    s_mov_b64 s[92:93], s[94:95]
    v_exp_f32 v92, v92
    v_mfma_f32_16x16x32_bf16 v[72:75], a[228:231], v[156:159], v[72:75]
    ds_read_b32 v248, v249 offset:51584
    v_rcp_f32 v100, v100
    v_mfma_f32_16x16x32_bf16 v[72:75], a[232:235], v[160:163], v[72:75]
    s_mov_b64 s[94:95], s[96:97]
    v_exp_f32 v93, v93
    v_mfma_f32_16x16x32_bf16 v[72:75], a[236:239], v[164:167], v[72:75]
    v_rcp_f32 v101, v101
    v_exp_f32 v94, v94
    v_rcp_f32 v102, v102
    v_exp_f32 v95, v95
    v_rcp_f32 v103, v103
    v_pk_mul_f32 v[104:105], v[76:77], v[96:97]
    v_pk_mul_f32 v[106:107], v[78:79], v[98:99]
    v_pk_mul_f32 v[108:109], v[80:81], v[100:101]
    v_pk_mul_f32 v[110:111], v[82:83], v[102:103]
    v_pk_add_f32 v[88:89], v[88:89], 1.0 op_sel_hi:[1,0]
    v_pk_add_f32 v[90:91], v[90:91], 1.0 op_sel_hi:[1,0]
    v_pk_add_f32 v[92:93], v[92:93], 1.0 op_sel_hi:[1,0]
    v_pk_add_f32 v[94:95], v[94:95], 1.0 op_sel_hi:[1,0]
    v_pk_fma_f32 v[28:29], v[104:105], v[104:105], v[28:29]
    v_pk_fma_f32 v[30:31], v[106:107], v[106:107], v[30:31]
    v_pk_fma_f32 v[32:33], v[108:109], v[108:109], v[32:33]
    v_pk_fma_f32 v[34:35], v[110:111], v[110:111], v[34:35]
    v_pk_fma_f32 v[96:97], v[68:69], v[68:69], s[50:51]
    v_pk_fma_f32 v[98:99], v[70:71], v[70:71], s[50:51]
    v_pk_fma_f32 v[100:101], v[72:73], v[72:73], s[50:51]
    v_pk_fma_f32 v[102:103], v[74:75], v[74:75], s[50:51]
    v_pk_mul_f32 v[96:97], v[96:97], v[68:69]
    v_pk_mul_f32 v[98:99], v[98:99], v[70:71]
    v_pk_mul_f32 v[100:101], v[100:101], v[72:73]
    v_pk_mul_f32 v[102:103], v[102:103], v[74:75]
    v_mfma_f32_16x16x32_bf16 v[76:79], a[240:243], v[144:147], 0
    v_cvt_pk_bf16_f32 v84, v104, v105
    v_exp_f32 v96, v96
    v_mfma_f32_16x16x32_bf16 v[76:79], a[244:247], v[148:151], v[76:79]
    s_waitcnt lgkmcnt(0)
    v_cvt_pk_bf16_f32 v85, v106, v107
    v_cmp_lt_u32 vcc, v248, v253
    v_rcp_f32 v88, v88
    v_mfma_f32_16x16x32_bf16 v[76:79], a[248:251], v[152:155], v[76:79]
    v_cvt_pk_bf16_f32 v86, v108, v109
    v_exp_f32 v97, v97
    v_mfma_f32_16x16x32_bf16 v[76:79], a[252:255], v[156:159], v[76:79]
    s_cbranch_vccnz L_flag1
L_flag1_ret:
    v_cvt_pk_bf16_f32 v87, v110, v111
    v_rcp_f32 v89, v89
    v_mfma_f32_16x16x32_bf16 v[76:79], v[112:115], v[160:163], v[76:79]
    s_add_u32 s52, s57, 0
    buffer_store_dwordx4 v[84:87], v1, s[12:15], s52 offen sc1
    v_exp_f32 v98, v98
    v_rcp_f32 v90, v90
    v_mfma_f32_16x16x32_bf16 v[76:79], v[116:119], v[164:167], v[76:79]
    v_add_u32 v9, 256, v9
    v_exp_f32 v99, v99
    v_mfma_f32_16x16x32_bf16 v[80:83], v[120:123], v[144:147], 0
    ds_read_b128 v[144:147], v2 offset:36864
    v_rcp_f32 v91, v91
    v_mfma_f32_16x16x32_bf16 v[80:83], v[124:127], v[148:151], v[80:83]
    ds_read_b128 v[148:151], v2 offset:38912
    v_exp_f32 v100, v100
    v_mfma_f32_16x16x32_bf16 v[80:83], v[128:131], v[152:155], v[80:83]
    ds_read_b128 v[152:155], v2 offset:40960
    v_rcp_f32 v92, v92
    v_mfma_f32_16x16x32_bf16 v[80:83], v[132:135], v[156:159], v[80:83]
    ds_read_b128 v[156:159], v3 offset:36864
    v_exp_f32 v101, v101
    v_mfma_f32_16x16x32_bf16 v[80:83], v[136:139], v[160:163], v[80:83]
    ds_read_b128 v[160:163], v3 offset:38912
    v_rcp_f32 v93, v93
    v_mfma_f32_16x16x32_bf16 v[80:83], v[140:143], v[164:167], v[80:83]
    ds_read_b128 v[164:167], v3 offset:40960
    v_exp_f32 v102, v102
    v_rcp_f32 v94, v94
    v_exp_f32 v103, v103
    v_rcp_f32 v95, v95
    v_pk_mul_f32 v[104:105], v[60:61], v[88:89]
    v_pk_mul_f32 v[106:107], v[62:63], v[90:91]
    v_pk_mul_f32 v[108:109], v[64:65], v[92:93]
    v_pk_mul_f32 v[110:111], v[66:67], v[94:95]
    v_pk_add_f32 v[96:97], v[96:97], 1.0 op_sel_hi:[1,0]
    v_pk_add_f32 v[98:99], v[98:99], 1.0 op_sel_hi:[1,0]
    v_pk_add_f32 v[100:101], v[100:101], 1.0 op_sel_hi:[1,0]
    v_pk_add_f32 v[102:103], v[102:103], 1.0 op_sel_hi:[1,0]
    v_pk_fma_f32 v[36:37], v[104:105], v[104:105], v[36:37]
    v_pk_fma_f32 v[38:39], v[106:107], v[106:107], v[38:39]
    v_pk_fma_f32 v[40:41], v[108:109], v[108:109], v[40:41]
    v_pk_fma_f32 v[42:43], v[110:111], v[110:111], v[42:43]
    s_waitcnt lgkmcnt(5)
    v_pk_fma_f32 v[88:89], v[76:77], v[76:77], s[50:51]
    v_pk_fma_f32 v[90:91], v[78:79], v[78:79], s[50:51]
    v_pk_fma_f32 v[92:93], v[80:81], v[80:81], s[50:51]
    v_pk_fma_f32 v[94:95], v[82:83], v[82:83], s[50:51]
    v_pk_mul_f32 v[88:89], v[88:89], v[76:77]
    v_pk_mul_f32 v[90:91], v[90:91], v[78:79]
    v_pk_mul_f32 v[92:93], v[92:93], v[80:81]
    v_pk_mul_f32 v[94:95], v[94:95], v[82:83]
    s_branch L_p1
L_last:
    s_waitcnt vmcnt(3)
    s_mov_b32 s54, 65536
    v_readfirstlane_b32 s52, v7
L_init:
    s_cmp_lt_u32 s52, 348
    s_cbranch_scc1 L_init_spin
L_init_ok:
    v_mfma_f32_16x16x32_bf16 v[60:63], a[0:3], v[144:147], 0
    s_waitcnt lgkmcnt(4)
    v_cvt_pk_bf16_f32 v84, v104, v105
    v_exp_f32 v88, v88
    v_mfma_f32_16x16x32_bf16 v[60:63], a[4:7], v[148:151], v[60:63]
    s_waitcnt lgkmcnt(3)
    v_cvt_pk_bf16_f32 v85, v106, v107
    v_rcp_f32 v96, v96
    v_mfma_f32_16x16x32_bf16 v[60:63], a[8:11], v[152:155], v[60:63]
    s_waitcnt lgkmcnt(2)
    v_cvt_pk_bf16_f32 v86, v108, v109
    v_exp_f32 v89, v89
    v_mfma_f32_16x16x32_bf16 v[60:63], a[12:15], v[156:159], v[60:63]
    s_waitcnt lgkmcnt(0)
    v_cvt_pk_bf16_f32 v87, v110, v111
    v_rcp_f32 v97, v97
    v_mfma_f32_16x16x32_bf16 v[60:63], a[16:19], v[160:163], v[60:63]
    s_add_u32 s52, s57, 1024
    buffer_store_dwordx4 v[84:87], v1, s[12:15], s52 offen sc1
    v_exp_f32 v90, v90
    v_rcp_f32 v98, v98
    v_mfma_f32_16x16x32_bf16 v[60:63], a[20:23], v[164:167], v[60:63]
    ds_read_b128 v[216:219], v4 offset:6144
    v_exp_f32 v91, v91
    v_mfma_f32_16x16x32_bf16 v[64:67], a[24:27], v[144:147], 0
    ds_read_b128 v[220:223], v4 offset:8192
    v_rcp_f32 v99, v99
    v_mfma_f32_16x16x32_bf16 v[64:67], a[28:31], v[148:151], v[64:67]
    ds_read_b128 v[224:227], v4 offset:10240
    s_lshl_b32 s53, s73, 10
    v_add_u32 v240, s53, v1
    s_add_u32 m0, s53, 43008
    s_mov_b32 s20, s42
    s_mov_b32 s21, s43
    s_mov_b32 s22, 1536
    v_exp_f32 v92, v92
    v_mfma_f32_16x16x32_bf16 v[64:67], a[32:35], v[152:155], v[64:67]
    buffer_load_dwordx4 v240, s[20:23], 0 offen lds
    v_rcp_f32 v100, v100
    v_mfma_f32_16x16x32_bf16 v[64:67], a[36:39], v[156:159], v[64:67]
    ds_read_b128 v[228:231], v5 offset:6144
    v_exp_f32 v93, v93
    v_mfma_f32_16x16x32_bf16 v[64:67], a[40:43], v[160:163], v[64:67]
    ds_read_b128 v[232:235], v5 offset:8192
    v_rcp_f32 v101, v101
    v_mfma_f32_16x16x32_bf16 v[64:67], a[44:47], v[164:167], v[64:67]
    ds_read_b128 v[236:239], v5 offset:10240
    v_exp_f32 v94, v94
    v_rcp_f32 v102, v102
    v_exp_f32 v95, v95
    v_rcp_f32 v103, v103
    v_pk_mul_f32 v[104:105], v[68:69], v[96:97]
    v_pk_mul_f32 v[106:107], v[70:71], v[98:99]
    v_pk_mul_f32 v[108:109], v[72:73], v[100:101]
    v_pk_mul_f32 v[110:111], v[74:75], v[102:103]
    v_pk_add_f32 v[88:89], v[88:89], 1.0 op_sel_hi:[1,0]
    v_pk_add_f32 v[90:91], v[90:91], 1.0 op_sel_hi:[1,0]
    v_pk_add_f32 v[92:93], v[92:93], 1.0 op_sel_hi:[1,0]
    v_pk_add_f32 v[94:95], v[94:95], 1.0 op_sel_hi:[1,0]
    v_pk_fma_f32 v[44:45], v[104:105], v[104:105], v[44:45]
    v_pk_fma_f32 v[46:47], v[106:107], v[106:107], v[46:47]
    v_pk_fma_f32 v[48:49], v[108:109], v[108:109], v[48:49]
    v_pk_fma_f32 v[50:51], v[110:111], v[110:111], v[50:51]
    s_waitcnt vmcnt(63) lgkmcnt(0)
    v_pk_fma_f32 v[96:97], v[60:61], v[60:61], s[50:51]
    v_pk_fma_f32 v[98:99], v[62:63], v[62:63], s[50:51]
    v_pk_fma_f32 v[100:101], v[64:65], v[64:65], s[50:51]
    v_pk_fma_f32 v[102:103], v[66:67], v[66:67], s[50:51]
    v_pk_mul_f32 v[96:97], v[96:97], v[60:61]
    v_pk_mul_f32 v[98:99], v[98:99], v[62:63]
    v_pk_mul_f32 v[100:101], v[100:101], v[64:65]
    v_pk_mul_f32 v[102:103], v[102:103], v[66:67]
    v_mfma_f32_16x16x32_bf16 v[68:71], a[0:3], v[216:219], 0
    v_cvt_pk_bf16_f32 v84, v104, v105
    v_exp_f32 v96, v96
    v_mfma_f32_16x16x32_bf16 v[68:71], a[4:7], v[220:223], v[68:71]
    s_add_u32 s53, s80, 52224
    buffer_load_dwordx4 v[172:175], v1, s[16:19], s53 offen sc1
    v_cvt_pk_bf16_f32 v85, v106, v107
    v_rcp_f32 v88, v88
    v_mfma_f32_16x16x32_bf16 v[68:71], a[8:11], v[224:227], v[68:71]
    v_cvt_pk_bf16_f32 v86, v108, v109
    v_exp_f32 v97, v97
    v_mfma_f32_16x16x32_bf16 v[68:71], a[12:15], v[228:231], v[68:71]
    v_cvt_pk_bf16_f32 v87, v110, v111
    v_rcp_f32 v89, v89
    v_mfma_f32_16x16x32_bf16 v[68:71], a[16:19], v[232:235], v[68:71]
    s_add_u32 s52, s57, 2048
    buffer_store_dwordx4 v[84:87], v1, s[12:15], s52 offen sc1
    v_exp_f32 v98, v98
    v_rcp_f32 v90, v90
    v_mfma_f32_16x16x32_bf16 v[68:71], a[20:23], v[236:239], v[68:71]
    v_exp_f32 v99, v99
    v_mfma_f32_16x16x32_bf16 v[72:75], a[24:27], v[216:219], 0
    v_rcp_f32 v91, v91
    v_mfma_f32_16x16x32_bf16 v[72:75], a[28:31], v[220:223], v[72:75]
    s_add_u32 s53, s80, 53248
    buffer_load_dwordx4 v[176:179], v1, s[16:19], s53 offen sc1
    v_exp_f32 v100, v100
    v_mfma_f32_16x16x32_bf16 v[72:75], a[32:35], v[224:227], v[72:75]
    v_rcp_f32 v92, v92
    v_mfma_f32_16x16x32_bf16 v[72:75], a[36:39], v[228:231], v[72:75]
    v_exp_f32 v101, v101
    v_mfma_f32_16x16x32_bf16 v[72:75], a[40:43], v[232:235], v[72:75]
    s_add_u32 s53, s80, 54272
    buffer_load_dwordx4 v[180:183], v1, s[16:19], s53 offen sc1
    v_rcp_f32 v93, v93
    v_mfma_f32_16x16x32_bf16 v[72:75], a[44:47], v[236:239], v[72:75]
    v_exp_f32 v102, v102
    v_rcp_f32 v94, v94
    v_exp_f32 v103, v103
    v_rcp_f32 v95, v95
    v_pk_mul_f32 v[104:105], v[76:77], v[88:89]
    v_pk_mul_f32 v[106:107], v[78:79], v[90:91]
    v_pk_mul_f32 v[108:109], v[80:81], v[92:93]
    v_pk_mul_f32 v[110:111], v[82:83], v[94:95]
    v_pk_add_f32 v[96:97], v[96:97], 1.0 op_sel_hi:[1,0]
    v_pk_add_f32 v[98:99], v[98:99], 1.0 op_sel_hi:[1,0]
    v_pk_add_f32 v[100:101], v[100:101], 1.0 op_sel_hi:[1,0]
    v_pk_add_f32 v[102:103], v[102:103], 1.0 op_sel_hi:[1,0]
    v_pk_fma_f32 v[52:53], v[104:105], v[104:105], v[52:53]
    v_pk_fma_f32 v[54:55], v[106:107], v[106:107], v[54:55]
    v_pk_fma_f32 v[56:57], v[108:109], v[108:109], v[56:57]
    v_pk_fma_f32 v[58:59], v[110:111], v[110:111], v[58:59]
    v_pk_fma_f32 v[88:89], v[68:69], v[68:69], s[50:51]
    v_pk_fma_f32 v[90:91], v[70:71], v[70:71], s[50:51]
    v_pk_fma_f32 v[92:93], v[72:73], v[72:73], s[50:51]
    v_pk_fma_f32 v[94:95], v[74:75], v[74:75], s[50:51]
    v_pk_mul_f32 v[88:89], v[88:89], v[68:69]
    v_pk_mul_f32 v[90:91], v[90:91], v[70:71]
    v_pk_mul_f32 v[92:93], v[92:93], v[72:73]
    v_pk_mul_f32 v[94:95], v[94:95], v[74:75]
    v_mfma_f32_16x16x32_bf16 v[76:79], a[48:51], v[144:147], 0
    v_cvt_pk_bf16_f32 v84, v104, v105
    v_exp_f32 v88, v88
    v_mfma_f32_16x16x32_bf16 v[76:79], a[52:55], v[148:151], v[76:79]
    s_add_u32 s53, s81, 0
    buffer_load_dwordx4 a[0:3], v1, s[16:19], s53 offen sc1
    v_cvt_pk_bf16_f32 v85, v106, v107
    v_rcp_f32 v96, v96
    v_mfma_f32_16x16x32_bf16 v[76:79], a[56:59], v[152:155], v[76:79]
    v_cvt_pk_bf16_f32 v86, v108, v109
    v_exp_f32 v89, v89
    v_mfma_f32_16x16x32_bf16 v[76:79], a[60:63], v[156:159], v[76:79]
    v_cvt_pk_bf16_f32 v87, v110, v111
    v_rcp_f32 v97, v97
    v_mfma_f32_16x16x32_bf16 v[76:79], a[64:67], v[160:163], v[76:79]
    s_add_u32 s52, s57, 3072
    buffer_store_dwordx4 v[84:87], v1, s[12:15], s52 offen sc1
    v_exp_f32 v90, v90
    v_rcp_f32 v98, v98
    v_mfma_f32_16x16x32_bf16 v[76:79], a[68:71], v[164:167], v[76:79]
    s_add_u32 s57, s57, 36864
    v_exp_f32 v91, v91
    v_mfma_f32_16x16x32_bf16 v[80:83], a[72:75], v[144:147], 0
    v_rcp_f32 v99, v99
    v_mfma_f32_16x16x32_bf16 v[80:83], a[76:79], v[148:151], v[80:83]
    s_add_u32 s53, s81, 1024
    buffer_load_dwordx4 a[4:7], v1, s[16:19], s53 offen sc1
    v_exp_f32 v92, v92
    v_mfma_f32_16x16x32_bf16 v[80:83], a[80:83], v[152:155], v[80:83]
    v_rcp_f32 v100, v100
    v_mfma_f32_16x16x32_bf16 v[80:83], a[84:87], v[156:159], v[80:83]
    v_exp_f32 v93, v93
    v_mfma_f32_16x16x32_bf16 v[80:83], a[88:91], v[160:163], v[80:83]
    s_add_u32 s53, s81, 2048
    buffer_load_dwordx4 a[8:11], v1, s[16:19], s53 offen sc1
    v_rcp_f32 v101, v101
    v_mfma_f32_16x16x32_bf16 v[80:83], a[92:95], v[164:167], v[80:83]
    v_exp_f32 v94, v94
    v_rcp_f32 v102, v102
    v_exp_f32 v95, v95
    v_rcp_f32 v103, v103
    v_pk_mul_f32 v[104:105], v[60:61], v[96:97]
    v_pk_mul_f32 v[106:107], v[62:63], v[98:99]
    v_pk_mul_f32 v[108:109], v[64:65], v[100:101]
    v_pk_mul_f32 v[110:111], v[66:67], v[102:103]
    v_pk_add_f32 v[88:89], v[88:89], 1.0 op_sel_hi:[1,0]
    v_pk_add_f32 v[90:91], v[90:91], 1.0 op_sel_hi:[1,0]
    v_pk_add_f32 v[92:93], v[92:93], 1.0 op_sel_hi:[1,0]
    v_pk_add_f32 v[94:95], v[94:95], 1.0 op_sel_hi:[1,0]
    v_pk_fma_f32 v[12:13], v[104:105], v[104:105], v[12:13]
    v_pk_fma_f32 v[14:15], v[106:107], v[106:107], v[14:15]
    v_pk_fma_f32 v[16:17], v[108:109], v[108:109], v[16:17]
    v_pk_fma_f32 v[18:19], v[110:111], v[110:111], v[18:19]
    v_pk_fma_f32 v[96:97], v[76:77], v[76:77], s[50:51]
    v_pk_fma_f32 v[98:99], v[78:79], v[78:79], s[50:51]
    v_pk_fma_f32 v[100:101], v[80:81], v[80:81], s[50:51]
    v_pk_fma_f32 v[102:103], v[82:83], v[82:83], s[50:51]
    v_pk_mul_f32 v[96:97], v[96:97], v[76:77]
    v_pk_mul_f32 v[98:99], v[98:99], v[78:79]
    v_pk_mul_f32 v[100:101], v[100:101], v[80:81]
    v_pk_mul_f32 v[102:103], v[102:103], v[82:83]
    v_mfma_f32_16x16x32_bf16 v[60:63], a[48:51], v[216:219], 0
    v_exp_f32 v96, v96
    v_mfma_f32_16x16x32_bf16 v[60:63], a[52:55], v[220:223], v[60:63]
    s_add_u32 s53, s81, 3072
    buffer_load_dwordx4 a[12:15], v1, s[16:19], s53 offen sc1
    v_rcp_f32 v88, v88
    v_mfma_f32_16x16x32_bf16 v[60:63], a[56:59], v[224:227], v[60:63]
    v_exp_f32 v97, v97
    v_mfma_f32_16x16x32_bf16 v[60:63], a[60:63], v[228:231], v[60:63]
    v_rcp_f32 v89, v89
    v_mfma_f32_16x16x32_bf16 v[60:63], a[64:67], v[232:235], v[60:63]
    v_exp_f32 v98, v98
    v_mfma_f32_16x16x32_bf16 v[60:63], a[68:71], v[236:239], v[60:63]
    v_rcp_f32 v90, v90
    v_mfma_f32_16x16x32_bf16 v[64:67], a[72:75], v[216:219], 0
    v_exp_f32 v99, v99
    v_mfma_f32_16x16x32_bf16 v[64:67], a[76:79], v[220:223], v[64:67]
    s_add_u32 s53, s81, 4096
    buffer_load_dwordx4 a[16:19], v1, s[16:19], s53 offen sc1
    v_rcp_f32 v91, v91
    v_mfma_f32_16x16x32_bf16 v[64:67], a[80:83], v[224:227], v[64:67]
    v_exp_f32 v100, v100
    v_mfma_f32_16x16x32_bf16 v[64:67], a[84:87], v[228:231], v[64:67]
    v_rcp_f32 v92, v92
    v_mfma_f32_16x16x32_bf16 v[64:67], a[88:91], v[232:235], v[64:67]
    s_add_u32 s53, s81, 5120
    buffer_load_dwordx4 a[20:23], v1, s[16:19], s53 offen sc1
    v_exp_f32 v101, v101
    v_mfma_f32_16x16x32_bf16 v[64:67], a[92:95], v[236:239], v[64:67]
    v_rcp_f32 v93, v93
    v_exp_f32 v102, v102
    v_rcp_f32 v94, v94
    v_exp_f32 v103, v103
    v_rcp_f32 v95, v95
    v_pk_mul_f32 v[104:105], v[68:69], v[88:89]
    v_pk_mul_f32 v[106:107], v[70:71], v[90:91]
    v_pk_mul_f32 v[108:109], v[72:73], v[92:93]
    v_pk_mul_f32 v[110:111], v[74:75], v[94:95]
    v_pk_add_f32 v[96:97], v[96:97], 1.0 op_sel_hi:[1,0]
    v_pk_add_f32 v[98:99], v[98:99], 1.0 op_sel_hi:[1,0]
    v_pk_add_f32 v[100:101], v[100:101], 1.0 op_sel_hi:[1,0]
    v_pk_add_f32 v[102:103], v[102:103], 1.0 op_sel_hi:[1,0]
    v_pk_fma_f32 v[12:13], v[104:105], v[104:105], v[12:13]
    v_pk_fma_f32 v[14:15], v[106:107], v[106:107], v[14:15]
    v_pk_fma_f32 v[16:17], v[108:109], v[108:109], v[16:17]
    v_pk_fma_f32 v[18:19], v[110:111], v[110:111], v[18:19]
    v_pk_fma_f32 v[88:89], v[60:61], v[60:61], s[50:51]
    v_pk_fma_f32 v[90:91], v[62:63], v[62:63], s[50:51]
    v_pk_fma_f32 v[92:93], v[64:65], v[64:65], s[50:51]
    v_pk_fma_f32 v[94:95], v[66:67], v[66:67], s[50:51]
    v_pk_mul_f32 v[88:89], v[88:89], v[60:61]
    v_pk_mul_f32 v[90:91], v[90:91], v[62:63]
    v_pk_mul_f32 v[92:93], v[92:93], v[64:65]
    v_pk_mul_f32 v[94:95], v[94:95], v[66:67]
    v_mfma_f32_16x16x32_bf16 v[68:71], a[96:99], v[144:147], 0
    v_exp_f32 v88, v88
    v_mfma_f32_16x16x32_bf16 v[68:71], a[100:103], v[148:151], v[68:71]
    s_add_u32 s53, s81, 6144
    buffer_load_dwordx4 a[24:27], v1, s[16:19], s53 offen sc1
    v_rcp_f32 v96, v96
    v_mfma_f32_16x16x32_bf16 v[68:71], a[104:107], v[152:155], v[68:71]
    v_exp_f32 v89, v89
    v_mfma_f32_16x16x32_bf16 v[68:71], a[108:111], v[156:159], v[68:71]
    v_rcp_f32 v97, v97
    v_mfma_f32_16x16x32_bf16 v[68:71], a[112:115], v[160:163], v[68:71]
    v_exp_f32 v90, v90
    v_mfma_f32_16x16x32_bf16 v[68:71], a[116:119], v[164:167], v[68:71]
    v_rcp_f32 v98, v98
    v_mfma_f32_16x16x32_bf16 v[72:75], a[120:123], v[144:147], 0
    v_exp_f32 v91, v91
    v_mfma_f32_16x16x32_bf16 v[72:75], a[124:127], v[148:151], v[72:75]
    s_add_u32 s53, s81, 7168
    buffer_load_dwordx4 a[28:31], v1, s[16:19], s53 offen sc1
    v_rcp_f32 v99, v99
    v_mfma_f32_16x16x32_bf16 v[72:75], a[128:131], v[152:155], v[72:75]
    v_exp_f32 v92, v92
    v_mfma_f32_16x16x32_bf16 v[72:75], a[132:135], v[156:159], v[72:75]
    v_rcp_f32 v100, v100
    v_mfma_f32_16x16x32_bf16 v[72:75], a[136:139], v[160:163], v[72:75]
    s_add_u32 s53, s81, 8192
    buffer_load_dwordx4 a[32:35], v1, s[16:19], s53 offen sc1
    v_exp_f32 v93, v93
    v_mfma_f32_16x16x32_bf16 v[72:75], a[140:143], v[164:167], v[72:75]
    v_rcp_f32 v101, v101
    v_exp_f32 v94, v94
    v_rcp_f32 v102, v102
    v_exp_f32 v95, v95
    v_rcp_f32 v103, v103
    v_pk_mul_f32 v[104:105], v[76:77], v[96:97]
    v_pk_mul_f32 v[106:107], v[78:79], v[98:99]
    v_pk_mul_f32 v[108:109], v[80:81], v[100:101]
    v_pk_mul_f32 v[110:111], v[82:83], v[102:103]
    v_pk_add_f32 v[88:89], v[88:89], 1.0 op_sel_hi:[1,0]
    v_pk_add_f32 v[90:91], v[90:91], 1.0 op_sel_hi:[1,0]
    v_pk_add_f32 v[92:93], v[92:93], 1.0 op_sel_hi:[1,0]
    v_pk_add_f32 v[94:95], v[94:95], 1.0 op_sel_hi:[1,0]
    v_pk_fma_f32 v[20:21], v[104:105], v[104:105], v[20:21]
    v_pk_fma_f32 v[22:23], v[106:107], v[106:107], v[22:23]
    v_pk_fma_f32 v[24:25], v[108:109], v[108:109], v[24:25]
    v_pk_fma_f32 v[26:27], v[110:111], v[110:111], v[26:27]
    v_pk_fma_f32 v[96:97], v[68:69], v[68:69], s[50:51]
    v_pk_fma_f32 v[98:99], v[70:71], v[70:71], s[50:51]
    v_pk_fma_f32 v[100:101], v[72:73], v[72:73], s[50:51]
    v_pk_fma_f32 v[102:103], v[74:75], v[74:75], s[50:51]
    v_pk_mul_f32 v[96:97], v[96:97], v[68:69]
    v_pk_mul_f32 v[98:99], v[98:99], v[70:71]
    v_pk_mul_f32 v[100:101], v[100:101], v[72:73]
    v_pk_mul_f32 v[102:103], v[102:103], v[74:75]
    v_mfma_f32_16x16x32_bf16 v[76:79], a[96:99], v[216:219], 0
    v_cvt_pk_bf16_f32 v84, v104, v105
    v_exp_f32 v96, v96
    v_mfma_f32_16x16x32_bf16 v[76:79], a[100:103], v[220:223], v[76:79]
    s_add_u32 s53, s81, 9216
    buffer_load_dwordx4 a[36:39], v1, s[16:19], s53 offen sc1
    v_cvt_pk_bf16_f32 v85, v106, v107
    v_rcp_f32 v88, v88
    v_mfma_f32_16x16x32_bf16 v[76:79], a[104:107], v[224:227], v[76:79]
    v_cvt_pk_bf16_f32 v86, v108, v109
    v_exp_f32 v97, v97
    v_mfma_f32_16x16x32_bf16 v[76:79], a[108:111], v[228:231], v[76:79]
    v_cvt_pk_bf16_f32 v87, v110, v111
    v_rcp_f32 v89, v89
    v_mfma_f32_16x16x32_bf16 v[76:79], a[112:115], v[232:235], v[76:79]
    s_add_u32 s52, s56, 0
    buffer_store_dwordx4 v[84:87], v1, s[12:15], s52 offen sc1
    v_exp_f32 v98, v98
    v_rcp_f32 v90, v90
    v_mfma_f32_16x16x32_bf16 v[76:79], a[116:119], v[236:239], v[76:79]
    v_exp_f32 v99, v99
    v_mfma_f32_16x16x32_bf16 v[80:83], a[120:123], v[216:219], 0
    v_rcp_f32 v91, v91
    v_mfma_f32_16x16x32_bf16 v[80:83], a[124:127], v[220:223], v[80:83]
    s_add_u32 s53, s81, 10240
    buffer_load_dwordx4 a[40:43], v1, s[16:19], s53 offen sc1
    v_exp_f32 v100, v100
    v_mfma_f32_16x16x32_bf16 v[80:83], a[128:131], v[224:227], v[80:83]
    v_rcp_f32 v92, v92
    v_mfma_f32_16x16x32_bf16 v[80:83], a[132:135], v[228:231], v[80:83]
    v_exp_f32 v101, v101
    v_mfma_f32_16x16x32_bf16 v[80:83], a[136:139], v[232:235], v[80:83]
    s_add_u32 s53, s81, 11264
    buffer_load_dwordx4 a[44:47], v1, s[16:19], s53 offen sc1
    v_rcp_f32 v93, v93
    v_mfma_f32_16x16x32_bf16 v[80:83], a[140:143], v[236:239], v[80:83]
    v_exp_f32 v102, v102
    v_rcp_f32 v94, v94
    v_exp_f32 v103, v103
    v_rcp_f32 v95, v95
    v_pk_mul_f32 v[104:105], v[60:61], v[88:89]
    v_pk_mul_f32 v[106:107], v[62:63], v[90:91]
    v_pk_mul_f32 v[108:109], v[64:65], v[92:93]
    v_pk_mul_f32 v[110:111], v[66:67], v[94:95]
    v_pk_add_f32 v[96:97], v[96:97], 1.0 op_sel_hi:[1,0]
    v_pk_add_f32 v[98:99], v[98:99], 1.0 op_sel_hi:[1,0]
    v_pk_add_f32 v[100:101], v[100:101], 1.0 op_sel_hi:[1,0]
    v_pk_add_f32 v[102:103], v[102:103], 1.0 op_sel_hi:[1,0]
    v_pk_fma_f32 v[20:21], v[104:105], v[104:105], v[20:21]
    v_pk_fma_f32 v[22:23], v[106:107], v[106:107], v[22:23]
    v_pk_fma_f32 v[24:25], v[108:109], v[108:109], v[24:25]
    v_pk_fma_f32 v[26:27], v[110:111], v[110:111], v[26:27]
    v_pk_fma_f32 v[88:89], v[76:77], v[76:77], s[50:51]
    v_pk_fma_f32 v[90:91], v[78:79], v[78:79], s[50:51]
    v_pk_fma_f32 v[92:93], v[80:81], v[80:81], s[50:51]
    v_pk_fma_f32 v[94:95], v[82:83], v[82:83], s[50:51]
    v_pk_mul_f32 v[88:89], v[88:89], v[76:77]
    v_pk_mul_f32 v[90:91], v[90:91], v[78:79]
    v_pk_mul_f32 v[92:93], v[92:93], v[80:81]
    v_pk_mul_f32 v[94:95], v[94:95], v[82:83]
    v_mfma_f32_16x16x32_bf16 v[60:63], a[144:147], v[144:147], 0
    v_exp_f32 v88, v88
    v_mfma_f32_16x16x32_bf16 v[60:63], a[148:151], v[148:151], v[60:63]
    s_add_u32 s53, s80, 55296
    buffer_load_dwordx4 v[184:187], v1, s[16:19], s53 offen sc1
    v_rcp_f32 v96, v96
    v_mfma_f32_16x16x32_bf16 v[60:63], a[152:155], v[152:155], v[60:63]
    v_exp_f32 v89, v89
    v_mfma_f32_16x16x32_bf16 v[60:63], a[156:159], v[156:159], v[60:63]
    v_rcp_f32 v97, v97
    v_mfma_f32_16x16x32_bf16 v[60:63], a[160:163], v[160:163], v[60:63]
    v_exp_f32 v90, v90
    v_mfma_f32_16x16x32_bf16 v[60:63], a[164:167], v[164:167], v[60:63]
    v_rcp_f32 v98, v98
    v_mfma_f32_16x16x32_bf16 v[64:67], a[168:171], v[144:147], 0
    v_exp_f32 v91, v91
    v_mfma_f32_16x16x32_bf16 v[64:67], a[172:175], v[148:151], v[64:67]
    s_add_u32 s53, s80, 56320
    buffer_load_dwordx4 v[188:191], v1, s[16:19], s53 offen sc1
    v_rcp_f32 v99, v99
    v_mfma_f32_16x16x32_bf16 v[64:67], a[176:179], v[152:155], v[64:67]
    v_exp_f32 v92, v92
    v_mfma_f32_16x16x32_bf16 v[64:67], a[180:183], v[156:159], v[64:67]
    v_rcp_f32 v100, v100
    v_mfma_f32_16x16x32_bf16 v[64:67], a[184:187], v[160:163], v[64:67]
    s_add_u32 s53, s80, 57344
    buffer_load_dwordx4 v[192:195], v1, s[16:19], s53 offen sc1
    v_exp_f32 v93, v93
    v_mfma_f32_16x16x32_bf16 v[64:67], a[188:191], v[164:167], v[64:67]
    v_rcp_f32 v101, v101
    v_exp_f32 v94, v94
    v_rcp_f32 v102, v102
    v_exp_f32 v95, v95
    v_rcp_f32 v103, v103
    v_pk_mul_f32 v[104:105], v[68:69], v[96:97]
    v_pk_mul_f32 v[106:107], v[70:71], v[98:99]
    v_pk_mul_f32 v[108:109], v[72:73], v[100:101]
    v_pk_mul_f32 v[110:111], v[74:75], v[102:103]
    v_pk_add_f32 v[88:89], v[88:89], 1.0 op_sel_hi:[1,0]
    v_pk_add_f32 v[90:91], v[90:91], 1.0 op_sel_hi:[1,0]
    v_pk_add_f32 v[92:93], v[92:93], 1.0 op_sel_hi:[1,0]
    v_pk_add_f32 v[94:95], v[94:95], 1.0 op_sel_hi:[1,0]
    v_pk_fma_f32 v[28:29], v[104:105], v[104:105], v[28:29]
    v_pk_fma_f32 v[30:31], v[106:107], v[106:107], v[30:31]
    v_pk_fma_f32 v[32:33], v[108:109], v[108:109], v[32:33]
    v_pk_fma_f32 v[34:35], v[110:111], v[110:111], v[34:35]
    v_pk_fma_f32 v[96:97], v[60:61], v[60:61], s[50:51]
    v_pk_fma_f32 v[98:99], v[62:63], v[62:63], s[50:51]
    v_pk_fma_f32 v[100:101], v[64:65], v[64:65], s[50:51]
    v_pk_fma_f32 v[102:103], v[66:67], v[66:67], s[50:51]
    v_pk_mul_f32 v[96:97], v[96:97], v[60:61]
    v_pk_mul_f32 v[98:99], v[98:99], v[62:63]
    v_pk_mul_f32 v[100:101], v[100:101], v[64:65]
    v_pk_mul_f32 v[102:103], v[102:103], v[66:67]
    v_mfma_f32_16x16x32_bf16 v[68:71], a[144:147], v[216:219], 0
    v_cvt_pk_bf16_f32 v84, v104, v105
    v_exp_f32 v96, v96
    v_mfma_f32_16x16x32_bf16 v[68:71], a[148:151], v[220:223], v[68:71]
    s_add_u32 s53, s80, 58368
    buffer_load_dwordx4 v[196:199], v1, s[16:19], s53 offen sc1
    v_cvt_pk_bf16_f32 v85, v106, v107
    v_rcp_f32 v88, v88
    v_mfma_f32_16x16x32_bf16 v[68:71], a[152:155], v[224:227], v[68:71]
    v_cvt_pk_bf16_f32 v86, v108, v109
    v_exp_f32 v97, v97
    v_mfma_f32_16x16x32_bf16 v[68:71], a[156:159], v[228:231], v[68:71]
    v_cvt_pk_bf16_f32 v87, v110, v111
    v_rcp_f32 v89, v89
    v_mfma_f32_16x16x32_bf16 v[68:71], a[160:163], v[232:235], v[68:71]
    s_add_u32 s52, s56, 1024
    buffer_store_dwordx4 v[84:87], v1, s[12:15], s52 offen sc1
    v_exp_f32 v98, v98
    v_rcp_f32 v90, v90
    v_mfma_f32_16x16x32_bf16 v[68:71], a[164:167], v[236:239], v[68:71]
    v_exp_f32 v99, v99
    v_mfma_f32_16x16x32_bf16 v[72:75], a[168:171], v[216:219], 0
    v_rcp_f32 v91, v91
    v_mfma_f32_16x16x32_bf16 v[72:75], a[172:175], v[220:223], v[72:75]
    s_add_u32 s53, s80, 59392
    buffer_load_dwordx4 v[200:203], v1, s[16:19], s53 offen sc1
    v_exp_f32 v100, v100
    v_mfma_f32_16x16x32_bf16 v[72:75], a[176:179], v[224:227], v[72:75]
    v_rcp_f32 v92, v92
    v_mfma_f32_16x16x32_bf16 v[72:75], a[180:183], v[228:231], v[72:75]
    v_exp_f32 v101, v101
    v_mfma_f32_16x16x32_bf16 v[72:75], a[184:187], v[232:235], v[72:75]
    s_add_u32 s53, s80, 60416
    buffer_load_dwordx4 v[204:207], v1, s[16:19], s53 offen sc1
    v_rcp_f32 v93, v93
    v_mfma_f32_16x16x32_bf16 v[72:75], a[188:191], v[236:239], v[72:75]
    v_exp_f32 v102, v102
    v_rcp_f32 v94, v94
    v_exp_f32 v103, v103
    v_rcp_f32 v95, v95
    v_pk_mul_f32 v[104:105], v[76:77], v[88:89]
    v_pk_mul_f32 v[106:107], v[78:79], v[90:91]
    v_pk_mul_f32 v[108:109], v[80:81], v[92:93]
    v_pk_mul_f32 v[110:111], v[82:83], v[94:95]
    v_pk_add_f32 v[96:97], v[96:97], 1.0 op_sel_hi:[1,0]
    v_pk_add_f32 v[98:99], v[98:99], 1.0 op_sel_hi:[1,0]
    v_pk_add_f32 v[100:101], v[100:101], 1.0 op_sel_hi:[1,0]
    v_pk_add_f32 v[102:103], v[102:103], 1.0 op_sel_hi:[1,0]
    v_pk_fma_f32 v[28:29], v[104:105], v[104:105], v[28:29]
    v_pk_fma_f32 v[30:31], v[106:107], v[106:107], v[30:31]
    v_pk_fma_f32 v[32:33], v[108:109], v[108:109], v[32:33]
    v_pk_fma_f32 v[34:35], v[110:111], v[110:111], v[34:35]
    v_pk_fma_f32 v[88:89], v[68:69], v[68:69], s[50:51]
    v_pk_fma_f32 v[90:91], v[70:71], v[70:71], s[50:51]
    v_pk_fma_f32 v[92:93], v[72:73], v[72:73], s[50:51]
    v_pk_fma_f32 v[94:95], v[74:75], v[74:75], s[50:51]
    v_pk_mul_f32 v[88:89], v[88:89], v[68:69]
    v_pk_mul_f32 v[90:91], v[90:91], v[70:71]
    v_pk_mul_f32 v[92:93], v[92:93], v[72:73]
    v_pk_mul_f32 v[94:95], v[94:95], v[74:75]
    v_mfma_f32_16x16x32_bf16 v[76:79], a[192:195], v[144:147], 0
    v_cvt_pk_bf16_f32 v84, v104, v105
    v_exp_f32 v88, v88
    v_mfma_f32_16x16x32_bf16 v[76:79], a[196:199], v[148:151], v[76:79]
    s_add_u32 s53, s80, 70656
    buffer_load_dwordx4 v[244:247], v1, s[16:19], s53 offen sc1
    v_cvt_pk_bf16_f32 v85, v106, v107
    v_rcp_f32 v96, v96
    v_mfma_f32_16x16x32_bf16 v[76:79], a[200:203], v[152:155], v[76:79]
    v_cvt_pk_bf16_f32 v86, v108, v109
    v_exp_f32 v89, v89
    v_mfma_f32_16x16x32_bf16 v[76:79], a[204:207], v[156:159], v[76:79]
    v_cvt_pk_bf16_f32 v87, v110, v111
    v_rcp_f32 v97, v97
    v_mfma_f32_16x16x32_bf16 v[76:79], a[208:211], v[160:163], v[76:79]
    s_add_u32 s52, s57, 0
    buffer_store_dwordx4 v[84:87], v1, s[12:15], s52 offen sc1
    v_exp_f32 v90, v90
    v_rcp_f32 v98, v98
    v_mfma_f32_16x16x32_bf16 v[76:79], a[212:215], v[164:167], v[76:79]
    v_exp_f32 v91, v91
    v_mfma_f32_16x16x32_bf16 v[80:83], a[216:219], v[144:147], 0
    v_rcp_f32 v99, v99
    v_mfma_f32_16x16x32_bf16 v[80:83], a[220:223], v[148:151], v[80:83]
    s_add_u32 s53, s80, 71680
    buffer_load_dwordx4 v[248:251], v1, s[16:19], s53 offen sc1
    v_exp_f32 v92, v92
    v_mfma_f32_16x16x32_bf16 v[80:83], a[224:227], v[152:155], v[80:83]
    v_rcp_f32 v100, v100
    v_mfma_f32_16x16x32_bf16 v[80:83], a[228:231], v[156:159], v[80:83]
    v_exp_f32 v93, v93
    v_mfma_f32_16x16x32_bf16 v[80:83], a[232:235], v[160:163], v[80:83]
    s_add_u32 s53, s80, 72704
    buffer_load_dwordx4 v[252:255], v1, s[16:19], s53 offen sc1
    v_rcp_f32 v101, v101
    v_mfma_f32_16x16x32_bf16 v[80:83], a[236:239], v[164:167], v[80:83]
    v_exp_f32 v94, v94
    v_rcp_f32 v102, v102
    v_exp_f32 v95, v95
    v_rcp_f32 v103, v103
    v_pk_mul_f32 v[104:105], v[60:61], v[96:97]
    v_pk_mul_f32 v[106:107], v[62:63], v[98:99]
    v_pk_mul_f32 v[108:109], v[64:65], v[100:101]
    v_pk_mul_f32 v[110:111], v[66:67], v[102:103]
    v_pk_add_f32 v[88:89], v[88:89], 1.0 op_sel_hi:[1,0]
    v_pk_add_f32 v[90:91], v[90:91], 1.0 op_sel_hi:[1,0]
    v_pk_add_f32 v[92:93], v[92:93], 1.0 op_sel_hi:[1,0]
    v_pk_add_f32 v[94:95], v[94:95], 1.0 op_sel_hi:[1,0]
    v_pk_fma_f32 v[36:37], v[104:105], v[104:105], v[36:37]
    v_pk_fma_f32 v[38:39], v[106:107], v[106:107], v[38:39]
    v_pk_fma_f32 v[40:41], v[108:109], v[108:109], v[40:41]
    v_pk_fma_f32 v[42:43], v[110:111], v[110:111], v[42:43]
    v_pk_fma_f32 v[96:97], v[76:77], v[76:77], s[50:51]
    v_pk_fma_f32 v[98:99], v[78:79], v[78:79], s[50:51]
    v_pk_fma_f32 v[100:101], v[80:81], v[80:81], s[50:51]
    v_pk_fma_f32 v[102:103], v[82:83], v[82:83], s[50:51]
    v_pk_mul_f32 v[96:97], v[96:97], v[76:77]
    v_pk_mul_f32 v[98:99], v[98:99], v[78:79]
    v_pk_mul_f32 v[100:101], v[100:101], v[80:81]
    v_pk_mul_f32 v[102:103], v[102:103], v[82:83]
    v_mfma_f32_16x16x32_bf16 v[60:63], a[192:195], v[216:219], 0
    v_cvt_pk_bf16_f32 v84, v104, v105
    v_exp_f32 v96, v96
    v_mfma_f32_16x16x32_bf16 v[60:63], a[196:199], v[220:223], v[60:63]
    s_add_u32 s53, s80, 0
    buffer_load_dwordx4 a[136:139], v1, s[16:19], s53 offen sc1
    v_cvt_pk_bf16_f32 v85, v106, v107
    v_rcp_f32 v88, v88
    v_mfma_f32_16x16x32_bf16 v[60:63], a[200:203], v[224:227], v[60:63]
    v_cvt_pk_bf16_f32 v86, v108, v109
    v_exp_f32 v97, v97
    v_mfma_f32_16x16x32_bf16 v[60:63], a[204:207], v[228:231], v[60:63]
    v_cvt_pk_bf16_f32 v87, v110, v111
    v_rcp_f32 v89, v89
    v_mfma_f32_16x16x32_bf16 v[60:63], a[208:211], v[232:235], v[60:63]
    s_add_u32 s52, s56, 2048
    buffer_store_dwordx4 v[84:87], v1, s[12:15], s52 offen sc1
    v_exp_f32 v98, v98
    v_rcp_f32 v90, v90
    v_mfma_f32_16x16x32_bf16 v[60:63], a[212:215], v[236:239], v[60:63]
    v_exp_f32 v99, v99
    v_mfma_f32_16x16x32_bf16 v[64:67], a[216:219], v[216:219], 0
    v_rcp_f32 v91, v91
    v_mfma_f32_16x16x32_bf16 v[64:67], a[220:223], v[220:223], v[64:67]
    s_add_u32 s53, s80, 1024
    buffer_load_dwordx4 a[140:143], v1, s[16:19], s53 offen sc1
    v_exp_f32 v100, v100
    v_mfma_f32_16x16x32_bf16 v[64:67], a[224:227], v[224:227], v[64:67]
    v_rcp_f32 v92, v92
    v_mfma_f32_16x16x32_bf16 v[64:67], a[228:231], v[228:231], v[64:67]
    v_exp_f32 v101, v101
    v_mfma_f32_16x16x32_bf16 v[64:67], a[232:235], v[232:235], v[64:67]
    s_add_u32 s53, s80, 2048
    buffer_load_dwordx4 a[144:147], v1, s[16:19], s53 offen sc1
    v_rcp_f32 v93, v93
    v_mfma_f32_16x16x32_bf16 v[64:67], a[236:239], v[236:239], v[64:67]
    v_exp_f32 v102, v102
    v_rcp_f32 v94, v94
    v_exp_f32 v103, v103
    v_rcp_f32 v95, v95
    v_pk_mul_f32 v[104:105], v[68:69], v[88:89]
    v_pk_mul_f32 v[106:107], v[70:71], v[90:91]
    v_pk_mul_f32 v[108:109], v[72:73], v[92:93]
    v_pk_mul_f32 v[110:111], v[74:75], v[94:95]
    v_pk_add_f32 v[96:97], v[96:97], 1.0 op_sel_hi:[1,0]
    v_pk_add_f32 v[98:99], v[98:99], 1.0 op_sel_hi:[1,0]
    v_pk_add_f32 v[100:101], v[100:101], 1.0 op_sel_hi:[1,0]
    v_pk_add_f32 v[102:103], v[102:103], 1.0 op_sel_hi:[1,0]
    v_pk_fma_f32 v[36:37], v[104:105], v[104:105], v[36:37]
    v_pk_fma_f32 v[38:39], v[106:107], v[106:107], v[38:39]
    v_pk_fma_f32 v[40:41], v[108:109], v[108:109], v[40:41]
    v_pk_fma_f32 v[42:43], v[110:111], v[110:111], v[42:43]
    v_pk_fma_f32 v[88:89], v[60:61], v[60:61], s[50:51]
    v_pk_fma_f32 v[90:91], v[62:63], v[62:63], s[50:51]
    v_pk_fma_f32 v[92:93], v[64:65], v[64:65], s[50:51]
    v_pk_fma_f32 v[94:95], v[66:67], v[66:67], s[50:51]
    v_pk_mul_f32 v[88:89], v[88:89], v[60:61]
    v_pk_mul_f32 v[90:91], v[90:91], v[62:63]
    v_pk_mul_f32 v[92:93], v[92:93], v[64:65]
    v_pk_mul_f32 v[94:95], v[94:95], v[66:67]
    v_mfma_f32_16x16x32_bf16 v[68:71], a[240:243], v[144:147], 0
    v_cvt_pk_bf16_f32 v84, v104, v105
    v_exp_f32 v88, v88
    v_mfma_f32_16x16x32_bf16 v[68:71], a[244:247], v[148:151], v[68:71]
    s_add_u32 s53, s80, 3072
    buffer_load_dwordx4 a[148:151], v1, s[16:19], s53 offen sc1
    v_cvt_pk_bf16_f32 v85, v106, v107
    v_rcp_f32 v96, v96
    v_mfma_f32_16x16x32_bf16 v[68:71], a[248:251], v[152:155], v[68:71]
    v_cvt_pk_bf16_f32 v86, v108, v109
    v_exp_f32 v89, v89
    v_mfma_f32_16x16x32_bf16 v[68:71], a[252:255], v[156:159], v[68:71]
    v_cvt_pk_bf16_f32 v87, v110, v111
    v_rcp_f32 v97, v97
    v_mfma_f32_16x16x32_bf16 v[68:71], v[112:115], v[160:163], v[68:71]
    s_add_u32 s52, s57, 1024
    buffer_store_dwordx4 v[84:87], v1, s[12:15], s52 offen sc1
    v_exp_f32 v90, v90
    v_rcp_f32 v98, v98
    v_mfma_f32_16x16x32_bf16 v[68:71], v[116:119], v[164:167], v[68:71]
    v_exp_f32 v91, v91
    v_mfma_f32_16x16x32_bf16 v[72:75], v[120:123], v[144:147], 0
    v_rcp_f32 v99, v99
    v_mfma_f32_16x16x32_bf16 v[72:75], v[124:127], v[148:151], v[72:75]
    s_add_u32 s53, s80, 4096
    buffer_load_dwordx4 a[152:155], v1, s[16:19], s53 offen sc1
    v_exp_f32 v92, v92
    v_mfma_f32_16x16x32_bf16 v[72:75], v[128:131], v[152:155], v[72:75]
    v_rcp_f32 v100, v100
    v_mfma_f32_16x16x32_bf16 v[72:75], v[132:135], v[156:159], v[72:75]
    v_exp_f32 v93, v93
    v_mfma_f32_16x16x32_bf16 v[72:75], v[136:139], v[160:163], v[72:75]
    s_add_u32 s53, s80, 5120
    buffer_load_dwordx4 a[156:159], v1, s[16:19], s53 offen sc1
    v_rcp_f32 v101, v101
    v_mfma_f32_16x16x32_bf16 v[72:75], v[140:143], v[164:167], v[72:75]
    v_exp_f32 v94, v94
    v_rcp_f32 v102, v102
    v_exp_f32 v95, v95
    v_rcp_f32 v103, v103
    v_pk_mul_f32 v[104:105], v[76:77], v[96:97]
    v_pk_mul_f32 v[106:107], v[78:79], v[98:99]
    v_pk_mul_f32 v[108:109], v[80:81], v[100:101]
    v_pk_mul_f32 v[110:111], v[82:83], v[102:103]
    v_pk_add_f32 v[88:89], v[88:89], 1.0 op_sel_hi:[1,0]
    v_pk_add_f32 v[90:91], v[90:91], 1.0 op_sel_hi:[1,0]
    v_pk_add_f32 v[92:93], v[92:93], 1.0 op_sel_hi:[1,0]
    v_pk_add_f32 v[94:95], v[94:95], 1.0 op_sel_hi:[1,0]
    v_pk_fma_f32 v[44:45], v[104:105], v[104:105], v[44:45]
    v_pk_fma_f32 v[46:47], v[106:107], v[106:107], v[46:47]
    v_pk_fma_f32 v[48:49], v[108:109], v[108:109], v[48:49]
    v_pk_fma_f32 v[50:51], v[110:111], v[110:111], v[50:51]
    v_pk_fma_f32 v[96:97], v[68:69], v[68:69], s[50:51]
    v_pk_fma_f32 v[98:99], v[70:71], v[70:71], s[50:51]
    v_pk_fma_f32 v[100:101], v[72:73], v[72:73], s[50:51]
    v_pk_fma_f32 v[102:103], v[74:75], v[74:75], s[50:51]
    v_pk_mul_f32 v[96:97], v[96:97], v[68:69]
    v_pk_mul_f32 v[98:99], v[98:99], v[70:71]
    v_pk_mul_f32 v[100:101], v[100:101], v[72:73]
    v_pk_mul_f32 v[102:103], v[102:103], v[74:75]
    v_mfma_f32_16x16x32_bf16 v[76:79], a[240:243], v[216:219], 0
    v_cvt_pk_bf16_f32 v84, v104, v105
    v_exp_f32 v96, v96
    v_mfma_f32_16x16x32_bf16 v[76:79], a[244:247], v[220:223], v[76:79]
    s_add_u32 s53, s80, 6144
    buffer_load_dwordx4 a[160:163], v1, s[16:19], s53 offen sc1
    v_cvt_pk_bf16_f32 v85, v106, v107
    v_rcp_f32 v88, v88
    v_mfma_f32_16x16x32_bf16 v[76:79], a[248:251], v[224:227], v[76:79]
    v_cvt_pk_bf16_f32 v86, v108, v109
    v_exp_f32 v97, v97
    v_mfma_f32_16x16x32_bf16 v[76:79], a[252:255], v[228:231], v[76:79]
    v_cvt_pk_bf16_f32 v87, v110, v111
    v_rcp_f32 v89, v89
    v_mfma_f32_16x16x32_bf16 v[76:79], v[112:115], v[232:235], v[76:79]
    s_add_u32 s52, s56, 3072
    buffer_store_dwordx4 v[84:87], v1, s[12:15], s52 offen sc1
    v_exp_f32 v98, v98
    v_rcp_f32 v90, v90
    v_mfma_f32_16x16x32_bf16 v[76:79], v[116:119], v[236:239], v[76:79]
    v_exp_f32 v99, v99
    v_mfma_f32_16x16x32_bf16 v[80:83], v[120:123], v[216:219], 0
    v_rcp_f32 v91, v91
    v_mfma_f32_16x16x32_bf16 v[80:83], v[124:127], v[220:223], v[80:83]
    s_add_u32 s53, s80, 7168
    buffer_load_dwordx4 a[164:167], v1, s[16:19], s53 offen sc1
    v_exp_f32 v100, v100
    v_mfma_f32_16x16x32_bf16 v[80:83], v[128:131], v[224:227], v[80:83]
    v_rcp_f32 v92, v92
    v_mfma_f32_16x16x32_bf16 v[80:83], v[132:135], v[228:231], v[80:83]
    v_exp_f32 v101, v101
    v_mfma_f32_16x16x32_bf16 v[80:83], v[136:139], v[232:235], v[80:83]
    s_add_u32 s53, s80, 8192
    buffer_load_dwordx4 a[168:171], v1, s[16:19], s53 offen sc1
    v_rcp_f32 v93, v93
    v_mfma_f32_16x16x32_bf16 v[80:83], v[140:143], v[236:239], v[80:83]
    v_exp_f32 v102, v102
    v_rcp_f32 v94, v94
    v_exp_f32 v103, v103
    v_rcp_f32 v95, v95
    v_pk_mul_f32 v[104:105], v[60:61], v[88:89]
    v_pk_mul_f32 v[106:107], v[62:63], v[90:91]
    v_pk_mul_f32 v[108:109], v[64:65], v[92:93]
    v_pk_mul_f32 v[110:111], v[66:67], v[94:95]
    v_pk_add_f32 v[96:97], v[96:97], 1.0 op_sel_hi:[1,0]
    v_pk_add_f32 v[98:99], v[98:99], 1.0 op_sel_hi:[1,0]
    v_pk_add_f32 v[100:101], v[100:101], 1.0 op_sel_hi:[1,0]
    v_pk_add_f32 v[102:103], v[102:103], 1.0 op_sel_hi:[1,0]
    v_pk_fma_f32 v[44:45], v[104:105], v[104:105], v[44:45]
    v_pk_fma_f32 v[46:47], v[106:107], v[106:107], v[46:47]
    v_pk_fma_f32 v[48:49], v[108:109], v[108:109], v[48:49]
    v_pk_fma_f32 v[50:51], v[110:111], v[110:111], v[50:51]
    v_pk_fma_f32 v[88:89], v[76:77], v[76:77], s[50:51]
    v_pk_fma_f32 v[90:91], v[78:79], v[78:79], s[50:51]
    v_pk_fma_f32 v[92:93], v[80:81], v[80:81], s[50:51]
    v_pk_fma_f32 v[94:95], v[82:83], v[82:83], s[50:51]
    v_pk_mul_f32 v[88:89], v[88:89], v[76:77]
    v_pk_mul_f32 v[90:91], v[90:91], v[78:79]
    v_pk_mul_f32 v[92:93], v[92:93], v[80:81]
    v_pk_mul_f32 v[94:95], v[94:95], v[82:83]
    v_cvt_pk_bf16_f32 v84, v104, v105
    v_cvt_pk_bf16_f32 v85, v106, v107
    v_cvt_pk_bf16_f32 v86, v108, v109
    v_cvt_pk_bf16_f32 v87, v110, v111
    s_add_u32 s52, s57, 2048
    buffer_store_dwordx4 v[84:87], v1, s[12:15], s52 offen sc1
    v_exp_f32 v88, v88
    v_rcp_f32 v96, v96
    v_exp_f32 v89, v89
    v_rcp_f32 v97, v97
    v_exp_f32 v90, v90
    v_rcp_f32 v98, v98
    v_exp_f32 v91, v91
    v_rcp_f32 v99, v99
    v_exp_f32 v92, v92
    v_rcp_f32 v100, v100
    v_exp_f32 v93, v93
    v_rcp_f32 v101, v101
    v_exp_f32 v94, v94
    v_rcp_f32 v102, v102
    v_exp_f32 v95, v95
    v_rcp_f32 v103, v103
    s_nop 0
    v_pk_mul_f32 v[104:105], v[68:69], v[96:97]
    v_pk_mul_f32 v[106:107], v[70:71], v[98:99]
    v_pk_mul_f32 v[108:109], v[72:73], v[100:101]
    v_pk_mul_f32 v[110:111], v[74:75], v[102:103]
    v_pk_add_f32 v[88:89], v[88:89], 1.0 op_sel_hi:[1,0]
    v_pk_add_f32 v[90:91], v[90:91], 1.0 op_sel_hi:[1,0]
    v_pk_add_f32 v[92:93], v[92:93], 1.0 op_sel_hi:[1,0]
    v_pk_add_f32 v[94:95], v[94:95], 1.0 op_sel_hi:[1,0]
    v_pk_fma_f32 v[52:53], v[104:105], v[104:105], v[52:53]
    v_pk_fma_f32 v[54:55], v[106:107], v[106:107], v[54:55]
    v_pk_fma_f32 v[56:57], v[108:109], v[108:109], v[56:57]
    v_pk_fma_f32 v[58:59], v[110:111], v[110:111], v[58:59]
    v_cvt_pk_bf16_f32 v84, v104, v105
    v_cvt_pk_bf16_f32 v85, v106, v107
    v_cvt_pk_bf16_f32 v86, v108, v109
    v_cvt_pk_bf16_f32 v87, v110, v111
    s_add_u32 s52, s56, 4096
    buffer_store_dwordx4 v[84:87], v1, s[12:15], s52 offen sc1
    v_rcp_f32 v88, v88
    v_rcp_f32 v89, v89
    v_rcp_f32 v90, v90
    v_rcp_f32 v91, v91
    v_rcp_f32 v92, v92
    v_rcp_f32 v93, v93
    v_rcp_f32 v94, v94
    v_rcp_f32 v95, v95
    s_nop 0
    v_pk_mul_f32 v[104:105], v[76:77], v[88:89]
    v_pk_mul_f32 v[106:107], v[78:79], v[90:91]
    v_pk_mul_f32 v[108:109], v[80:81], v[92:93]
    v_pk_mul_f32 v[110:111], v[82:83], v[94:95]
    v_pk_fma_f32 v[52:53], v[104:105], v[104:105], v[52:53]
    v_pk_fma_f32 v[54:55], v[106:107], v[106:107], v[54:55]
    v_pk_fma_f32 v[56:57], v[108:109], v[108:109], v[56:57]
    v_pk_fma_f32 v[58:59], v[110:111], v[110:111], v[58:59]
    v_cvt_pk_bf16_f32 v84, v104, v105
    v_cvt_pk_bf16_f32 v85, v106, v107
    v_cvt_pk_bf16_f32 v86, v108, v109
    v_cvt_pk_bf16_f32 v87, v110, v111
    s_add_u32 s52, s57, 3072
    buffer_store_dwordx4 v[84:87], v1, s[12:15], s52 offen sc1
    s_nop 0
    v_add_f32_dpp v12, v12, v12 row_ror:8 row_mask:0xf bank_mask:0xf
    v_add_f32_dpp v13, v13, v13 row_ror:8 row_mask:0xf bank_mask:0xf
    v_add_f32_dpp v14, v14, v14 row_ror:8 row_mask:0xf bank_mask:0xf
    v_add_f32_dpp v15, v15, v15 row_ror:8 row_mask:0xf bank_mask:0xf
    v_add_f32_dpp v16, v16, v16 row_ror:8 row_mask:0xf bank_mask:0xf
    v_add_f32_dpp v17, v17, v17 row_ror:8 row_mask:0xf bank_mask:0xf
    v_add_f32_dpp v18, v18, v18 row_ror:8 row_mask:0xf bank_mask:0xf
    v_add_f32_dpp v19, v19, v19 row_ror:8 row_mask:0xf bank_mask:0xf
    v_add_f32_dpp v20, v20, v20 row_ror:8 row_mask:0xf bank_mask:0xf
    v_add_f32_dpp v21, v21, v21 row_ror:8 row_mask:0xf bank_mask:0xf
    v_add_f32_dpp v22, v22, v22 row_ror:8 row_mask:0xf bank_mask:0xf
    v_add_f32_dpp v23, v23, v23 row_ror:8 row_mask:0xf bank_mask:0xf
    v_add_f32_dpp v24, v24, v24 row_ror:8 row_mask:0xf bank_mask:0xf
    v_add_f32_dpp v25, v25, v25 row_ror:8 row_mask:0xf bank_mask:0xf
    v_add_f32_dpp v26, v26, v26 row_ror:8 row_mask:0xf bank_mask:0xf
    v_add_f32_dpp v27, v27, v27 row_ror:8 row_mask:0xf bank_mask:0xf
    v_add_f32_dpp v28, v28, v28 row_ror:8 row_mask:0xf bank_mask:0xf
    v_add_f32_dpp v29, v29, v29 row_ror:8 row_mask:0xf bank_mask:0xf
    v_add_f32_dpp v30, v30, v30 row_ror:8 row_mask:0xf bank_mask:0xf
    v_add_f32_dpp v31, v31, v31 row_ror:8 row_mask:0xf bank_mask:0xf
    v_add_f32_dpp v32, v32, v32 row_ror:8 row_mask:0xf bank_mask:0xf
    v_add_f32_dpp v33, v33, v33 row_ror:8 row_mask:0xf bank_mask:0xf
    v_add_f32_dpp v34, v34, v34 row_ror:8 row_mask:0xf bank_mask:0xf
    v_add_f32_dpp v35, v35, v35 row_ror:8 row_mask:0xf bank_mask:0xf
    v_add_f32_dpp v12, v36, v36 row_ror:8 row_mask:0xf bank_mask:0xc
    v_add_f32_dpp v13, v37, v37 row_ror:8 row_mask:0xf bank_mask:0xc
    v_add_f32_dpp v14, v38, v38 row_ror:8 row_mask:0xf bank_mask:0xc
    v_add_f32_dpp v15, v39, v39 row_ror:8 row_mask:0xf bank_mask:0xc
    v_add_f32_dpp v16, v40, v40 row_ror:8 row_mask:0xf bank_mask:0xc
    v_add_f32_dpp v17, v41, v41 row_ror:8 row_mask:0xf bank_mask:0xc
    v_add_f32_dpp v18, v42, v42 row_ror:8 row_mask:0xf bank_mask:0xc
    v_add_f32_dpp v19, v43, v43 row_ror:8 row_mask:0xf bank_mask:0xc
    v_add_f32_dpp v20, v44, v44 row_ror:8 row_mask:0xf bank_mask:0xc
    v_add_f32_dpp v21, v45, v45 row_ror:8 row_mask:0xf bank_mask:0xc
    v_add_f32_dpp v22, v46, v46 row_ror:8 row_mask:0xf bank_mask:0xc
    v_add_f32_dpp v23, v47, v47 row_ror:8 row_mask:0xf bank_mask:0xc
    v_add_f32_dpp v24, v48, v48 row_ror:8 row_mask:0xf bank_mask:0xc
    v_add_f32_dpp v25, v49, v49 row_ror:8 row_mask:0xf bank_mask:0xc
    v_add_f32_dpp v26, v50, v50 row_ror:8 row_mask:0xf bank_mask:0xc
    v_add_f32_dpp v27, v51, v51 row_ror:8 row_mask:0xf bank_mask:0xc
    v_add_f32_dpp v28, v52, v52 row_ror:8 row_mask:0xf bank_mask:0xc
    v_add_f32_dpp v29, v53, v53 row_ror:8 row_mask:0xf bank_mask:0xc
    v_add_f32_dpp v30, v54, v54 row_ror:8 row_mask:0xf bank_mask:0xc
    v_add_f32_dpp v31, v55, v55 row_ror:8 row_mask:0xf bank_mask:0xc
    v_add_f32_dpp v32, v56, v56 row_ror:8 row_mask:0xf bank_mask:0xc
    v_add_f32_dpp v33, v57, v57 row_ror:8 row_mask:0xf bank_mask:0xc
    v_add_f32_dpp v34, v58, v58 row_ror:8 row_mask:0xf bank_mask:0xc
    v_add_f32_dpp v35, v59, v59 row_ror:8 row_mask:0xf bank_mask:0xc
    v_add_f32_dpp v12, v12, v12 row_half_mirror row_mask:0xf bank_mask:0xf
    v_add_f32_dpp v13, v13, v13 row_half_mirror row_mask:0xf bank_mask:0xf
    v_add_f32_dpp v14, v14, v14 row_half_mirror row_mask:0xf bank_mask:0xf
    v_add_f32_dpp v15, v15, v15 row_half_mirror row_mask:0xf bank_mask:0xf
    v_add_f32_dpp v16, v16, v16 row_half_mirror row_mask:0xf bank_mask:0xf
    v_add_f32_dpp v17, v17, v17 row_half_mirror row_mask:0xf bank_mask:0xf
    v_add_f32_dpp v18, v18, v18 row_half_mirror row_mask:0xf bank_mask:0xf
    v_add_f32_dpp v19, v19, v19 row_half_mirror row_mask:0xf bank_mask:0xf
    v_add_f32_dpp v20, v20, v20 row_half_mirror row_mask:0xf bank_mask:0xf
    v_add_f32_dpp v21, v21, v21 row_half_mirror row_mask:0xf bank_mask:0xf
    v_add_f32_dpp v22, v22, v22 row_half_mirror row_mask:0xf bank_mask:0xf
    v_add_f32_dpp v23, v23, v23 row_half_mirror row_mask:0xf bank_mask:0xf
    v_add_f32_dpp v12, v24, v24 row_half_mirror row_mask:0xf bank_mask:0xa
    v_add_f32_dpp v13, v25, v25 row_half_mirror row_mask:0xf bank_mask:0xa
    v_add_f32_dpp v14, v26, v26 row_half_mirror row_mask:0xf bank_mask:0xa
    v_add_f32_dpp v15, v27, v27 row_half_mirror row_mask:0xf bank_mask:0xa
    v_add_f32_dpp v16, v28, v28 row_half_mirror row_mask:0xf bank_mask:0xa
    v_add_f32_dpp v17, v29, v29 row_half_mirror row_mask:0xf bank_mask:0xa
    v_add_f32_dpp v18, v30, v30 row_half_mirror row_mask:0xf bank_mask:0xa
    v_add_f32_dpp v19, v31, v31 row_half_mirror row_mask:0xf bank_mask:0xa
    v_add_f32_dpp v20, v32, v32 row_half_mirror row_mask:0xf bank_mask:0xa
    v_add_f32_dpp v21, v33, v33 row_half_mirror row_mask:0xf bank_mask:0xa
    v_add_f32_dpp v22, v34, v34 row_half_mirror row_mask:0xf bank_mask:0xa
    v_add_f32_dpp v23, v35, v35 row_half_mirror row_mask:0xf bank_mask:0xa
    v_add_f32_dpp v12, v12, v12 quad_perm:[1,0,3,2] row_mask:0xf bank_mask:0xf
    v_add_f32_dpp v13, v13, v13 quad_perm:[1,0,3,2] row_mask:0xf bank_mask:0xf
    v_add_f32_dpp v14, v14, v14 quad_perm:[1,0,3,2] row_mask:0xf bank_mask:0xf
    v_add_f32_dpp v15, v15, v15 quad_perm:[1,0,3,2] row_mask:0xf bank_mask:0xf
    v_add_f32_dpp v16, v16, v16 quad_perm:[1,0,3,2] row_mask:0xf bank_mask:0xf
    v_add_f32_dpp v17, v17, v17 quad_perm:[1,0,3,2] row_mask:0xf bank_mask:0xf
    v_add_f32_dpp v18, v18, v18 quad_perm:[1,0,3,2] row_mask:0xf bank_mask:0xf
    v_add_f32_dpp v19, v19, v19 quad_perm:[1,0,3,2] row_mask:0xf bank_mask:0xf
    v_add_f32_dpp v20, v20, v20 quad_perm:[1,0,3,2] row_mask:0xf bank_mask:0xf
    v_add_f32_dpp v21, v21, v21 quad_perm:[1,0,3,2] row_mask:0xf bank_mask:0xf
    v_add_f32_dpp v22, v22, v22 quad_perm:[1,0,3,2] row_mask:0xf bank_mask:0xf
    v_add_f32_dpp v23, v23, v23 quad_perm:[1,0,3,2] row_mask:0xf bank_mask:0xf
    v_add_f32_dpp v12, v12, v12 quad_perm:[2,3,0,1] row_mask:0xf bank_mask:0xf
    v_add_f32_dpp v13, v13, v13 quad_perm:[2,3,0,1] row_mask:0xf bank_mask:0xf
    v_add_f32_dpp v14, v14, v14 quad_perm:[2,3,0,1] row_mask:0xf bank_mask:0xf
    v_add_f32_dpp v15, v15, v15 quad_perm:[2,3,0,1] row_mask:0xf bank_mask:0xf
    v_add_f32_dpp v16, v16, v16 quad_perm:[2,3,0,1] row_mask:0xf bank_mask:0xf
    v_add_f32_dpp v17, v17, v17 quad_perm:[2,3,0,1] row_mask:0xf bank_mask:0xf
    v_add_f32_dpp v18, v18, v18 quad_perm:[2,3,0,1] row_mask:0xf bank_mask:0xf
    v_add_f32_dpp v19, v19, v19 quad_perm:[2,3,0,1] row_mask:0xf bank_mask:0xf
    v_add_f32_dpp v20, v20, v20 quad_perm:[2,3,0,1] row_mask:0xf bank_mask:0xf
    v_add_f32_dpp v21, v21, v21 quad_perm:[2,3,0,1] row_mask:0xf bank_mask:0xf
    v_add_f32_dpp v22, v22, v22 quad_perm:[2,3,0,1] row_mask:0xf bank_mask:0xf
    v_add_f32_dpp v23, v23, v23 quad_perm:[2,3,0,1] row_mask:0xf bank_mask:0xf
    s_mov_b32 s68, 0xaaaaaaaa
    s_mov_b32 s69, 0xaaaaaaaa
    s_mov_b32 s70, 0xcccccccc
    s_mov_b32 s71, 0xcccccccc
    v_lshrrev_b32 v64, 2, v1
    v_cndmask_b32 v12, v12, v13, s[68:69]
    v_cndmask_b32 v14, v14, v15, s[68:69]
    v_cndmask_b32 v12, v12, v14, s[70:71]
    v_cndmask_b32 v16, v16, v17, s[68:69]
    v_cndmask_b32 v18, v18, v19, s[68:69]
    v_cndmask_b32 v16, v16, v18, s[70:71]
    v_cndmask_b32 v20, v20, v21, s[68:69]
    v_cndmask_b32 v22, v22, v23, s[68:69]
    v_cndmask_b32 v20, v20, v22, s[70:71]
    s_and_b32 s52, s2, 3
    s_mul_i32 s52, s52, 3072
    s_mul_i32 s64, s3, 768
    s_add_u32 s64, s64, 393216
    s_add_u32 s52, s52, s64
    buffer_atomic_add_f32 v12, v64, s[16:19], s52 offen offset:0
    buffer_atomic_add_f32 v16, v64, s[16:19], s52 offen offset:256
    buffer_atomic_add_f32 v20, v64, s[16:19], s52 offen offset:512
    s_lshl_b32 s52, s3, 10
    v_add_u32 v65, s52, v1
    v_lshrrev_b32 v73, 4, v1
    v_bfe_u32 v74, v73, 2, 1
    v_bfe_u32 v75, v73, 3, 1
    v_lshl_add_u32 v74, v75, 1, v74
    v_mul_u32_u24 v74, 3, v74
    v_lshrrev_b32 v75, 4, v73
    v_and_b32 v73, 3, v73
    v_lshl_add_u32 v72, v75, 2, v73
    v_lshl_add_u32 v72, v74, 4, v72
    v_lshlrev_b32 v72, 1, v72
    s_add_u32 s53, s80, 9216
    buffer_load_dwordx4 a[172:175], v1, s[16:19], s53 offen sc1
    s_mov_b32 s20, s40
    s_mov_b32 s21, s41
    s_mov_b32 s22, 1536
    s_mov_b32 s23, 0x20000
    s_mul_i32 s52, s3, 384
    buffer_load_ushort v66, v72, s[20:23], s52 offen offset:0
    buffer_load_ushort v67, v72, s[20:23], s52 offen offset:32
    buffer_load_ushort v68, v72, s[20:23], s52 offen offset:64
    v_lshlrev_b32 v75, 6, v75
    v_lshl_add_u32 v75, v73, 4, v75
    s_mul_i32 s52, s3, 1536
    s_add_u32 s52, s52, 36864
    v_add_u32 v75, s52, v75
    s_add_u32 s53, s80, 10240
    buffer_load_dwordx4 a[176:179], v1, s[16:19], s53 offen sc1
    v_add_u32 v73, 0, v74
    v_lshrrev_b32 v69, 1, v73
    v_lshl_add_u32 v69, v69, 8, v75
    v_and_b32 v73, 1, v73
    v_lshl_add_u32 v69, v73, 3, v69
    v_add_u32 v73, 1, v74
    v_lshrrev_b32 v70, 1, v73
    v_lshl_add_u32 v70, v70, 8, v75
    v_and_b32 v73, 1, v73
    v_lshl_add_u32 v70, v73, 3, v70
    v_add_u32 v73, 2, v74
    v_lshrrev_b32 v71, 1, v73
    s_add_u32 s53, s80, 11264
    buffer_load_dwordx4 a[180:183], v1, s[16:19], s53 offen sc1
    v_lshl_add_u32 v71, v71, 8, v75
    v_and_b32 v73, 1, v73
    v_lshl_add_u32 v71, v73, 3, v71
    v_add_u32 v4, 68096, v1
    v_add_u32 v5, 51712, v1
    s_mul_i32 s52, s3, 2048
    v_add_u32 v6, s52, v5
    v_lshrrev_b32 v73, 4, v1
    v_and_b32 v74, 15, v73
    v_lshrrev_b32 v75, 4, v73
    v_lshlrev_b32 v9, 2, v74
    v_add_u32 v9, 49152, v9
    s_add_u32 s53, s80, 12288
    buffer_load_dwordx4 a[184:187], v1, s[16:19], s53 offen sc1
    s_lshl_b32 s52, s3, 1
    v_lshrrev_b32 v76, 1, v75
    v_add_u32 v76, s52, v76
    v_lshrrev_b32 v7, 1, v74
    v_xor_b32 v76, v76, v7
    v_lshlrev_b32 v76, 4, v76
    v_lshl_add_u32 v76, v74, 7, v76
    v_and_b32 v7, 1, v75
    v_lshl_add_u32 v7, v7, 3, v76
    v_add_u32 v7, 36864, v7
    v_add_u32 v8, 36864, v8
    s_lshl_b32 s52, s73, 4
    v_add_u32 v76, s52, v74
    s_add_u32 s53, s80, 13312
    buffer_load_dwordx4 a[188:191], v1, s[16:19], s53 offen sc1
    v_lshlrev_b32 v77, 3, v75
    v_add_u32 v85, 43008, v77
    v_sub_u32 v76, v76, v77
    v_mov_b32 v78, 0x3f80
    v_mov_b32 v79, 0x3f800000
    v_cmp_eq_u32 vcc, 0, v76
    v_cmp_eq_u32 s[68:69], 1, v76
    s_nop 1
    v_cndmask_b32 v77, 0, v78, vcc
    v_cndmask_b32 v77, v77, v79, s[68:69]
    v_accvgpr_write_b32 a96, v77
    v_cmp_eq_u32 vcc, 2, v76
    v_cmp_eq_u32 s[68:69], 3, v76
    s_nop 1
    v_cndmask_b32 v77, 0, v78, vcc
    s_add_u32 s53, s80, 14336
    buffer_load_dwordx4 a[192:195], v1, s[16:19], s53 offen sc1
    v_cndmask_b32 v77, v77, v79, s[68:69]
    v_accvgpr_write_b32 a97, v77
    v_cmp_eq_u32 vcc, 4, v76
    v_cmp_eq_u32 s[68:69], 5, v76
    s_nop 1
    v_cndmask_b32 v77, 0, v78, vcc
    v_cndmask_b32 v77, v77, v79, s[68:69]
    v_accvgpr_write_b32 a98, v77
    v_cmp_eq_u32 vcc, 6, v76
    v_cmp_eq_u32 s[68:69], 7, v76
    s_nop 1
    v_cndmask_b32 v77, 0, v78, vcc
    s_add_u32 s53, s80, 15360
    buffer_load_dwordx4 a[196:199], v1, s[16:19], s53 offen sc1
    v_cndmask_b32 v77, v77, v79, s[68:69]
    v_accvgpr_write_b32 a99, v77
    v_lshlrev_b32 v84, 4, v74
    v_add_u32 v84, 36864, v84
    s_mov_b32 s55, 36864
    s_add_u32 s62, s62, 36864
    s_add_u32 s56, s74, 73728
    s_add_u32 s57, s75, 94208
    s_mov_b32 s63, 68096
    s_mov_b32 s78, 20480
    s_mov_b32 s79, 12288
    s_mov_b32 s61, 0xffffd000
    s_mov_b32 s66, 0
    s_mov_b32 s67, 0
    s_mov_b32 s76, 0
    s_add_u32 s28, s16, 425984
    s_addc_u32 s29, s17, 0
    s_cmp_eq_u32 s3, 0
    s_cselect_b32 s30, 16384, 0
    s_mov_b32 s31, 0x20000
    v_mul_u32_u24 v77, 64, v1
    s_add_u32 s53, s80, 16384
    buffer_load_dwordx4 a[200:203], v1, s[16:19], s53 offen sc1
    s_lshr_b32 s65, s2, 3
    s_and_b32 s65, s65, 7
    s_lshl_b32 s65, s65, 7
    v_mov_b32 v47, 1
    s_waitcnt vmcnt(11)
    s_barrier
    buffer_atomic_add v47, v77, s[28:31], s65 offen
    ds_read2_b64 a[100:103], v85 offset0:136 offset1:140
    ds_read2_b64 a[104:107], v85 offset0:144 offset1:148
    ds_read2_b64 a[108:111], v85 offset0:152 offset1:156
    s_add_u32 s53, s80, 17408
    buffer_load_dwordx4 a[204:207], v1, s[16:19], s53 offen sc1
    s_waitcnt vmcnt(56) lgkmcnt(2)
    v_mfma_f32_16x16x32_bf16 v[12:15], v[172:175], a[100:103], 0
    ds_read2_b64 a[112:115], v85 offset0:184 offset1:188
    v_mfma_f32_16x16x32_bf16 v[16:19], v[176:179], a[100:103], 0
    v_mfma_f32_16x16x32_bf16 v[20:23], v[180:183], a[100:103], 0
    s_waitcnt vmcnt(39) lgkmcnt(2)
    v_mfma_f32_16x16x32_bf16 v[12:15], v[184:187], a[104:107], v[12:15]
    ds_read2_b64 a[116:119], v85 offset0:0 offset1:4
    v_mfma_f32_16x16x32_bf16 v[16:19], v[188:191], a[104:107], v[16:19]
    v_mfma_f32_16x16x32_bf16 v[20:23], v[192:195], a[104:107], v[20:23]
    s_add_u32 s53, s80, 18432
    buffer_load_dwordx4 a[208:211], v1, s[16:19], s53 offen sc1
    s_waitcnt vmcnt(36) lgkmcnt(2)
    v_mfma_f32_16x16x32_bf16 v[12:15], v[196:199], a[108:111], v[12:15]
    ds_read2_b64 a[120:123], v85 offset0:8 offset1:12
    v_mfma_f32_16x16x32_bf16 v[16:19], v[200:203], a[108:111], v[16:19]
    v_mfma_f32_16x16x32_bf16 v[20:23], v[204:207], a[108:111], v[20:23]
    s_waitcnt vmcnt(32) lgkmcnt(2)
    v_mfma_f32_16x16x32_bf16 v[12:15], v[244:247], a[112:115], v[12:15]
    ds_read2_b64 a[100:103], v85 offset0:16 offset1:20
    v_mfma_f32_16x16x32_bf16 v[16:19], v[248:251], a[112:115], v[16:19]
    v_mfma_f32_16x16x32_bf16 v[20:23], v[252:255], a[112:115], v[20:23]
    s_add_u32 s53, s80, 19456
    buffer_load_dwordx4 a[212:215], v1, s[16:19], s53 offen sc1
    s_waitcnt vmcnt(29) lgkmcnt(2)
    v_mfma_f32_16x16x32_bf16 v[12:15], a[136:139], a[116:119], v[12:15]
    ds_read2_b64 a[104:107], v85 offset0:24 offset1:28
    v_mfma_f32_16x16x32_bf16 v[16:19], a[140:143], a[116:119], v[16:19]
    v_mfma_f32_16x16x32_bf16 v[20:23], a[144:147], a[116:119], v[20:23]
    s_waitcnt vmcnt(25) lgkmcnt(2)
    v_mfma_f32_16x16x32_bf16 v[12:15], a[148:151], a[120:123], v[12:15]
    ds_read2_b64 a[108:111], v85 offset0:32 offset1:36
    v_mfma_f32_16x16x32_bf16 v[16:19], a[152:155], a[120:123], v[16:19]
    v_mfma_f32_16x16x32_bf16 v[20:23], a[156:159], a[120:123], v[20:23]
    s_add_u32 s53, s80, 20480
    buffer_load_dwordx4 a[216:219], v1, s[16:19], s53 offen sc1
    s_waitcnt vmcnt(22) lgkmcnt(2)
    v_mfma_f32_16x16x32_bf16 v[12:15], a[160:163], a[100:103], v[12:15]
    ds_read2_b64 a[112:115], v85 offset0:40 offset1:44
    v_mfma_f32_16x16x32_bf16 v[16:19], a[164:167], a[100:103], v[16:19]
    v_mfma_f32_16x16x32_bf16 v[20:23], a[168:171], a[100:103], v[20:23]
    s_waitcnt vmcnt(10) lgkmcnt(2)
    v_mfma_f32_16x16x32_bf16 v[12:15], a[172:175], a[104:107], v[12:15]
    ds_read2_b64 a[116:119], v85 offset0:48 offset1:52
    v_mfma_f32_16x16x32_bf16 v[16:19], a[176:179], a[104:107], v[16:19]
    v_mfma_f32_16x16x32_bf16 v[20:23], a[180:183], a[104:107], v[20:23]
    s_add_u32 s53, s80, 21504
    buffer_load_dwordx4 a[220:223], v1, s[16:19], s53 offen sc1
    s_waitcnt vmcnt(8) lgkmcnt(2)
    v_mfma_f32_16x16x32_bf16 v[12:15], a[184:187], a[108:111], v[12:15]
    ds_read2_b64 a[120:123], v85 offset0:56 offset1:60
    v_mfma_f32_16x16x32_bf16 v[16:19], a[188:191], a[108:111], v[16:19]
    v_mfma_f32_16x16x32_bf16 v[20:23], a[192:195], a[108:111], v[20:23]
    s_add_u32 s53, s80, 22528
    buffer_load_dwordx4 a[224:227], v1, s[16:19], s53 offen sc1
    s_add_u32 s53, s80, 23552
    buffer_load_dwordx4 a[228:231], v1, s[16:19], s53 offen sc1
    s_add_u32 s53, s80, 46080
    buffer_load_dwordx4 v[148:151], v1, s[16:19], s53 offen sc1
    s_add_u32 s53, s80, 47104
    buffer_load_dwordx4 v[152:155], v1, s[16:19], s53 offen sc1
    s_add_u32 s53, s80, 48128
    buffer_load_dwordx4 v[156:159], v1, s[16:19], s53 offen sc1
    s_add_u32 s53, s80, 49152
    buffer_load_dwordx4 v[160:163], v1, s[16:19], s53 offen sc1
    s_add_u32 s53, s80, 50176
    buffer_load_dwordx4 v[164:167], v1, s[16:19], s53 offen sc1
    s_add_u32 s53, s80, 51200
    buffer_load_dwordx4 v[168:171], v1, s[16:19], s53 offen sc1
    s_add_u32 s53, s80, 24576
    buffer_load_dwordx4 a[232:235], v1, s[16:19], s53 offen sc1
    s_waitcnt vmcnt(13) lgkmcnt(2)
    v_mfma_f32_16x16x32_bf16 v[12:15], a[196:199], a[112:115], v[12:15]
    ds_read2_b64 a[100:103], v85 offset0:120 offset1:124
    v_mfma_f32_16x16x32_bf16 v[16:19], a[200:203], a[112:115], v[16:19]
    v_mfma_f32_16x16x32_bf16 v[20:23], a[204:207], a[112:115], v[20:23]
    s_add_u32 s53, s80, 25600
    buffer_load_dwordx4 a[236:239], v1, s[16:19], s53 offen sc1
    s_add_u32 s53, s80, 26624
    buffer_load_dwordx4 a[240:243], v1, s[16:19], s53 offen sc1
    s_add_u32 s53, s80, 27648
    buffer_load_dwordx4 a[244:247], v1, s[16:19], s53 offen sc1
    s_waitcnt vmcnt(13) lgkmcnt(2)
    v_mfma_f32_16x16x32_bf16 v[12:15], a[208:211], a[116:119], v[12:15]
    ds_read2_b64 a[104:107], v85 offset0:128 offset1:132
    v_mfma_f32_16x16x32_bf16 v[16:19], a[212:215], a[116:119], v[16:19]
    v_mfma_f32_16x16x32_bf16 v[20:23], a[216:219], a[116:119], v[20:23]
    s_add_u32 s53, s80, 28672
    buffer_load_dwordx4 a[248:251], v1, s[16:19], s53 offen sc1
    s_add_u32 s53, s80, 29696
    buffer_load_dwordx4 a[252:255], v1, s[16:19], s53 offen sc1
    s_add_u32 s53, s80, 36864
    buffer_load_dwordx4 v[112:115], v1, s[16:19], s53 offen sc1
    s_waitcnt vmcnt(13) lgkmcnt(2)
    v_mfma_f32_16x16x32_bf16 v[12:15], a[220:223], a[120:123], v[12:15]
    ds_read2_b64 a[108:111], v85 offset0:64 offset1:68
    v_mfma_f32_16x16x32_bf16 v[16:19], a[224:227], a[120:123], v[16:19]
    v_mfma_f32_16x16x32_bf16 v[20:23], a[228:231], a[120:123], v[20:23]
    s_cmp_lg_u32 s3, 0
    s_cbranch_scc1 L_arr_ok
    s_and_b32 s52, s2, 15
    s_mul_i32 s52, s52, 1024
    v_lshrrev_b32 v73, 4, v1
    v_and_b32 v73, 7, v73
    v_lshlrev_b32 v73, 7, v73
    s_mov_b32 s54, 65536
L_arr:
    buffer_load_dword v47, v73, s[28:31], s52 offen sc1
    s_sub_u32 s54, s54, 1
    s_waitcnt vmcnt(0)
    v_cmp_gt_u32 vcc, 32, v47
    s_nop 4
    s_cbranch_vccz L_arr_ok
    s_cmp_lg_u32 s54, 0
    s_cbranch_scc1 L_arr
L_arr_ok:
    s_barrier
    s_add_u32 s52, s64, 0
    buffer_load_dword v24, v64, s[16:19], s52 offen offset:0 sc1
    buffer_load_dword v25, v64, s[16:19], s52 offen offset:256 sc1
    buffer_load_dword v26, v64, s[16:19], s52 offen offset:512 sc1
    s_add_u32 s52, s64, 3072
    buffer_load_dword v27, v64, s[16:19], s52 offen offset:0 sc1
    buffer_load_dword v28, v64, s[16:19], s52 offen offset:256 sc1
    buffer_load_dword v29, v64, s[16:19], s52 offen offset:512 sc1
    s_add_u32 s52, s64, 6144
    buffer_load_dword v30, v64, s[16:19], s52 offen offset:0 sc1
    buffer_load_dword v31, v64, s[16:19], s52 offen offset:256 sc1
    buffer_load_dword v32, v64, s[16:19], s52 offen offset:512 sc1
    s_add_u32 s52, s64, 9216
    buffer_load_dword v33, v64, s[16:19], s52 offen offset:0 sc1
    buffer_load_dword v34, v64, s[16:19], s52 offen offset:256 sc1
    buffer_load_dword v35, v64, s[16:19], s52 offen offset:512 sc1
    v_lshrrev_b32 v75, 8, v65
    v_lshlrev_b32 v75, 2, v75
    v_add_u32 v75, 45056, v75
    v_and_b32 v76, 60, v64
    v_add_u32 v76, 45056, v76
    v_mov_b32 v73, 0x358637bd
    s_add_u32 s53, s80, 37888
    buffer_load_dwordx4 v[116:119], v1, s[16:19], s53 offen sc1
    s_add_u32 s53, s80, 38912
    buffer_load_dwordx4 v[120:123], v1, s[16:19], s53 offen sc1
    s_add_u32 s53, s80, 39936
    buffer_load_dwordx4 v[124:127], v1, s[16:19], s53 offen sc1
    s_add_u32 s53, s80, 40960
    buffer_load_dwordx4 v[128:131], v1, s[16:19], s53 offen sc1
    s_add_u32 s53, s80, 41984
    buffer_load_dwordx4 v[132:135], v1, s[16:19], s53 offen sc1
    s_add_u32 s53, s80, 43008
    buffer_load_dwordx4 v[136:139], v1, s[16:19], s53 offen sc1
    s_waitcnt lgkmcnt(2)
    v_mfma_f32_16x16x32_bf16 v[12:15], v[148:151], a[100:103], v[12:15]
    ds_read2_b64 a[112:115], v85 offset0:72 offset1:76
    v_mfma_f32_16x16x32_bf16 v[16:19], v[152:155], a[100:103], v[16:19]
    v_mfma_f32_16x16x32_bf16 v[20:23], v[156:159], a[100:103], v[20:23]
    s_waitcnt lgkmcnt(2)
    v_mfma_f32_16x16x32_bf16 v[12:15], v[160:163], a[104:107], v[12:15]
    v_mfma_f32_16x16x32_bf16 v[16:19], v[164:167], a[104:107], v[16:19]
    v_mfma_f32_16x16x32_bf16 v[20:23], v[168:171], a[104:107], v[20:23]
    s_waitcnt lgkmcnt(1)
    v_mfma_f32_16x16x32_bf16 v[12:15], a[232:235], a[108:111], v[12:15]
    v_mfma_f32_16x16x32_bf16 v[16:19], a[236:239], a[108:111], v[16:19]
    v_mfma_f32_16x16x32_bf16 v[20:23], a[240:243], a[108:111], v[20:23]
    s_waitcnt lgkmcnt(0)
    v_mfma_f32_16x16x32_bf16 v[12:15], a[244:247], a[112:115], v[12:15]
    v_mfma_f32_16x16x32_bf16 v[16:19], a[248:251], a[112:115], v[16:19]
    v_mfma_f32_16x16x32_bf16 v[20:23], a[252:255], a[112:115], v[20:23]
    v_lshrrev_b32 v77, 4, v1
    v_bfe_u32 v78, v77, 2, 2
    v_lshrrev_b32 v79, 4, v77
    v_cmp_eq_u32 vcc, v78, v79
    v_and_b32 v78, 1, v77
    v_lshlrev_b32 v78, 4, v78
    v_mov_b32 v79, 0xffff
    v_lshlrev_b32 v78, v78, v79
    v_cndmask_b32 v78, 0, v78, vcc
    v_bfe_i32 v79, v77, 1, 1
    v_and_b32 v87, v78, v79
    v_xor_b32 v72, v78, v87
    ds_read_b128 a[100:103], v3 offset:0
    ds_read_b128 a[104:107], v3 offset:2048
    ds_read_b128 a[108:111], v3 offset:4096
    ds_read_b128 a[112:115], v2 offset:0
    ds_read_b128 a[116:119], v2 offset:2048
    ds_read_b128 a[120:123], v2 offset:4096
    ds_read_b32 v86, v9
    s_waitcnt lgkmcnt(0)
    v_mfma_f32_16x16x32_bf16 v[48:51], a[12:15], a[100:103], 0
    v_mfma_f32_16x16x32_bf16 v[52:55], a[36:39], a[100:103], 0
    v_mfma_f32_16x16x32_bf16 v[48:51], a[16:19], a[104:107], v[48:51]
    v_mfma_f32_16x16x32_bf16 v[52:55], a[40:43], a[104:107], v[52:55]
    v_mfma_f32_16x16x32_bf16 v[48:51], a[20:23], a[108:111], v[48:51]
    v_mfma_f32_16x16x32_bf16 v[52:55], a[44:47], a[108:111], v[52:55]
    v_mfma_f32_16x16x32_bf16 v[48:51], a[0:3], a[112:115], v[48:51]
    v_mfma_f32_16x16x32_bf16 v[52:55], a[24:27], a[112:115], v[52:55]
    v_mfma_f32_16x16x32_bf16 v[48:51], a[4:7], a[116:119], v[48:51]
    v_mfma_f32_16x16x32_bf16 v[52:55], a[28:31], a[116:119], v[52:55]
    v_mfma_f32_16x16x32_bf16 v[48:51], a[8:11], a[120:123], v[48:51]
    v_mfma_f32_16x16x32_bf16 v[52:55], a[32:35], a[120:123], v[52:55]
    s_nop 7
    v_mul_f32 v48, v86, v48
    v_mul_f32 v49, v86, v49
    v_fma_f32 v80, v48, v48, s50
    v_fma_f32 v81, v49, v49, s50
    v_mul_f32 v80, v80, v48
    v_mul_f32 v81, v81, v49
    v_exp_f32 v80, v80
    v_exp_f32 v81, v81
    v_add_f32 v80, 1.0, v80
    v_add_f32 v81, 1.0, v81
    v_rcp_f32 v80, v80
    v_rcp_f32 v81, v81
    v_mul_f32 v48, v48, v80
    v_mul_f32 v49, v49, v81
    v_cvt_pk_bf16_f32 v48, v48, v49
    v_mul_f32 v50, v86, v50
    v_mul_f32 v51, v86, v51
    v_fma_f32 v82, v50, v50, s50
    v_fma_f32 v83, v51, v51, s50
    v_mul_f32 v82, v82, v50
    v_mul_f32 v83, v83, v51
    v_exp_f32 v82, v82
    v_exp_f32 v83, v83
    v_add_f32 v82, 1.0, v82
    v_add_f32 v83, 1.0, v83
    v_rcp_f32 v82, v82
    v_rcp_f32 v83, v83
    v_mul_f32 v50, v50, v82
    v_mul_f32 v51, v51, v83
    v_cvt_pk_bf16_f32 v49, v50, v51
    v_mul_f32 v52, v86, v52
    v_mul_f32 v53, v86, v53
    v_fma_f32 v80, v52, v52, s50
    v_fma_f32 v81, v53, v53, s50
    v_mul_f32 v80, v80, v52
    v_mul_f32 v81, v81, v53
    s_waitcnt vmcnt(6)
    v_lshlrev_b32 v66, 16, v66
    v_lshlrev_b32 v67, 16, v67
    v_lshlrev_b32 v68, 16, v68
    v_add_f32 v24, v24, v27
    v_add_f32 v25, v25, v28
    v_add_f32 v26, v26, v29
    v_add_f32 v24, v24, v30
    v_add_f32 v25, v25, v31
    v_add_f32 v26, v26, v32
    v_add_f32 v24, v24, v33
    v_add_f32 v25, v25, v34
    v_add_f32 v26, v26, v35
    v_fmamk_f32 v24, v24, 0x4091afa4, v73
    v_fmamk_f32 v25, v25, 0x4091afa4, v73
    v_fmamk_f32 v26, v26, 0x4091afa4, v73
    v_sqrt_f32 v24, v24
    v_sqrt_f32 v25, v25
    v_sqrt_f32 v26, v26
    s_nop 0
    v_add_f32 v74, v24, v25
    v_add_f32 v74, v74, v26
    v_mul_f32 v24, v24, v66
    s_nop 0
    v_add_f32_dpp v74, v74, v74 quad_perm:[1,0,3,2] row_mask:0xf bank_mask:0xf
    v_mul_f32 v25, v25, v67
    s_nop 0
    v_add_f32_dpp v74, v74, v74 quad_perm:[2,3,0,1] row_mask:0xf bank_mask:0xf
    v_mul_f32 v26, v26, v68
    s_nop 0
    v_add_f32_dpp v74, v74, v74 row_half_mirror row_mask:0xf bank_mask:0xf
    s_nop 0
    s_nop 0
    v_add_f32_dpp v74, v74, v74 row_mirror row_mask:0xf bank_mask:0xf
    ds_write_b32 v75, v74
    s_waitcnt lgkmcnt(0)
    s_barrier
    ds_read_b32 v74, v76
    s_waitcnt lgkmcnt(0)
    v_add_f32_dpp v74, v74, v74 quad_perm:[1,0,3,2] row_mask:0xf bank_mask:0xf
    s_nop 1
    v_add_f32_dpp v74, v74, v74 quad_perm:[2,3,0,1] row_mask:0xf bank_mask:0xf
    s_nop 1
    v_add_f32_dpp v74, v74, v74 row_half_mirror row_mask:0xf bank_mask:0xf
    s_nop 1
    v_add_f32_dpp v74, v74, v74 row_mirror row_mask:0xf bank_mask:0xf
    s_nop 1
    v_fmamk_f32 v74, v74, 0x3aaaaaab, v73
    v_rcp_f32 v74, v74
    v_mov_b32 v73, 0xc0088e99
    v_mul_f32 v74, v74, v73
    v_fma_f32 v24, v24, v74, v73
    v_fma_f32 v25, v25, v74, v73
    v_fma_f32 v26, v26, v74, v73
    v_cvt_pk_bf16_f32 v28, v24, v24
    v_cvt_pk_bf16_f32 v30, v25, v25
    v_cvt_pk_bf16_f32 v32, v26, v26
    v_and_b32 v29, s77, v28
    v_and_b32 v31, s77, v30
    v_and_b32 v33, s77, v32
    v_sub_f32 v24, v24, v29
    v_sub_f32 v25, v25, v31
    v_sub_f32 v26, v26, v33
    v_cvt_pk_bf16_f32 v29, v24, v24
    v_cvt_pk_bf16_f32 v31, v25, v25
    v_cvt_pk_bf16_f32 v33, v26, v26
    ds_write_b64 v69, v[28:29]
    ds_write_b64 v70, v[30:31]
    ds_write_b64 v71, v[32:33]
    v_mov_b32 v10, v72
    v_mov_b32 v66, 0
    v_mov_b32 v67, 0
    v_mov_b32 v72, 0
    v_mov_b32 v73, 0
    s_waitcnt lgkmcnt(0)
    s_barrier
    ds_read_b128 v[76:79], v84 offset:4352
    s_waitcnt lgkmcnt(0)
    v_and_b32 v64, v10, v76
    v_and_b32 v65, v87, v76
    v_and_b32 v68, v10, v78
    v_and_b32 v69, v87, v78
    v_and_b32 v70, v10, v77
    v_and_b32 v71, v87, v77
    v_and_b32 v74, v10, v79
    v_and_b32 v75, v87, v79
    ds_read_b128 v[76:79], v84 offset:4608
    v_mfma_f32_16x16x32_bf16 v[24:27], v[64:67], v[172:175], 0
    v_mfma_f32_16x16x32_bf16 v[28:31], v[66:69], v[172:175], 0
    s_add_u32 s53, s80, 44032
    buffer_load_dwordx4 v[140:143], v1, s[16:19], s53 offen sc1
    v_mfma_f32_16x16x32_bf16 v[24:27], v[70:73], v[172:175], v[24:27]
    v_mfma_f32_16x16x32_bf16 v[28:31], v[72:75], v[172:175], v[28:31]
    v_mfma_f32_16x16x32_bf16 v[32:35], v[64:67], v[176:179], 0
    v_mfma_f32_16x16x32_bf16 v[36:39], v[66:69], v[176:179], 0
    s_add_u32 s53, s80, 45056
    buffer_load_dwordx4 v[144:147], v1, s[16:19], s53 offen sc1
    v_mfma_f32_16x16x32_bf16 v[32:35], v[70:73], v[176:179], v[32:35]
    v_mfma_f32_16x16x32_bf16 v[36:39], v[72:75], v[176:179], v[36:39]
    v_mfma_f32_16x16x32_bf16 v[40:43], v[64:67], v[180:183], 0
    s_waitcnt lgkmcnt(0)
    v_and_b32 v64, v10, v76
    v_and_b32 v65, v87, v76
    v_cvt_pk_bf16_f32 v172, v24, v25
    v_mfma_f32_16x16x32_bf16 v[44:47], v[66:69], v[180:183], 0
    s_add_u32 s53, s80, 61440
    buffer_load_dwordx4 v[208:211], v1, s[16:19], s53 offen sc1
    v_and_b32 v68, v10, v78
    v_and_b32 v69, v87, v78
    v_cvt_pk_bf16_f32 v173, v26, v27
    v_mfma_f32_16x16x32_bf16 v[40:43], v[70:73], v[180:183], v[40:43]
    v_and_b32 v70, v10, v77
    v_and_b32 v71, v87, v77
    v_cvt_pk_bf16_f32 v174, v28, v29
    v_mfma_f32_16x16x32_bf16 v[44:47], v[72:75], v[180:183], v[44:47]
    v_and_b32 v74, v10, v79
    v_and_b32 v75, v87, v79
    v_cvt_pk_bf16_f32 v175, v30, v31
    v_mfma_f32_16x16x32_bf16 v[24:27], v[64:67], v[184:187], 0
    ds_read_b128 v[76:79], v84 offset:4864
    v_cvt_pk_bf16_f32 v176, v32, v33
    v_mfma_f32_16x16x32_bf16 v[28:31], v[66:69], v[184:187], 0
    s_add_u32 s53, s80, 62464
    buffer_load_dwordx4 v[212:215], v1, s[16:19], s53 offen sc1
    v_cvt_pk_bf16_f32 v177, v34, v35
    v_mfma_f32_16x16x32_bf16 v[24:27], v[70:73], v[184:187], v[24:27]
    v_cvt_pk_bf16_f32 v178, v36, v37
    v_mfma_f32_16x16x32_bf16 v[28:31], v[72:75], v[184:187], v[28:31]
    v_cvt_pk_bf16_f32 v179, v38, v39
    v_mfma_f32_16x16x32_bf16 v[32:35], v[64:67], v[188:191], 0
    v_cvt_pk_bf16_f32 v180, v40, v41
    v_mfma_f32_16x16x32_bf16 v[36:39], v[66:69], v[188:191], 0
    s_add_u32 s53, s80, 63488
    buffer_load_dwordx4 v[216:219], v1, s[16:19], s53 offen sc1
    v_cvt_pk_bf16_f32 v181, v42, v43
    v_mfma_f32_16x16x32_bf16 v[32:35], v[70:73], v[188:191], v[32:35]
    v_cvt_pk_bf16_f32 v182, v44, v45
    v_mfma_f32_16x16x32_bf16 v[36:39], v[72:75], v[188:191], v[36:39]
    v_cvt_pk_bf16_f32 v183, v46, v47
    v_mfma_f32_16x16x32_bf16 v[40:43], v[64:67], v[192:195], 0
    s_waitcnt lgkmcnt(0)
    v_and_b32 v64, v10, v76
    v_and_b32 v65, v87, v76
    v_cvt_pk_bf16_f32 v184, v24, v25
    v_mfma_f32_16x16x32_bf16 v[44:47], v[66:69], v[192:195], 0
    s_add_u32 s53, s80, 64512
    buffer_load_dwordx4 v[220:223], v1, s[16:19], s53 offen sc1
    v_and_b32 v68, v10, v78
    v_and_b32 v69, v87, v78
    v_cvt_pk_bf16_f32 v185, v26, v27
    v_mfma_f32_16x16x32_bf16 v[40:43], v[70:73], v[192:195], v[40:43]
    v_and_b32 v70, v10, v77
    v_and_b32 v71, v87, v77
    v_cvt_pk_bf16_f32 v186, v28, v29
    v_mfma_f32_16x16x32_bf16 v[44:47], v[72:75], v[192:195], v[44:47]
    v_and_b32 v74, v10, v79
    v_and_b32 v75, v87, v79
    v_cvt_pk_bf16_f32 v187, v30, v31
    v_mfma_f32_16x16x32_bf16 v[24:27], v[64:67], v[196:199], 0
    ds_read_b128 v[76:79], v84 offset:5888
    v_cvt_pk_bf16_f32 v188, v32, v33
    v_mfma_f32_16x16x32_bf16 v[28:31], v[66:69], v[196:199], 0
    s_add_u32 s53, s80, 65536
    buffer_load_dwordx4 v[224:227], v1, s[16:19], s53 offen sc1
    v_cvt_pk_bf16_f32 v189, v34, v35
    v_mfma_f32_16x16x32_bf16 v[24:27], v[70:73], v[196:199], v[24:27]
    v_cvt_pk_bf16_f32 v190, v36, v37
    v_mfma_f32_16x16x32_bf16 v[28:31], v[72:75], v[196:199], v[28:31]
    v_cvt_pk_bf16_f32 v191, v38, v39
    v_mfma_f32_16x16x32_bf16 v[32:35], v[64:67], v[200:203], 0
    v_cvt_pk_bf16_f32 v192, v40, v41
    v_mfma_f32_16x16x32_bf16 v[36:39], v[66:69], v[200:203], 0
    s_add_u32 s53, s80, 66560
    buffer_load_dwordx4 v[228:231], v1, s[16:19], s53 offen sc1
    v_cvt_pk_bf16_f32 v193, v42, v43
    v_mfma_f32_16x16x32_bf16 v[32:35], v[70:73], v[200:203], v[32:35]
    v_cvt_pk_bf16_f32 v194, v44, v45
    v_mfma_f32_16x16x32_bf16 v[36:39], v[72:75], v[200:203], v[36:39]
    v_cvt_pk_bf16_f32 v195, v46, v47
    v_mfma_f32_16x16x32_bf16 v[40:43], v[64:67], v[204:207], 0
    s_waitcnt lgkmcnt(0)
    v_and_b32 v64, v10, v76
    v_and_b32 v65, v87, v76
    v_cvt_pk_bf16_f32 v196, v24, v25
    v_mfma_f32_16x16x32_bf16 v[44:47], v[66:69], v[204:207], 0
    s_add_u32 s53, s80, 67584
    buffer_load_dwordx4 v[232:235], v1, s[16:19], s53 offen sc1
    v_and_b32 v68, v10, v78
    v_and_b32 v69, v87, v78
    v_cvt_pk_bf16_f32 v197, v26, v27
    v_mfma_f32_16x16x32_bf16 v[40:43], v[70:73], v[204:207], v[40:43]
    v_and_b32 v70, v10, v77
    v_and_b32 v71, v87, v77
    v_cvt_pk_bf16_f32 v198, v28, v29
    v_mfma_f32_16x16x32_bf16 v[44:47], v[72:75], v[204:207], v[44:47]
    v_and_b32 v74, v10, v79
    v_and_b32 v75, v87, v79
    v_cvt_pk_bf16_f32 v199, v30, v31
    v_mfma_f32_16x16x32_bf16 v[24:27], v[64:67], v[244:247], 0
    ds_read_b128 v[76:79], v84 offset:0
    v_cvt_pk_bf16_f32 v200, v32, v33
    v_mfma_f32_16x16x32_bf16 v[28:31], v[66:69], v[244:247], 0
    s_add_u32 s53, s80, 68608
    buffer_load_dwordx4 v[236:239], v1, s[16:19], s53 offen sc1
    v_cvt_pk_bf16_f32 v201, v34, v35
    v_mfma_f32_16x16x32_bf16 v[24:27], v[70:73], v[244:247], v[24:27]
    v_cvt_pk_bf16_f32 v202, v36, v37
    v_mfma_f32_16x16x32_bf16 v[28:31], v[72:75], v[244:247], v[28:31]
    v_cvt_pk_bf16_f32 v203, v38, v39
    v_mfma_f32_16x16x32_bf16 v[32:35], v[64:67], v[248:251], 0
    v_cvt_pk_bf16_f32 v204, v40, v41
    v_mfma_f32_16x16x32_bf16 v[36:39], v[66:69], v[248:251], 0
    s_add_u32 s53, s80, 69632
    buffer_load_dwordx4 v[240:243], v1, s[16:19], s53 offen sc1
    v_cvt_pk_bf16_f32 v205, v42, v43
    v_mfma_f32_16x16x32_bf16 v[32:35], v[70:73], v[248:251], v[32:35]
    v_cvt_pk_bf16_f32 v206, v44, v45
    v_mfma_f32_16x16x32_bf16 v[36:39], v[72:75], v[248:251], v[36:39]
    v_cvt_pk_bf16_f32 v207, v46, v47
    v_mfma_f32_16x16x32_bf16 v[40:43], v[64:67], v[252:255], 0
    s_waitcnt lgkmcnt(0)
    v_and_b32 v64, v10, v76
    v_and_b32 v65, v87, v76
    v_cvt_pk_bf16_f32 v244, v24, v25
    v_mfma_f32_16x16x32_bf16 v[44:47], v[66:69], v[252:255], 0
    s_add_u32 s53, s80, 30720
    buffer_load_dwordx4 v[88:91], v1, s[16:19], s53 offen sc1
    v_and_b32 v68, v10, v78
    v_and_b32 v69, v87, v78
    v_cvt_pk_bf16_f32 v245, v26, v27
    v_mfma_f32_16x16x32_bf16 v[40:43], v[70:73], v[252:255], v[40:43]
    v_and_b32 v70, v10, v77
    v_and_b32 v71, v87, v77
    v_cvt_pk_bf16_f32 v246, v28, v29
    v_mfma_f32_16x16x32_bf16 v[44:47], v[72:75], v[252:255], v[44:47]
    v_and_b32 v74, v10, v79
    v_and_b32 v75, v87, v79
    v_cvt_pk_bf16_f32 v247, v30, v31
    v_mfma_f32_16x16x32_bf16 v[24:27], v[64:67], a[136:139], 0
    ds_read_b128 v[76:79], v84 offset:256
    v_cvt_pk_bf16_f32 v248, v32, v33
    v_mfma_f32_16x16x32_bf16 v[28:31], v[66:69], a[136:139], 0
    s_add_u32 s53, s80, 31744
    buffer_load_dwordx4 v[92:95], v1, s[16:19], s53 offen sc1
    v_cvt_pk_bf16_f32 v249, v34, v35
    v_mfma_f32_16x16x32_bf16 v[24:27], v[70:73], a[136:139], v[24:27]
    v_cvt_pk_bf16_f32 v250, v36, v37
    v_mfma_f32_16x16x32_bf16 v[28:31], v[72:75], a[136:139], v[28:31]
    v_cvt_pk_bf16_f32 v251, v38, v39
    v_mfma_f32_16x16x32_bf16 v[32:35], v[64:67], a[140:143], 0
    v_cvt_pk_bf16_f32 v252, v40, v41
    v_mfma_f32_16x16x32_bf16 v[36:39], v[66:69], a[140:143], 0
    s_add_u32 s53, s80, 32768
    buffer_load_dwordx4 v[96:99], v1, s[16:19], s53 offen sc1
    v_cvt_pk_bf16_f32 v253, v42, v43
    v_mfma_f32_16x16x32_bf16 v[32:35], v[70:73], a[140:143], v[32:35]
    v_cvt_pk_bf16_f32 v254, v44, v45
    v_mfma_f32_16x16x32_bf16 v[36:39], v[72:75], a[140:143], v[36:39]
    v_cvt_pk_bf16_f32 v255, v46, v47
    v_mfma_f32_16x16x32_bf16 v[40:43], v[64:67], a[144:147], 0
    s_waitcnt lgkmcnt(0)
    v_and_b32 v64, v10, v76
    v_and_b32 v65, v87, v76
    v_cvt_pk_bf16_f32 v24, v24, v25
    v_accvgpr_write_b32 a136, v24
    v_mfma_f32_16x16x32_bf16 v[44:47], v[66:69], a[144:147], 0
    s_add_u32 s53, s80, 33792
    buffer_load_dwordx4 v[100:103], v1, s[16:19], s53 offen sc1
    v_and_b32 v68, v10, v78
    v_and_b32 v69, v87, v78
    v_cvt_pk_bf16_f32 v26, v26, v27
    v_accvgpr_write_b32 a137, v26
    v_mfma_f32_16x16x32_bf16 v[40:43], v[70:73], a[144:147], v[40:43]
    v_and_b32 v70, v10, v77
    v_and_b32 v71, v87, v77
    v_cvt_pk_bf16_f32 v28, v28, v29
    v_accvgpr_write_b32 a138, v28
    v_mfma_f32_16x16x32_bf16 v[44:47], v[72:75], a[144:147], v[44:47]
    v_and_b32 v74, v10, v79
    v_and_b32 v75, v87, v79
    v_cvt_pk_bf16_f32 v30, v30, v31
    v_accvgpr_write_b32 a139, v30
    v_mfma_f32_16x16x32_bf16 v[24:27], v[64:67], a[148:151], 0
    ds_read_b128 v[76:79], v84 offset:512
    v_cvt_pk_bf16_f32 v32, v32, v33
    v_accvgpr_write_b32 a140, v32
    v_mfma_f32_16x16x32_bf16 v[28:31], v[66:69], a[148:151], 0
    s_add_u32 s53, s80, 34816
    buffer_load_dwordx4 v[104:107], v1, s[16:19], s53 offen sc1
    v_cvt_pk_bf16_f32 v34, v34, v35
    v_accvgpr_write_b32 a141, v34
    v_mfma_f32_16x16x32_bf16 v[24:27], v[70:73], a[148:151], v[24:27]
    v_cvt_pk_bf16_f32 v36, v36, v37
    v_accvgpr_write_b32 a142, v36
    v_mfma_f32_16x16x32_bf16 v[28:31], v[72:75], a[148:151], v[28:31]
    v_cvt_pk_bf16_f32 v38, v38, v39
    v_accvgpr_write_b32 a143, v38
    v_mfma_f32_16x16x32_bf16 v[32:35], v[64:67], a[152:155], 0
    v_cvt_pk_bf16_f32 v40, v40, v41
    v_accvgpr_write_b32 a144, v40
    v_mfma_f32_16x16x32_bf16 v[36:39], v[66:69], a[152:155], 0
    s_add_u32 s53, s80, 35840
    buffer_load_dwordx4 v[108:111], v1, s[16:19], s53 offen sc1
    v_cvt_pk_bf16_f32 v42, v42, v43
    v_accvgpr_write_b32 a145, v42
    v_mfma_f32_16x16x32_bf16 v[32:35], v[70:73], a[152:155], v[32:35]
    v_cvt_pk_bf16_f32 v44, v44, v45
    v_accvgpr_write_b32 a146, v44
    v_mfma_f32_16x16x32_bf16 v[36:39], v[72:75], a[152:155], v[36:39]
    v_cvt_pk_bf16_f32 v46, v46, v47
    v_accvgpr_write_b32 a147, v46
    v_mfma_f32_16x16x32_bf16 v[40:43], v[64:67], a[156:159], 0
    s_waitcnt lgkmcnt(0)
    v_and_b32 v64, v10, v76
    v_and_b32 v65, v87, v76
    v_cvt_pk_bf16_f32 v24, v24, v25
    v_accvgpr_write_b32 a148, v24
    v_mfma_f32_16x16x32_bf16 v[44:47], v[66:69], a[156:159], 0
    s_add_u32 s53, s81, 12288
    buffer_load_dwordx4 a[48:51], v1, s[16:19], s53 offen sc1
    v_and_b32 v68, v10, v78
    v_and_b32 v69, v87, v78
    v_cvt_pk_bf16_f32 v26, v26, v27
    v_accvgpr_write_b32 a149, v26
    v_mfma_f32_16x16x32_bf16 v[40:43], v[70:73], a[156:159], v[40:43]
    v_and_b32 v70, v10, v77
    v_and_b32 v71, v87, v77
    v_cvt_pk_bf16_f32 v28, v28, v29
    v_accvgpr_write_b32 a150, v28
    v_mfma_f32_16x16x32_bf16 v[44:47], v[72:75], a[156:159], v[44:47]
    v_and_b32 v74, v10, v79
    v_and_b32 v75, v87, v79
    v_cvt_pk_bf16_f32 v30, v30, v31
    v_accvgpr_write_b32 a151, v30
    v_mfma_f32_16x16x32_bf16 v[24:27], v[64:67], a[160:163], 0
    ds_read_b128 v[76:79], v84 offset:768
    v_cvt_pk_bf16_f32 v32, v32, v33
    v_accvgpr_write_b32 a152, v32
    v_mfma_f32_16x16x32_bf16 v[28:31], v[66:69], a[160:163], 0
    s_add_u32 s53, s81, 13312
    buffer_load_dwordx4 a[52:55], v1, s[16:19], s53 offen sc1
    v_cvt_pk_bf16_f32 v34, v34, v35
    v_accvgpr_write_b32 a153, v34
    v_mfma_f32_16x16x32_bf16 v[24:27], v[70:73], a[160:163], v[24:27]
    v_cvt_pk_bf16_f32 v36, v36, v37
    v_accvgpr_write_b32 a154, v36
    v_mfma_f32_16x16x32_bf16 v[28:31], v[72:75], a[160:163], v[28:31]
    v_cvt_pk_bf16_f32 v38, v38, v39
    v_accvgpr_write_b32 a155, v38
    v_mfma_f32_16x16x32_bf16 v[32:35], v[64:67], a[164:167], 0
    v_cvt_pk_bf16_f32 v40, v40, v41
    v_accvgpr_write_b32 a156, v40
    v_mfma_f32_16x16x32_bf16 v[36:39], v[66:69], a[164:167], 0
    s_add_u32 s53, s81, 14336
    buffer_load_dwordx4 a[56:59], v1, s[16:19], s53 offen sc1
    v_cvt_pk_bf16_f32 v42, v42, v43
    v_accvgpr_write_b32 a157, v42
    v_mfma_f32_16x16x32_bf16 v[32:35], v[70:73], a[164:167], v[32:35]
    v_cvt_pk_bf16_f32 v44, v44, v45
    v_accvgpr_write_b32 a158, v44
    v_mfma_f32_16x16x32_bf16 v[36:39], v[72:75], a[164:167], v[36:39]
    v_cvt_pk_bf16_f32 v46, v46, v47
    v_accvgpr_write_b32 a159, v46
    v_mfma_f32_16x16x32_bf16 v[40:43], v[64:67], a[168:171], 0
    s_waitcnt lgkmcnt(0)
    v_and_b32 v64, v10, v76
    v_and_b32 v65, v87, v76
    v_cvt_pk_bf16_f32 v24, v24, v25
    v_accvgpr_write_b32 a160, v24
    v_mfma_f32_16x16x32_bf16 v[44:47], v[66:69], a[168:171], 0
    s_add_u32 s53, s81, 15360
    buffer_load_dwordx4 a[60:63], v1, s[16:19], s53 offen sc1
    v_and_b32 v68, v10, v78
    v_and_b32 v69, v87, v78
    v_cvt_pk_bf16_f32 v26, v26, v27
    v_accvgpr_write_b32 a161, v26
    v_mfma_f32_16x16x32_bf16 v[40:43], v[70:73], a[168:171], v[40:43]
    v_and_b32 v70, v10, v77
    v_and_b32 v71, v87, v77
    v_cvt_pk_bf16_f32 v28, v28, v29
    v_accvgpr_write_b32 a162, v28
    v_mfma_f32_16x16x32_bf16 v[44:47], v[72:75], a[168:171], v[44:47]
    v_and_b32 v74, v10, v79
    v_and_b32 v75, v87, v79
    v_cvt_pk_bf16_f32 v30, v30, v31
    v_accvgpr_write_b32 a163, v30
    v_mfma_f32_16x16x32_bf16 v[24:27], v[64:67], a[172:175], 0
    ds_read_b128 v[76:79], v84 offset:1024
    v_cvt_pk_bf16_f32 v32, v32, v33
    v_accvgpr_write_b32 a164, v32
    v_mfma_f32_16x16x32_bf16 v[28:31], v[66:69], a[172:175], 0
    s_add_u32 s53, s81, 16384
    buffer_load_dwordx4 a[64:67], v1, s[16:19], s53 offen sc1
    v_cvt_pk_bf16_f32 v34, v34, v35
    v_accvgpr_write_b32 a165, v34
    v_mfma_f32_16x16x32_bf16 v[24:27], v[70:73], a[172:175], v[24:27]
    v_cvt_pk_bf16_f32 v36, v36, v37
    v_accvgpr_write_b32 a166, v36
    v_mfma_f32_16x16x32_bf16 v[28:31], v[72:75], a[172:175], v[28:31]
    v_cvt_pk_bf16_f32 v38, v38, v39
    v_accvgpr_write_b32 a167, v38
    v_mfma_f32_16x16x32_bf16 v[32:35], v[64:67], a[176:179], 0
    v_cvt_pk_bf16_f32 v40, v40, v41
    v_accvgpr_write_b32 a168, v40
    v_mfma_f32_16x16x32_bf16 v[36:39], v[66:69], a[176:179], 0
    s_add_u32 s53, s81, 17408
    buffer_load_dwordx4 a[68:71], v1, s[16:19], s53 offen sc1
    v_cvt_pk_bf16_f32 v42, v42, v43
    v_accvgpr_write_b32 a169, v42
    v_mfma_f32_16x16x32_bf16 v[32:35], v[70:73], a[176:179], v[32:35]
    v_cvt_pk_bf16_f32 v44, v44, v45
    v_accvgpr_write_b32 a170, v44
    v_mfma_f32_16x16x32_bf16 v[36:39], v[72:75], a[176:179], v[36:39]
    v_cvt_pk_bf16_f32 v46, v46, v47
    v_accvgpr_write_b32 a171, v46
    v_mfma_f32_16x16x32_bf16 v[40:43], v[64:67], a[180:183], 0
    s_waitcnt lgkmcnt(0)
    v_and_b32 v64, v10, v76
    v_and_b32 v65, v87, v76
    v_cvt_pk_bf16_f32 v24, v24, v25
    v_accvgpr_write_b32 a172, v24
    v_mfma_f32_16x16x32_bf16 v[44:47], v[66:69], a[180:183], 0
    s_add_u32 s53, s81, 18432
    buffer_load_dwordx4 a[72:75], v1, s[16:19], s53 offen sc1
    v_and_b32 v68, v10, v78
    v_and_b32 v69, v87, v78
    v_cvt_pk_bf16_f32 v26, v26, v27
    v_accvgpr_write_b32 a173, v26
    v_mfma_f32_16x16x32_bf16 v[40:43], v[70:73], a[180:183], v[40:43]
    v_and_b32 v70, v10, v77
    v_and_b32 v71, v87, v77
    v_cvt_pk_bf16_f32 v28, v28, v29
    v_accvgpr_write_b32 a174, v28
    v_mfma_f32_16x16x32_bf16 v[44:47], v[72:75], a[180:183], v[44:47]
    v_and_b32 v74, v10, v79
    v_and_b32 v75, v87, v79
    v_cvt_pk_bf16_f32 v30, v30, v31
    v_accvgpr_write_b32 a175, v30
    v_mfma_f32_16x16x32_bf16 v[24:27], v[64:67], a[184:187], 0
    ds_read_b128 v[76:79], v84 offset:1280
    v_cvt_pk_bf16_f32 v32, v32, v33
    v_accvgpr_write_b32 a176, v32
    v_mfma_f32_16x16x32_bf16 v[28:31], v[66:69], a[184:187], 0
    s_add_u32 s53, s81, 19456
    buffer_load_dwordx4 a[76:79], v1, s[16:19], s53 offen sc1
    v_cvt_pk_bf16_f32 v34, v34, v35
    v_accvgpr_write_b32 a177, v34
    v_mfma_f32_16x16x32_bf16 v[24:27], v[70:73], a[184:187], v[24:27]
    v_cvt_pk_bf16_f32 v36, v36, v37
    v_accvgpr_write_b32 a178, v36
    v_mfma_f32_16x16x32_bf16 v[28:31], v[72:75], a[184:187], v[28:31]
    v_cvt_pk_bf16_f32 v38, v38, v39
    v_accvgpr_write_b32 a179, v38
    v_mfma_f32_16x16x32_bf16 v[32:35], v[64:67], a[188:191], 0
    v_cvt_pk_bf16_f32 v40, v40, v41
    v_accvgpr_write_b32 a180, v40
    v_mfma_f32_16x16x32_bf16 v[36:39], v[66:69], a[188:191], 0
    s_add_u32 s53, s81, 20480
    buffer_load_dwordx4 a[80:83], v1, s[16:19], s53 offen sc1
    v_cvt_pk_bf16_f32 v42, v42, v43
    v_accvgpr_write_b32 a181, v42
    v_mfma_f32_16x16x32_bf16 v[32:35], v[70:73], a[188:191], v[32:35]
    v_cvt_pk_bf16_f32 v44, v44, v45
    v_accvgpr_write_b32 a182, v44
    v_mfma_f32_16x16x32_bf16 v[36:39], v[72:75], a[188:191], v[36:39]
    v_cvt_pk_bf16_f32 v46, v46, v47
    v_accvgpr_write_b32 a183, v46
    v_mfma_f32_16x16x32_bf16 v[40:43], v[64:67], a[192:195], 0
    s_waitcnt lgkmcnt(0)
    v_and_b32 v64, v10, v76
    v_and_b32 v65, v87, v76
    v_cvt_pk_bf16_f32 v24, v24, v25
    v_accvgpr_write_b32 a184, v24
    v_mfma_f32_16x16x32_bf16 v[44:47], v[66:69], a[192:195], 0
    s_add_u32 s53, s81, 21504
    buffer_load_dwordx4 a[84:87], v1, s[16:19], s53 offen sc1
    v_and_b32 v68, v10, v78
    v_and_b32 v69, v87, v78
    v_cvt_pk_bf16_f32 v26, v26, v27
    v_accvgpr_write_b32 a185, v26
    v_mfma_f32_16x16x32_bf16 v[40:43], v[70:73], a[192:195], v[40:43]
    v_and_b32 v70, v10, v77
    v_and_b32 v71, v87, v77
    v_cvt_pk_bf16_f32 v28, v28, v29
    v_accvgpr_write_b32 a186, v28
    v_mfma_f32_16x16x32_bf16 v[44:47], v[72:75], a[192:195], v[44:47]
    v_and_b32 v74, v10, v79
    v_and_b32 v75, v87, v79
    v_cvt_pk_bf16_f32 v30, v30, v31
    v_accvgpr_write_b32 a187, v30
    v_mfma_f32_16x16x32_bf16 v[24:27], v[64:67], a[196:199], 0
    ds_read_b128 v[76:79], v84 offset:1536
    v_cvt_pk_bf16_f32 v32, v32, v33
    v_accvgpr_write_b32 a188, v32
    v_mfma_f32_16x16x32_bf16 v[28:31], v[66:69], a[196:199], 0
    s_add_u32 s53, s81, 22528
    buffer_load_dwordx4 a[88:91], v1, s[16:19], s53 offen sc1
    v_cvt_pk_bf16_f32 v34, v34, v35
    v_accvgpr_write_b32 a189, v34
    v_mfma_f32_16x16x32_bf16 v[24:27], v[70:73], a[196:199], v[24:27]
    v_cvt_pk_bf16_f32 v36, v36, v37
    v_accvgpr_write_b32 a190, v36
    v_mfma_f32_16x16x32_bf16 v[28:31], v[72:75], a[196:199], v[28:31]
    v_cvt_pk_bf16_f32 v38, v38, v39
    v_accvgpr_write_b32 a191, v38
    v_mfma_f32_16x16x32_bf16 v[32:35], v[64:67], a[200:203], 0
    v_cvt_pk_bf16_f32 v40, v40, v41
    v_accvgpr_write_b32 a192, v40
    v_mfma_f32_16x16x32_bf16 v[36:39], v[66:69], a[200:203], 0
    s_add_u32 s53, s81, 23552
    buffer_load_dwordx4 a[92:95], v1, s[16:19], s53 offen sc1
    v_cvt_pk_bf16_f32 v42, v42, v43
    v_accvgpr_write_b32 a193, v42
    v_mfma_f32_16x16x32_bf16 v[32:35], v[70:73], a[200:203], v[32:35]
    v_cvt_pk_bf16_f32 v44, v44, v45
    v_accvgpr_write_b32 a194, v44
    v_mfma_f32_16x16x32_bf16 v[36:39], v[72:75], a[200:203], v[36:39]
    v_cvt_pk_bf16_f32 v46, v46, v47
    v_accvgpr_write_b32 a195, v46
    v_mfma_f32_16x16x32_bf16 v[40:43], v[64:67], a[204:207], 0
    s_waitcnt lgkmcnt(0)
    v_and_b32 v64, v10, v76
    v_and_b32 v65, v87, v76
    v_cvt_pk_bf16_f32 v24, v24, v25
    v_accvgpr_write_b32 a196, v24
    v_mfma_f32_16x16x32_bf16 v[44:47], v[66:69], a[204:207], 0
    v_and_b32 v68, v10, v78
    v_and_b32 v69, v87, v78
    v_cvt_pk_bf16_f32 v26, v26, v27
    v_accvgpr_write_b32 a197, v26
    v_mfma_f32_16x16x32_bf16 v[40:43], v[70:73], a[204:207], v[40:43]
    v_and_b32 v70, v10, v77
    v_and_b32 v71, v87, v77
    v_cvt_pk_bf16_f32 v28, v28, v29
    v_accvgpr_write_b32 a198, v28
    v_mfma_f32_16x16x32_bf16 v[44:47], v[72:75], a[204:207], v[44:47]
    v_and_b32 v74, v10, v79
    v_and_b32 v75, v87, v79
    v_cvt_pk_bf16_f32 v30, v30, v31
    v_accvgpr_write_b32 a199, v30
    v_mfma_f32_16x16x32_bf16 v[24:27], v[64:67], a[208:211], 0
    ds_read_b128 v[76:79], v84 offset:1792
    v_cvt_pk_bf16_f32 v32, v32, v33
    v_accvgpr_write_b32 a200, v32
    v_mfma_f32_16x16x32_bf16 v[28:31], v[66:69], a[208:211], 0
    v_cvt_pk_bf16_f32 v34, v34, v35
    v_accvgpr_write_b32 a201, v34
    v_mfma_f32_16x16x32_bf16 v[24:27], v[70:73], a[208:211], v[24:27]
    v_cvt_pk_bf16_f32 v36, v36, v37
    v_accvgpr_write_b32 a202, v36
    v_mfma_f32_16x16x32_bf16 v[28:31], v[72:75], a[208:211], v[28:31]
    v_cvt_pk_bf16_f32 v38, v38, v39
    v_accvgpr_write_b32 a203, v38
    v_mfma_f32_16x16x32_bf16 v[32:35], v[64:67], a[212:215], 0
    v_cvt_pk_bf16_f32 v40, v40, v41
    v_accvgpr_write_b32 a204, v40
    v_mfma_f32_16x16x32_bf16 v[36:39], v[66:69], a[212:215], 0
    v_cvt_pk_bf16_f32 v42, v42, v43
    v_accvgpr_write_b32 a205, v42
    v_mfma_f32_16x16x32_bf16 v[32:35], v[70:73], a[212:215], v[32:35]
    v_cvt_pk_bf16_f32 v44, v44, v45
    v_accvgpr_write_b32 a206, v44
    v_mfma_f32_16x16x32_bf16 v[36:39], v[72:75], a[212:215], v[36:39]
    v_cvt_pk_bf16_f32 v46, v46, v47
    v_accvgpr_write_b32 a207, v46
    v_mfma_f32_16x16x32_bf16 v[40:43], v[64:67], a[216:219], 0
    s_waitcnt lgkmcnt(0)
    v_and_b32 v64, v10, v76
    v_and_b32 v65, v87, v76
    v_cvt_pk_bf16_f32 v24, v24, v25
    v_accvgpr_write_b32 a208, v24
    v_mfma_f32_16x16x32_bf16 v[44:47], v[66:69], a[216:219], 0
    v_and_b32 v68, v10, v78
    v_and_b32 v69, v87, v78
    v_cvt_pk_bf16_f32 v26, v26, v27
    v_accvgpr_write_b32 a209, v26
    v_mfma_f32_16x16x32_bf16 v[40:43], v[70:73], a[216:219], v[40:43]
    v_and_b32 v70, v10, v77
    v_and_b32 v71, v87, v77
    v_cvt_pk_bf16_f32 v28, v28, v29
    v_accvgpr_write_b32 a210, v28
    v_mfma_f32_16x16x32_bf16 v[44:47], v[72:75], a[216:219], v[44:47]
    v_and_b32 v74, v10, v79
    v_and_b32 v75, v87, v79
    v_cvt_pk_bf16_f32 v30, v30, v31
    v_accvgpr_write_b32 a211, v30
    v_mfma_f32_16x16x32_bf16 v[24:27], v[64:67], a[220:223], 0
    ds_read_b128 v[76:79], v84 offset:3840
    v_cvt_pk_bf16_f32 v32, v32, v33
    v_accvgpr_write_b32 a212, v32
    v_mfma_f32_16x16x32_bf16 v[28:31], v[66:69], a[220:223], 0
    v_cvt_pk_bf16_f32 v34, v34, v35
    v_accvgpr_write_b32 a213, v34
    v_mfma_f32_16x16x32_bf16 v[24:27], v[70:73], a[220:223], v[24:27]
    v_cvt_pk_bf16_f32 v36, v36, v37
    v_accvgpr_write_b32 a214, v36
    v_mfma_f32_16x16x32_bf16 v[28:31], v[72:75], a[220:223], v[28:31]
    v_cvt_pk_bf16_f32 v38, v38, v39
    v_accvgpr_write_b32 a215, v38
    v_mfma_f32_16x16x32_bf16 v[32:35], v[64:67], a[224:227], 0
    v_cvt_pk_bf16_f32 v40, v40, v41
    v_accvgpr_write_b32 a216, v40
    v_mfma_f32_16x16x32_bf16 v[36:39], v[66:69], a[224:227], 0
    v_cvt_pk_bf16_f32 v42, v42, v43
    v_accvgpr_write_b32 a217, v42
    v_mfma_f32_16x16x32_bf16 v[32:35], v[70:73], a[224:227], v[32:35]
    v_cvt_pk_bf16_f32 v44, v44, v45
    v_accvgpr_write_b32 a218, v44
    v_mfma_f32_16x16x32_bf16 v[36:39], v[72:75], a[224:227], v[36:39]
    v_cvt_pk_bf16_f32 v46, v46, v47
    v_accvgpr_write_b32 a219, v46
    v_mfma_f32_16x16x32_bf16 v[40:43], v[64:67], a[228:231], 0
    s_waitcnt lgkmcnt(0)
    v_and_b32 v64, v10, v76
    v_and_b32 v65, v87, v76
    v_cvt_pk_bf16_f32 v24, v24, v25
    v_accvgpr_write_b32 a220, v24
    v_mfma_f32_16x16x32_bf16 v[44:47], v[66:69], a[228:231], 0
    v_and_b32 v68, v10, v78
    v_and_b32 v69, v87, v78
    v_cvt_pk_bf16_f32 v26, v26, v27
    v_accvgpr_write_b32 a221, v26
    v_mfma_f32_16x16x32_bf16 v[40:43], v[70:73], a[228:231], v[40:43]
    v_and_b32 v70, v10, v77
    v_and_b32 v71, v87, v77
    v_cvt_pk_bf16_f32 v28, v28, v29
    v_accvgpr_write_b32 a222, v28
    v_mfma_f32_16x16x32_bf16 v[44:47], v[72:75], a[228:231], v[44:47]
    v_and_b32 v74, v10, v79
    v_and_b32 v75, v87, v79
    v_cvt_pk_bf16_f32 v30, v30, v31
    v_accvgpr_write_b32 a223, v30
    v_mfma_f32_16x16x32_bf16 v[24:27], v[64:67], v[148:151], 0
    ds_read_b128 v[76:79], v84 offset:4096
    v_cvt_pk_bf16_f32 v32, v32, v33
    v_accvgpr_write_b32 a224, v32
    v_mfma_f32_16x16x32_bf16 v[28:31], v[66:69], v[148:151], 0
    v_cvt_pk_bf16_f32 v34, v34, v35
    v_accvgpr_write_b32 a225, v34
    v_mfma_f32_16x16x32_bf16 v[24:27], v[70:73], v[148:151], v[24:27]
    v_cvt_pk_bf16_f32 v36, v36, v37
    v_accvgpr_write_b32 a226, v36
    v_mfma_f32_16x16x32_bf16 v[28:31], v[72:75], v[148:151], v[28:31]
    v_cvt_pk_bf16_f32 v38, v38, v39
    v_accvgpr_write_b32 a227, v38
    v_mfma_f32_16x16x32_bf16 v[32:35], v[64:67], v[152:155], 0
    v_cvt_pk_bf16_f32 v40, v40, v41
    v_accvgpr_write_b32 a228, v40
    v_mfma_f32_16x16x32_bf16 v[36:39], v[66:69], v[152:155], 0
    v_cvt_pk_bf16_f32 v42, v42, v43
    v_accvgpr_write_b32 a229, v42
    v_mfma_f32_16x16x32_bf16 v[32:35], v[70:73], v[152:155], v[32:35]
    v_cvt_pk_bf16_f32 v44, v44, v45
    v_accvgpr_write_b32 a230, v44
    v_mfma_f32_16x16x32_bf16 v[36:39], v[72:75], v[152:155], v[36:39]
    v_cvt_pk_bf16_f32 v46, v46, v47
    v_accvgpr_write_b32 a231, v46
    v_mfma_f32_16x16x32_bf16 v[40:43], v[64:67], v[156:159], 0
    s_waitcnt lgkmcnt(0)
    v_and_b32 v64, v10, v76
    v_and_b32 v65, v87, v76
    v_cvt_pk_bf16_f32 v148, v24, v25
    v_mfma_f32_16x16x32_bf16 v[44:47], v[66:69], v[156:159], 0
    v_and_b32 v68, v10, v78
    v_and_b32 v69, v87, v78
    v_cvt_pk_bf16_f32 v149, v26, v27
    v_mfma_f32_16x16x32_bf16 v[40:43], v[70:73], v[156:159], v[40:43]
    v_and_b32 v70, v10, v77
    v_and_b32 v71, v87, v77
    v_cvt_pk_bf16_f32 v150, v28, v29
    v_mfma_f32_16x16x32_bf16 v[44:47], v[72:75], v[156:159], v[44:47]
    v_and_b32 v74, v10, v79
    v_and_b32 v75, v87, v79
    v_cvt_pk_bf16_f32 v151, v30, v31
    v_mfma_f32_16x16x32_bf16 v[24:27], v[64:67], v[160:163], 0
    ds_read_b128 v[76:79], v84 offset:2048
    v_cvt_pk_bf16_f32 v152, v32, v33
    v_mfma_f32_16x16x32_bf16 v[28:31], v[66:69], v[160:163], 0
    v_cvt_pk_bf16_f32 v153, v34, v35
    v_mfma_f32_16x16x32_bf16 v[24:27], v[70:73], v[160:163], v[24:27]
    v_cvt_pk_bf16_f32 v154, v36, v37
    v_mfma_f32_16x16x32_bf16 v[28:31], v[72:75], v[160:163], v[28:31]
    v_cvt_pk_bf16_f32 v155, v38, v39
    v_mfma_f32_16x16x32_bf16 v[32:35], v[64:67], v[164:167], 0
    v_cvt_pk_bf16_f32 v156, v40, v41
    v_mfma_f32_16x16x32_bf16 v[36:39], v[66:69], v[164:167], 0
    v_cvt_pk_bf16_f32 v157, v42, v43
    v_mfma_f32_16x16x32_bf16 v[32:35], v[70:73], v[164:167], v[32:35]
    v_cvt_pk_bf16_f32 v158, v44, v45
    v_mfma_f32_16x16x32_bf16 v[36:39], v[72:75], v[164:167], v[36:39]
    v_cvt_pk_bf16_f32 v159, v46, v47
    v_mfma_f32_16x16x32_bf16 v[40:43], v[64:67], v[168:171], 0
    s_waitcnt lgkmcnt(0)
    v_and_b32 v64, v10, v76
    v_and_b32 v65, v87, v76
    v_cvt_pk_bf16_f32 v160, v24, v25
    v_mfma_f32_16x16x32_bf16 v[44:47], v[66:69], v[168:171], 0
    v_and_b32 v68, v10, v78
    v_and_b32 v69, v87, v78
    v_cvt_pk_bf16_f32 v161, v26, v27
    v_mfma_f32_16x16x32_bf16 v[40:43], v[70:73], v[168:171], v[40:43]
    v_and_b32 v70, v10, v77
    v_and_b32 v71, v87, v77
    v_cvt_pk_bf16_f32 v162, v28, v29
    v_mfma_f32_16x16x32_bf16 v[44:47], v[72:75], v[168:171], v[44:47]
    v_and_b32 v74, v10, v79
    v_and_b32 v75, v87, v79
    v_cvt_pk_bf16_f32 v163, v30, v31
    v_mfma_f32_16x16x32_bf16 v[24:27], v[64:67], a[232:235], 0
    ds_read_b128 v[76:79], v84 offset:2304
    v_cvt_pk_bf16_f32 v164, v32, v33
    v_mfma_f32_16x16x32_bf16 v[28:31], v[66:69], a[232:235], 0
    v_cvt_pk_bf16_f32 v165, v34, v35
    v_mfma_f32_16x16x32_bf16 v[24:27], v[70:73], a[232:235], v[24:27]
    v_cvt_pk_bf16_f32 v166, v36, v37
    v_mfma_f32_16x16x32_bf16 v[28:31], v[72:75], a[232:235], v[28:31]
    v_cvt_pk_bf16_f32 v167, v38, v39
    v_mfma_f32_16x16x32_bf16 v[32:35], v[64:67], a[236:239], 0
    v_cvt_pk_bf16_f32 v168, v40, v41
    v_mfma_f32_16x16x32_bf16 v[36:39], v[66:69], a[236:239], 0
    v_cvt_pk_bf16_f32 v169, v42, v43
    v_mfma_f32_16x16x32_bf16 v[32:35], v[70:73], a[236:239], v[32:35]
    v_cvt_pk_bf16_f32 v170, v44, v45
    v_mfma_f32_16x16x32_bf16 v[36:39], v[72:75], a[236:239], v[36:39]
    v_cvt_pk_bf16_f32 v171, v46, v47
    v_mfma_f32_16x16x32_bf16 v[40:43], v[64:67], a[240:243], 0
    s_waitcnt lgkmcnt(0)
    v_and_b32 v64, v10, v76
    v_and_b32 v65, v87, v76
    v_cvt_pk_bf16_f32 v24, v24, v25
    v_accvgpr_write_b32 a232, v24
    v_mfma_f32_16x16x32_bf16 v[44:47], v[66:69], a[240:243], 0
    v_and_b32 v68, v10, v78
    v_and_b32 v69, v87, v78
    v_cvt_pk_bf16_f32 v26, v26, v27
    v_accvgpr_write_b32 a233, v26
    v_mfma_f32_16x16x32_bf16 v[40:43], v[70:73], a[240:243], v[40:43]
    v_and_b32 v70, v10, v77
    v_and_b32 v71, v87, v77
    v_cvt_pk_bf16_f32 v28, v28, v29
    v_accvgpr_write_b32 a234, v28
    v_mfma_f32_16x16x32_bf16 v[44:47], v[72:75], a[240:243], v[44:47]
    v_and_b32 v74, v10, v79
    v_and_b32 v75, v87, v79
    v_cvt_pk_bf16_f32 v30, v30, v31
    v_accvgpr_write_b32 a235, v30
    v_mfma_f32_16x16x32_bf16 v[24:27], v[64:67], a[244:247], 0
    ds_read_b128 v[76:79], v84 offset:3072
    v_cvt_pk_bf16_f32 v32, v32, v33
    v_accvgpr_write_b32 a236, v32
    v_mfma_f32_16x16x32_bf16 v[28:31], v[66:69], a[244:247], 0
    v_cvt_pk_bf16_f32 v34, v34, v35
    v_accvgpr_write_b32 a237, v34
    v_mfma_f32_16x16x32_bf16 v[24:27], v[70:73], a[244:247], v[24:27]
    ds_read2_b64 a[116:119], v85 offset0:96 offset1:100
    v_cvt_pk_bf16_f32 v36, v36, v37
    v_accvgpr_write_b32 a238, v36
    v_mfma_f32_16x16x32_bf16 v[28:31], v[72:75], a[244:247], v[28:31]
    v_cvt_pk_bf16_f32 v38, v38, v39
    v_accvgpr_write_b32 a239, v38
    v_mfma_f32_16x16x32_bf16 v[32:35], v[64:67], a[248:251], 0
    v_cvt_pk_bf16_f32 v40, v40, v41
    v_accvgpr_write_b32 a240, v40
    v_mfma_f32_16x16x32_bf16 v[36:39], v[66:69], a[248:251], 0
    v_cvt_pk_bf16_f32 v42, v42, v43
    v_accvgpr_write_b32 a241, v42
    v_mfma_f32_16x16x32_bf16 v[32:35], v[70:73], a[248:251], v[32:35]
    v_cvt_pk_bf16_f32 v44, v44, v45
    v_accvgpr_write_b32 a242, v44
    v_mfma_f32_16x16x32_bf16 v[36:39], v[72:75], a[248:251], v[36:39]
    v_cvt_pk_bf16_f32 v46, v46, v47
    v_accvgpr_write_b32 a243, v46
    v_mfma_f32_16x16x32_bf16 v[40:43], v[64:67], a[252:255], 0
    s_waitcnt lgkmcnt(1)
    v_and_b32 v64, v10, v76
    v_and_b32 v65, v87, v76
    v_cvt_pk_bf16_f32 v24, v24, v25
    v_accvgpr_write_b32 a244, v24
    v_mfma_f32_16x16x32_bf16 v[44:47], v[66:69], a[252:255], 0
    v_and_b32 v68, v10, v78
    v_and_b32 v69, v87, v78
    v_cvt_pk_bf16_f32 v26, v26, v27
    v_accvgpr_write_b32 a245, v26
    v_mfma_f32_16x16x32_bf16 v[40:43], v[70:73], a[252:255], v[40:43]
    v_and_b32 v70, v10, v77
    v_and_b32 v71, v87, v77
    v_cvt_pk_bf16_f32 v28, v28, v29
    v_accvgpr_write_b32 a246, v28
    v_mfma_f32_16x16x32_bf16 v[44:47], v[72:75], a[252:255], v[44:47]
    s_waitcnt lgkmcnt(0)
    v_and_b32 v74, v10, v79
    v_and_b32 v75, v87, v79
    v_cvt_pk_bf16_f32 v30, v30, v31
    v_accvgpr_write_b32 a247, v30
    v_mfma_f32_16x16x32_bf16 v[12:15], v[112:115], a[116:119], v[12:15]
    v_mfma_f32_16x16x32_bf16 v[24:27], v[64:67], v[112:115], 0
    ds_read_b128 v[76:79], v84 offset:3328
    v_cvt_pk_bf16_f32 v32, v32, v33
    v_accvgpr_write_b32 a248, v32
    v_mfma_f32_16x16x32_bf16 v[28:31], v[66:69], v[112:115], 0
    v_cvt_pk_bf16_f32 v34, v34, v35
    v_accvgpr_write_b32 a249, v34
    v_mfma_f32_16x16x32_bf16 v[24:27], v[70:73], v[112:115], v[24:27]
    ds_read2_b64 a[120:123], v85 offset0:104 offset1:108
    v_cvt_pk_bf16_f32 v36, v36, v37
    v_accvgpr_write_b32 a250, v36
    v_mfma_f32_16x16x32_bf16 v[28:31], v[72:75], v[112:115], v[28:31]
    s_waitcnt vmcnt(34)
    v_cvt_pk_bf16_f32 v38, v38, v39
    v_accvgpr_write_b32 a251, v38
    v_mfma_f32_16x16x32_bf16 v[16:19], v[116:119], a[116:119], v[16:19]
    v_mfma_f32_16x16x32_bf16 v[32:35], v[64:67], v[116:119], 0
    v_cvt_pk_bf16_f32 v40, v40, v41
    v_accvgpr_write_b32 a252, v40
    v_mfma_f32_16x16x32_bf16 v[36:39], v[66:69], v[116:119], 0
    v_cvt_pk_bf16_f32 v42, v42, v43
    v_accvgpr_write_b32 a253, v42
    v_mfma_f32_16x16x32_bf16 v[32:35], v[70:73], v[116:119], v[32:35]
    v_cvt_pk_bf16_f32 v44, v44, v45
    v_accvgpr_write_b32 a254, v44
    v_mfma_f32_16x16x32_bf16 v[36:39], v[72:75], v[116:119], v[36:39]
    s_waitcnt vmcnt(33)
    v_cvt_pk_bf16_f32 v46, v46, v47
    v_accvgpr_write_b32 a255, v46
    v_mfma_f32_16x16x32_bf16 v[20:23], v[120:123], a[116:119], v[20:23]
    v_mfma_f32_16x16x32_bf16 v[40:43], v[64:67], v[120:123], 0
    s_waitcnt lgkmcnt(1)
    v_and_b32 v64, v10, v76
    v_and_b32 v65, v87, v76
    v_cvt_pk_bf16_f32 v112, v24, v25
    v_mfma_f32_16x16x32_bf16 v[44:47], v[66:69], v[120:123], 0
    v_and_b32 v68, v10, v78
    v_and_b32 v69, v87, v78
    v_cvt_pk_bf16_f32 v113, v26, v27
    v_mfma_f32_16x16x32_bf16 v[40:43], v[70:73], v[120:123], v[40:43]
    v_and_b32 v70, v10, v77
    v_and_b32 v71, v87, v77
    v_cvt_pk_bf16_f32 v114, v28, v29
    v_mfma_f32_16x16x32_bf16 v[44:47], v[72:75], v[120:123], v[44:47]
    s_waitcnt vmcnt(32) lgkmcnt(0)
    v_and_b32 v74, v10, v79
    v_and_b32 v75, v87, v79
    v_cvt_pk_bf16_f32 v115, v30, v31
    v_mfma_f32_16x16x32_bf16 v[12:15], v[124:127], a[120:123], v[12:15]
    v_mfma_f32_16x16x32_bf16 v[24:27], v[64:67], v[124:127], 0
    ds_read_b128 v[76:79], v84 offset:3584
    v_cvt_pk_bf16_f32 v116, v32, v33
    v_mfma_f32_16x16x32_bf16 v[28:31], v[66:69], v[124:127], 0
    v_cvt_pk_bf16_f32 v117, v34, v35
    v_mfma_f32_16x16x32_bf16 v[24:27], v[70:73], v[124:127], v[24:27]
    ds_read2_b64 a[100:103], v85 offset0:112 offset1:116
    v_cvt_pk_bf16_f32 v118, v36, v37
    v_mfma_f32_16x16x32_bf16 v[28:31], v[72:75], v[124:127], v[28:31]
    s_waitcnt vmcnt(31)
    v_cvt_pk_bf16_f32 v119, v38, v39
    v_mfma_f32_16x16x32_bf16 v[16:19], v[128:131], a[120:123], v[16:19]
    v_mfma_f32_16x16x32_bf16 v[32:35], v[64:67], v[128:131], 0
    v_cvt_pk_bf16_f32 v120, v40, v41
    v_mfma_f32_16x16x32_bf16 v[36:39], v[66:69], v[128:131], 0
    v_cvt_pk_bf16_f32 v121, v42, v43
    v_mfma_f32_16x16x32_bf16 v[32:35], v[70:73], v[128:131], v[32:35]
    v_cvt_pk_bf16_f32 v122, v44, v45
    v_mfma_f32_16x16x32_bf16 v[36:39], v[72:75], v[128:131], v[36:39]
    s_waitcnt vmcnt(30)
    v_cvt_pk_bf16_f32 v123, v46, v47
    v_mfma_f32_16x16x32_bf16 v[20:23], v[132:135], a[120:123], v[20:23]
    v_mfma_f32_16x16x32_bf16 v[40:43], v[64:67], v[132:135], 0
    s_waitcnt lgkmcnt(1)
    v_and_b32 v64, v10, v76
    v_and_b32 v65, v87, v76
    v_cvt_pk_bf16_f32 v124, v24, v25
    v_mfma_f32_16x16x32_bf16 v[44:47], v[66:69], v[132:135], 0
    v_and_b32 v68, v10, v78
    v_and_b32 v69, v87, v78
    v_cvt_pk_bf16_f32 v125, v26, v27
    v_mfma_f32_16x16x32_bf16 v[40:43], v[70:73], v[132:135], v[40:43]
    v_and_b32 v70, v10, v77
    v_and_b32 v71, v87, v77
    v_cvt_pk_bf16_f32 v126, v28, v29
    v_mfma_f32_16x16x32_bf16 v[44:47], v[72:75], v[132:135], v[44:47]
    s_waitcnt vmcnt(29) lgkmcnt(0)
    v_and_b32 v74, v10, v79
    v_and_b32 v75, v87, v79
    v_cvt_pk_bf16_f32 v127, v30, v31
    v_mfma_f32_16x16x32_bf16 v[12:15], v[136:139], a[100:103], v[12:15]
    v_mfma_f32_16x16x32_bf16 v[24:27], v[64:67], v[136:139], 0
    ds_read_b128 v[76:79], v84 offset:5120
    v_cvt_pk_bf16_f32 v128, v32, v33
    v_mfma_f32_16x16x32_bf16 v[28:31], v[66:69], v[136:139], 0
    v_cvt_pk_bf16_f32 v129, v34, v35
    v_mfma_f32_16x16x32_bf16 v[24:27], v[70:73], v[136:139], v[24:27]
    ds_read2_b64 a[104:107], v85 offset0:160 offset1:164
    v_cvt_pk_bf16_f32 v130, v36, v37
    v_mfma_f32_16x16x32_bf16 v[28:31], v[72:75], v[136:139], v[28:31]
    s_waitcnt vmcnt(28)
    v_cvt_pk_bf16_f32 v131, v38, v39
    v_mfma_f32_16x16x32_bf16 v[16:19], v[140:143], a[100:103], v[16:19]
    v_mfma_f32_16x16x32_bf16 v[32:35], v[64:67], v[140:143], 0
    v_cvt_pk_bf16_f32 v132, v40, v41
    v_mfma_f32_16x16x32_bf16 v[36:39], v[66:69], v[140:143], 0
    v_cvt_pk_bf16_f32 v133, v42, v43
    v_mfma_f32_16x16x32_bf16 v[32:35], v[70:73], v[140:143], v[32:35]
    v_cvt_pk_bf16_f32 v134, v44, v45
    v_mfma_f32_16x16x32_bf16 v[36:39], v[72:75], v[140:143], v[36:39]
    s_waitcnt vmcnt(27)
    v_cvt_pk_bf16_f32 v135, v46, v47
    v_mfma_f32_16x16x32_bf16 v[20:23], v[144:147], a[100:103], v[20:23]
    v_mfma_f32_16x16x32_bf16 v[40:43], v[64:67], v[144:147], 0
    s_waitcnt lgkmcnt(1)
    v_and_b32 v64, v10, v76
    v_and_b32 v65, v87, v76
    v_cvt_pk_bf16_f32 v136, v24, v25
    v_mfma_f32_16x16x32_bf16 v[44:47], v[66:69], v[144:147], 0
    v_and_b32 v68, v10, v78
    v_and_b32 v69, v87, v78
    v_cvt_pk_bf16_f32 v137, v26, v27
    v_mfma_f32_16x16x32_bf16 v[40:43], v[70:73], v[144:147], v[40:43]
    v_and_b32 v70, v10, v77
    v_and_b32 v71, v87, v77
    v_cvt_pk_bf16_f32 v138, v28, v29
    v_mfma_f32_16x16x32_bf16 v[44:47], v[72:75], v[144:147], v[44:47]
    s_waitcnt vmcnt(26) lgkmcnt(0)
    v_and_b32 v74, v10, v79
    v_and_b32 v75, v87, v79
    v_cvt_pk_bf16_f32 v139, v30, v31
    v_mfma_f32_16x16x32_bf16 v[12:15], v[208:211], a[104:107], v[12:15]
    v_mfma_f32_16x16x32_bf16 v[24:27], v[64:67], v[208:211], 0
    ds_read_b128 v[76:79], v84 offset:5376
    v_cvt_pk_bf16_f32 v140, v32, v33
    v_mfma_f32_16x16x32_bf16 v[28:31], v[66:69], v[208:211], 0
    v_cvt_pk_bf16_f32 v141, v34, v35
    v_mfma_f32_16x16x32_bf16 v[24:27], v[70:73], v[208:211], v[24:27]
    ds_read2_b64 a[108:111], v85 offset0:168 offset1:172
    v_cvt_pk_bf16_f32 v142, v36, v37
    v_mfma_f32_16x16x32_bf16 v[28:31], v[72:75], v[208:211], v[28:31]
    s_waitcnt vmcnt(25)
    v_cvt_pk_bf16_f32 v143, v38, v39
    v_mfma_f32_16x16x32_bf16 v[16:19], v[212:215], a[104:107], v[16:19]
    v_mfma_f32_16x16x32_bf16 v[32:35], v[64:67], v[212:215], 0
    v_cvt_pk_bf16_f32 v144, v40, v41
    v_mfma_f32_16x16x32_bf16 v[36:39], v[66:69], v[212:215], 0
    v_cvt_pk_bf16_f32 v145, v42, v43
    v_mfma_f32_16x16x32_bf16 v[32:35], v[70:73], v[212:215], v[32:35]
    v_cvt_pk_bf16_f32 v146, v44, v45
    v_mfma_f32_16x16x32_bf16 v[36:39], v[72:75], v[212:215], v[36:39]
    s_waitcnt vmcnt(24)
    v_cvt_pk_bf16_f32 v147, v46, v47
    v_mfma_f32_16x16x32_bf16 v[20:23], v[216:219], a[104:107], v[20:23]
    v_mfma_f32_16x16x32_bf16 v[40:43], v[64:67], v[216:219], 0
    s_waitcnt lgkmcnt(1)
    v_and_b32 v64, v10, v76
    v_and_b32 v65, v87, v76
    v_cvt_pk_bf16_f32 v208, v24, v25
    v_mfma_f32_16x16x32_bf16 v[44:47], v[66:69], v[216:219], 0
    v_and_b32 v68, v10, v78
    v_and_b32 v69, v87, v78
    v_cvt_pk_bf16_f32 v209, v26, v27
    v_mfma_f32_16x16x32_bf16 v[40:43], v[70:73], v[216:219], v[40:43]
    v_and_b32 v70, v10, v77
    v_and_b32 v71, v87, v77
    v_cvt_pk_bf16_f32 v210, v28, v29
    v_mfma_f32_16x16x32_bf16 v[44:47], v[72:75], v[216:219], v[44:47]
    s_waitcnt vmcnt(23) lgkmcnt(0)
    v_and_b32 v74, v10, v79
    v_and_b32 v75, v87, v79
    v_cvt_pk_bf16_f32 v211, v30, v31
    v_mfma_f32_16x16x32_bf16 v[12:15], v[220:223], a[108:111], v[12:15]
    v_mfma_f32_16x16x32_bf16 v[24:27], v[64:67], v[220:223], 0
    ds_read_b128 v[76:79], v84 offset:5632
    v_cvt_pk_bf16_f32 v212, v32, v33
    v_mfma_f32_16x16x32_bf16 v[28:31], v[66:69], v[220:223], 0
    v_cvt_pk_bf16_f32 v213, v34, v35
    v_mfma_f32_16x16x32_bf16 v[24:27], v[70:73], v[220:223], v[24:27]
    ds_read2_b64 a[112:115], v85 offset0:176 offset1:180
    v_cvt_pk_bf16_f32 v214, v36, v37
    v_mfma_f32_16x16x32_bf16 v[28:31], v[72:75], v[220:223], v[28:31]
    s_waitcnt vmcnt(22)
    v_cvt_pk_bf16_f32 v215, v38, v39
    v_mfma_f32_16x16x32_bf16 v[16:19], v[224:227], a[108:111], v[16:19]
    v_mfma_f32_16x16x32_bf16 v[32:35], v[64:67], v[224:227], 0
    v_cvt_pk_bf16_f32 v216, v40, v41
    v_mfma_f32_16x16x32_bf16 v[36:39], v[66:69], v[224:227], 0
    v_cvt_pk_bf16_f32 v217, v42, v43
    v_mfma_f32_16x16x32_bf16 v[32:35], v[70:73], v[224:227], v[32:35]
    v_cvt_pk_bf16_f32 v218, v44, v45
    v_mfma_f32_16x16x32_bf16 v[36:39], v[72:75], v[224:227], v[36:39]
    s_waitcnt vmcnt(21)
    v_cvt_pk_bf16_f32 v219, v46, v47
    v_mfma_f32_16x16x32_bf16 v[20:23], v[228:231], a[108:111], v[20:23]
    v_mfma_f32_16x16x32_bf16 v[40:43], v[64:67], v[228:231], 0
    s_waitcnt lgkmcnt(1)
    v_and_b32 v64, v10, v76
    v_and_b32 v65, v87, v76
    v_cvt_pk_bf16_f32 v220, v24, v25
    v_mfma_f32_16x16x32_bf16 v[44:47], v[66:69], v[228:231], 0
    v_and_b32 v68, v10, v78
    v_and_b32 v69, v87, v78
    v_cvt_pk_bf16_f32 v221, v26, v27
    v_mfma_f32_16x16x32_bf16 v[40:43], v[70:73], v[228:231], v[40:43]
    v_and_b32 v70, v10, v77
    v_and_b32 v71, v87, v77
    v_cvt_pk_bf16_f32 v222, v28, v29
    v_mfma_f32_16x16x32_bf16 v[44:47], v[72:75], v[228:231], v[44:47]
    s_waitcnt vmcnt(20) lgkmcnt(0)
    v_and_b32 v74, v10, v79
    v_and_b32 v75, v87, v79
    v_cvt_pk_bf16_f32 v223, v30, v31
    v_mfma_f32_16x16x32_bf16 v[12:15], v[232:235], a[112:115], v[12:15]
    v_mfma_f32_16x16x32_bf16 v[24:27], v[64:67], v[232:235], 0
    ds_read_b128 v[76:79], v84 offset:2560
    v_cvt_pk_bf16_f32 v224, v32, v33
    v_mfma_f32_16x16x32_bf16 v[28:31], v[66:69], v[232:235], 0
    v_cvt_pk_bf16_f32 v225, v34, v35
    v_mfma_f32_16x16x32_bf16 v[24:27], v[70:73], v[232:235], v[24:27]
    ds_read2_b64 a[116:119], v85 offset0:80 offset1:84
    v_cvt_pk_bf16_f32 v226, v36, v37
    v_mfma_f32_16x16x32_bf16 v[28:31], v[72:75], v[232:235], v[28:31]
    s_waitcnt vmcnt(19)
    v_cvt_pk_bf16_f32 v227, v38, v39
    v_mfma_f32_16x16x32_bf16 v[16:19], v[236:239], a[112:115], v[16:19]
    v_mfma_f32_16x16x32_bf16 v[32:35], v[64:67], v[236:239], 0
    v_cvt_pk_bf16_f32 v228, v40, v41
    v_mfma_f32_16x16x32_bf16 v[36:39], v[66:69], v[236:239], 0
    v_cvt_pk_bf16_f32 v229, v42, v43
    v_mfma_f32_16x16x32_bf16 v[32:35], v[70:73], v[236:239], v[32:35]
    v_cvt_pk_bf16_f32 v230, v44, v45
    v_mfma_f32_16x16x32_bf16 v[36:39], v[72:75], v[236:239], v[36:39]
    s_waitcnt vmcnt(18)
    v_cvt_pk_bf16_f32 v231, v46, v47
    v_mfma_f32_16x16x32_bf16 v[20:23], v[240:243], a[112:115], v[20:23]
    v_mfma_f32_16x16x32_bf16 v[40:43], v[64:67], v[240:243], 0
    s_waitcnt lgkmcnt(1)
    v_and_b32 v64, v10, v76
    v_and_b32 v65, v87, v76
    v_cvt_pk_bf16_f32 v232, v24, v25
    v_mfma_f32_16x16x32_bf16 v[44:47], v[66:69], v[240:243], 0
    v_and_b32 v68, v10, v78
    v_and_b32 v69, v87, v78
    v_cvt_pk_bf16_f32 v233, v26, v27
    v_mfma_f32_16x16x32_bf16 v[40:43], v[70:73], v[240:243], v[40:43]
    v_and_b32 v70, v10, v77
    v_and_b32 v71, v87, v77
    v_cvt_pk_bf16_f32 v234, v28, v29
    v_mfma_f32_16x16x32_bf16 v[44:47], v[72:75], v[240:243], v[44:47]
    s_waitcnt vmcnt(17) lgkmcnt(0)
    v_and_b32 v74, v10, v79
    v_and_b32 v75, v87, v79
    v_cvt_pk_bf16_f32 v235, v30, v31
    v_mfma_f32_16x16x32_bf16 v[12:15], v[88:91], a[116:119], v[12:15]
    v_mfma_f32_16x16x32_bf16 v[24:27], v[64:67], v[88:91], 0
    ds_read_b128 v[76:79], v84 offset:2816
    v_cvt_pk_bf16_f32 v236, v32, v33
    v_mfma_f32_16x16x32_bf16 v[28:31], v[66:69], v[88:91], 0
    v_cvt_pk_bf16_f32 v237, v34, v35
    v_mfma_f32_16x16x32_bf16 v[24:27], v[70:73], v[88:91], v[24:27]
    ds_read2_b64 a[120:123], v85 offset0:88 offset1:92
    v_cvt_pk_bf16_f32 v238, v36, v37
    v_mfma_f32_16x16x32_bf16 v[28:31], v[72:75], v[88:91], v[28:31]
    s_waitcnt vmcnt(16)
    v_cvt_pk_bf16_f32 v239, v38, v39
    v_mfma_f32_16x16x32_bf16 v[16:19], v[92:95], a[116:119], v[16:19]
    v_mfma_f32_16x16x32_bf16 v[32:35], v[64:67], v[92:95], 0
    v_cvt_pk_bf16_f32 v240, v40, v41
    v_mfma_f32_16x16x32_bf16 v[36:39], v[66:69], v[92:95], 0
    v_cvt_pk_bf16_f32 v241, v42, v43
    v_mfma_f32_16x16x32_bf16 v[32:35], v[70:73], v[92:95], v[32:35]
    v_cvt_pk_bf16_f32 v242, v44, v45
    v_mfma_f32_16x16x32_bf16 v[36:39], v[72:75], v[92:95], v[36:39]
    s_waitcnt vmcnt(15)
    v_cvt_pk_bf16_f32 v243, v46, v47
    v_mfma_f32_16x16x32_bf16 v[20:23], v[96:99], a[116:119], v[20:23]
    v_mfma_f32_16x16x32_bf16 v[40:43], v[64:67], v[96:99], 0
    s_waitcnt lgkmcnt(1)
    v_and_b32 v64, v10, v76
    v_and_b32 v65, v87, v76
    v_cvt_pk_bf16_f32 v88, v24, v25
    v_mfma_f32_16x16x32_bf16 v[44:47], v[66:69], v[96:99], 0
    v_and_b32 v68, v10, v78
    v_and_b32 v69, v87, v78
    v_cvt_pk_bf16_f32 v89, v26, v27
    v_mfma_f32_16x16x32_bf16 v[40:43], v[70:73], v[96:99], v[40:43]
    v_and_b32 v70, v10, v77
    v_and_b32 v71, v87, v77
    v_cvt_pk_bf16_f32 v90, v28, v29
    v_mfma_f32_16x16x32_bf16 v[44:47], v[72:75], v[96:99], v[44:47]
    s_waitcnt vmcnt(14) lgkmcnt(0)
    v_and_b32 v74, v10, v79
    v_and_b32 v75, v87, v79
    v_cvt_pk_bf16_f32 v91, v30, v31
    v_mfma_f32_16x16x32_bf16 v[12:15], v[100:103], a[120:123], v[12:15]
    v_mfma_f32_16x16x32_bf16 v[24:27], v[64:67], v[100:103], 0
    ds_read_b128 a[124:127], v2 offset:0
    v_cvt_pk_bf16_f32 v92, v32, v33
    v_mfma_f32_16x16x32_bf16 v[28:31], v[66:69], v[100:103], 0
    ds_read_b128 a[128:131], v2 offset:2048
    v_cvt_pk_bf16_f32 v93, v34, v35
    v_mfma_f32_16x16x32_bf16 v[24:27], v[70:73], v[100:103], v[24:27]
    ds_read_b128 a[132:135], v2 offset:4096
    v_cvt_pk_bf16_f32 v94, v36, v37
    v_mfma_f32_16x16x32_bf16 v[28:31], v[72:75], v[100:103], v[28:31]
    s_waitcnt vmcnt(13)
    v_cvt_pk_bf16_f32 v95, v38, v39
    v_mfma_f32_16x16x32_bf16 v[16:19], v[104:107], a[120:123], v[16:19]
    v_mfma_f32_16x16x32_bf16 v[32:35], v[64:67], v[104:107], 0
    v_cvt_pk_bf16_f32 v96, v40, v41
    v_mfma_f32_16x16x32_bf16 v[36:39], v[66:69], v[104:107], 0
    v_cvt_pk_bf16_f32 v97, v42, v43
    v_mfma_f32_16x16x32_bf16 v[32:35], v[70:73], v[104:107], v[32:35]
    v_cvt_pk_bf16_f32 v98, v44, v45
    v_mfma_f32_16x16x32_bf16 v[36:39], v[72:75], v[104:107], v[36:39]
    s_waitcnt vmcnt(12)
    v_cvt_pk_bf16_f32 v99, v46, v47
    v_mfma_f32_16x16x32_bf16 v[20:23], v[108:111], a[120:123], v[20:23]
    v_mfma_f32_16x16x32_bf16 v[40:43], v[64:67], v[108:111], 0
    v_cvt_pk_bf16_f32 v100, v24, v25
    v_mfma_f32_16x16x32_bf16 v[44:47], v[66:69], v[108:111], 0
    v_cvt_pk_bf16_f32 v101, v26, v27
    v_mfma_f32_16x16x32_bf16 v[40:43], v[70:73], v[108:111], v[40:43]
    v_cvt_pk_bf16_f32 v102, v28, v29
    v_mfma_f32_16x16x32_bf16 v[44:47], v[72:75], v[108:111], v[44:47]
    v_cvt_pk_bf16_f32 v103, v30, v31
    v_cvt_pk_bf16_f32 v104, v32, v33
    v_cvt_pk_bf16_f32 v105, v34, v35
    v_cvt_pk_bf16_f32 v106, v36, v37
    v_cvt_pk_bf16_f32 v107, v38, v39
    s_nop 3
    v_cvt_pk_bf16_f32 v108, v40, v41
    v_cvt_pk_bf16_f32 v109, v42, v43
    v_cvt_pk_bf16_f32 v110, v44, v45
    v_cvt_pk_bf16_f32 v111, v46, v47
    s_waitcnt vmcnt(0)
    s_waitcnt lgkmcnt(0)
    v_mfma_f32_16x16x32_bf16 v[24:27], a[96:99], a[124:127], v[12:15]
    v_mfma_f32_16x16x32_bf16 v[28:31], a[96:99], a[128:131], v[16:19]
    v_mfma_f32_16x16x32_bf16 v[32:35], a[96:99], a[132:135], v[20:23]
    ds_read_b128 a[100:103], v3 offset:6144
    ds_read_b128 a[104:107], v3 offset:8192
    ds_read_b128 a[108:111], v3 offset:10240
    s_waitcnt lgkmcnt(2)
    ds_read_b128 a[112:115], v2 offset:6144
    s_mov_b32 s54, 18
    v_mfma_f32_16x16x32_bf16 v[64:67], a[12:15], a[100:103], 0
    v_exp_f32 v80, v80
    v_mfma_f32_16x16x32_bf16 v[68:71], a[36:39], a[100:103], 0
    v_exp_f32 v81, v81
    v_mfma_f32_16x16x32_bf16 v[72:75], a[60:63], a[100:103], 0
    v_add_f32 v80, 1.0, v80
    v_mfma_f32_16x16x32_bf16 v[76:79], a[84:87], a[100:103], 0
    s_waitcnt lgkmcnt(2)
    ds_read_b128 a[116:119], v2 offset:8192
    v_mfma_f32_16x16x32_bf16 v[64:67], a[16:19], a[104:107], v[64:67]
    v_mfma_f32_16x16x32_bf16 v[68:71], a[40:43], a[104:107], v[68:71]
    v_mfma_f32_16x16x32_bf16 v[72:75], a[64:67], a[104:107], v[72:75]
    v_mfma_f32_16x16x32_bf16 v[76:79], a[88:91], a[104:107], v[76:79]
    s_waitcnt lgkmcnt(2)
    ds_read_b128 a[120:123], v2 offset:10240
    v_add_f32 v81, 1.0, v81
    v_mfma_f32_16x16x32_bf16 v[64:67], a[20:23], a[108:111], v[64:67]
    v_mfma_f32_16x16x32_bf16 v[68:71], a[44:47], a[108:111], v[68:71]
    v_rcp_f32 v80, v80
    v_mfma_f32_16x16x32_bf16 v[72:75], a[68:71], a[108:111], v[72:75]
    v_rcp_f32 v81, v81
    v_mfma_f32_16x16x32_bf16 v[76:79], a[92:95], a[108:111], v[76:79]
    s_waitcnt lgkmcnt(2)
    ds_read_b128 a[100:103], v4 offset:0
    v_mfma_f32_16x16x32_bf16 v[64:67], a[0:3], a[112:115], v[64:67]
    v_mfma_f32_16x16x32_bf16 v[68:71], a[24:27], a[112:115], v[68:71]
    v_mul_f32 v52, v52, v80
    v_mul_f32 v53, v53, v81
    v_mfma_f32_16x16x32_bf16 v[72:75], a[48:51], a[112:115], v[72:75]
    v_cvt_pk_bf16_f32 v50, v52, v53
    v_mul_f32 v54, v86, v54
    v_mfma_f32_16x16x32_bf16 v[76:79], a[72:75], a[112:115], v[76:79]
    v_mul_f32 v55, v86, v55
    v_fma_f32 v82, v54, v54, s50
    v_mfma_f32_16x16x32_bf16 v[36:39], a[96:99], a[112:115], v[12:15]
    s_waitcnt lgkmcnt(2)
    ds_read_b128 a[104:107], v4 offset:5120
    v_fma_f32 v83, v55, v55, s50
    v_mfma_f32_16x16x32_bf16 v[64:67], a[4:7], a[116:119], v[64:67]
    v_mul_f32 v82, v82, v54
    v_mul_f32 v83, v83, v55
    v_mfma_f32_16x16x32_bf16 v[68:71], a[28:31], a[116:119], v[68:71]
    v_exp_f32 v82, v82
    v_mfma_f32_16x16x32_bf16 v[72:75], a[52:55], a[116:119], v[72:75]
    ds_read_b32 v10, v9 offset:64
    v_mfma_f32_16x16x32_bf16 v[76:79], a[76:79], a[116:119], v[76:79]
    v_exp_f32 v83, v83
    v_mfma_f32_16x16x32_bf16 v[40:43], a[96:99], a[116:119], v[16:19]
    s_waitcnt lgkmcnt(3)
    ds_read_b128 a[108:111], v4 offset:10240
    v_mfma_f32_16x16x32_bf16 v[64:67], a[8:11], a[120:123], v[64:67]
    v_add_f32 v82, 1.0, v82
    v_add_f32 v83, 1.0, v83
    v_mfma_f32_16x16x32_bf16 v[68:71], a[32:35], a[120:123], v[68:71]
    v_rcp_f32 v82, v82
    v_mfma_f32_16x16x32_bf16 v[72:75], a[56:59], a[120:123], v[72:75]
    v_mfma_f32_16x16x32_bf16 v[76:79], a[80:83], a[120:123], v[76:79]
    v_rcp_f32 v83, v83
    v_mfma_f32_16x16x32_bf16 v[44:47], a[96:99], a[120:123], v[20:23]
    s_waitcnt lgkmcnt(3)
    ds_read_b128 a[112:115], v4 offset:15360
    v_mul_f32 v54, v54, v82
    v_mfma_f32_16x16x32_bf16 v[24:27], a[148:151], a[100:103], v[24:27]
    s_waitcnt lgkmcnt(2)
    v_mul_f32 v55, v55, v83
    v_cvt_pk_bf16_f32 v51, v54, v55
    v_mfma_f32_16x16x32_bf16 v[28:31], a[152:155], a[100:103], v[28:31]
    ds_write_b128 v6, v[48:51] offset:0
    v_mfma_f32_16x16x32_bf16 v[32:35], a[156:159], a[100:103], v[32:35]
    s_waitcnt lgkmcnt(4)
    ds_read_b128 a[116:119], v4 offset:1024
    v_mul_f32 v64, v10, v64
    v_mfma_f32_16x16x32_bf16 v[24:27], a[220:223], a[104:107], v[24:27]
    v_mul_f32 v65, v10, v65
    v_fma_f32 v80, v64, v64, s50
    v_mfma_f32_16x16x32_bf16 v[28:31], a[224:227], a[104:107], v[28:31]
    s_add_u32 s76, s76, 1
    v_fma_f32 v81, v65, v65, s50
    v_mul_f32 v80, v80, v64
    v_mfma_f32_16x16x32_bf16 v[32:35], a[228:231], a[104:107], v[32:35]
    s_waitcnt lgkmcnt(3)
    ds_read_b128 a[120:123], v4 offset:6144
    v_mul_f32 v81, v81, v65
    v_mfma_f32_16x16x32_bf16 v[24:27], v[124:127], a[108:111], v[24:27]
    s_cmp_eq_u32 s76, 4
    v_exp_f32 v80, v80
    v_mfma_f32_16x16x32_bf16 v[28:31], v[128:131], a[108:111], v[28:31]
    s_cselect_b32 s65, 0xffff1000, s78
    v_exp_f32 v81, v81
    v_mfma_f32_16x16x32_bf16 v[32:35], v[132:135], a[108:111], v[32:35]
    s_waitcnt lgkmcnt(3)
    ds_read_b128 a[100:103], v4 offset:11264
    v_mfma_f32_16x16x32_bf16 v[24:27], v[196:199], a[112:115], v[24:27]
    s_cselect_b32 s76, 0, s76
    v_add_f32 v80, 1.0, v80
    v_add_f32 v81, 1.0, v81
    v_mfma_f32_16x16x32_bf16 v[28:31], v[200:203], a[112:115], v[28:31]
    s_cmp_eq_u32 s66, 3
    v_rcp_f32 v80, v80
    v_mfma_f32_16x16x32_bf16 v[32:35], v[204:207], a[112:115], v[32:35]
    s_waitcnt lgkmcnt(2)
    ds_read_b128 a[104:107], v4 offset:16384
    v_mfma_f32_16x16x32_bf16 v[24:27], a[160:163], a[116:119], v[24:27]
    s_cselect_b32 s53, 0xffff7000, s79
    v_rcp_f32 v81, v81
    v_mul_f32 v64, v64, v80
    v_mul_f32 v65, v65, v81
    v_cvt_pk_bf16_f32 v64, v64, v65
    v_mul_f32 v66, v10, v66
    v_mfma_f32_16x16x32_bf16 v[28:31], a[164:167], a[116:119], v[28:31]
    s_cmp_eq_u32 s66, 0
    v_mul_f32 v67, v10, v67
    v_fma_f32 v82, v66, v66, s50
    v_mfma_f32_16x16x32_bf16 v[32:35], a[168:171], a[116:119], v[32:35]
    s_waitcnt lgkmcnt(2)
    ds_read_b128 a[108:111], v4 offset:2048
    v_fma_f32 v83, v67, v67, s50
    v_mfma_f32_16x16x32_bf16 v[24:27], a[232:235], a[120:123], v[24:27]
    s_cselect_b32 s59, 0xffff7000, s79
    v_mul_f32 v82, v82, v66
    v_mul_f32 v83, v83, v67
    v_mfma_f32_16x16x32_bf16 v[28:31], a[236:239], a[120:123], v[28:31]
    v_add_u32 v2, s53, v2
    v_add_u32 v3, s53, v3
    v_mfma_f32_16x16x32_bf16 v[32:35], a[240:243], a[120:123], v[32:35]
    s_waitcnt lgkmcnt(2)
    ds_read_b128 a[112:115], v4 offset:7168
    v_add_u32 v7, s59, v7
    v_mfma_f32_16x16x32_bf16 v[24:27], v[136:139], a[100:103], v[24:27]
    v_exp_f32 v82, v82
    v_mfma_f32_16x16x32_bf16 v[28:31], v[140:143], a[100:103], v[28:31]
    v_exp_f32 v83, v83
    v_mfma_f32_16x16x32_bf16 v[32:35], v[144:147], a[100:103], v[32:35]
    s_waitcnt lgkmcnt(2)
    ds_read_b128 a[116:119], v4 offset:12288
    v_mfma_f32_16x16x32_bf16 v[24:27], v[208:211], a[104:107], v[24:27]
    v_add_f32 v82, 1.0, v82
    v_add_f32 v83, 1.0, v83
    v_mfma_f32_16x16x32_bf16 v[28:31], v[212:215], a[104:107], v[28:31]
    v_rcp_f32 v82, v82
    v_mfma_f32_16x16x32_bf16 v[32:35], v[216:219], a[104:107], v[32:35]
    s_waitcnt lgkmcnt(2)
    ds_read_b128 a[120:123], v4 offset:17408
    v_mfma_f32_16x16x32_bf16 v[24:27], a[172:175], a[108:111], v[24:27]
    v_rcp_f32 v83, v83
    v_mfma_f32_16x16x32_bf16 v[28:31], a[176:179], a[108:111], v[28:31]
    v_mul_f32 v66, v66, v82
    v_mfma_f32_16x16x32_bf16 v[32:35], a[180:183], a[108:111], v[32:35]
    s_waitcnt lgkmcnt(2)
    ds_read_b128 a[100:103], v4 offset:3072
    v_mul_f32 v67, v67, v83
    v_mfma_f32_16x16x32_bf16 v[24:27], a[244:247], a[112:115], v[24:27]
    v_cvt_pk_bf16_f32 v65, v66, v67
    v_mul_f32 v68, v10, v68
    v_mfma_f32_16x16x32_bf16 v[28:31], a[248:251], a[112:115], v[28:31]
    v_mul_f32 v69, v10, v69
    v_fma_f32 v80, v68, v68, s50
    v_mfma_f32_16x16x32_bf16 v[32:35], a[252:255], a[112:115], v[32:35]
    s_waitcnt lgkmcnt(2)
    ds_read_b128 a[104:107], v4 offset:8192
    v_fma_f32 v81, v69, v69, s50
    v_mfma_f32_16x16x32_bf16 v[24:27], v[148:151], a[116:119], v[24:27]
    v_mul_f32 v80, v80, v68
    v_mul_f32 v81, v81, v69
    v_mfma_f32_16x16x32_bf16 v[28:31], v[152:155], a[116:119], v[28:31]
    v_exp_f32 v80, v80
    v_mfma_f32_16x16x32_bf16 v[32:35], v[156:159], a[116:119], v[32:35]
    s_waitcnt lgkmcnt(2)
    ds_read_b128 a[108:111], v4 offset:13312
    v_mfma_f32_16x16x32_bf16 v[24:27], v[220:223], a[120:123], v[24:27]
    v_exp_f32 v81, v81
    v_mfma_f32_16x16x32_bf16 v[28:31], v[224:227], a[120:123], v[28:31]
    v_add_f32 v80, 1.0, v80
    v_mfma_f32_16x16x32_bf16 v[32:35], v[228:231], a[120:123], v[32:35]
    s_waitcnt lgkmcnt(2)
    ds_read_b128 a[112:115], v4 offset:18432
    v_add_f32 v81, 1.0, v81
    v_mfma_f32_16x16x32_bf16 v[24:27], a[184:187], a[100:103], v[24:27]
    v_rcp_f32 v80, v80
    v_mfma_f32_16x16x32_bf16 v[28:31], a[188:191], a[100:103], v[28:31]
    v_rcp_f32 v81, v81
    v_mfma_f32_16x16x32_bf16 v[32:35], a[192:195], a[100:103], v[32:35]
    s_waitcnt lgkmcnt(2)
    ds_read_b128 a[116:119], v4 offset:4096
    v_mfma_f32_16x16x32_bf16 v[24:27], v[88:91], a[104:107], v[24:27]
    v_mul_f32 v68, v68, v80
    v_mfma_f32_16x16x32_bf16 v[28:31], v[92:95], a[104:107], v[28:31]
    v_mul_f32 v69, v69, v81
    v_cvt_pk_bf16_f32 v66, v68, v69
    v_mfma_f32_16x16x32_bf16 v[32:35], v[96:99], a[104:107], v[32:35]
    s_waitcnt lgkmcnt(2)
    ds_read_b128 a[120:123], v4 offset:9216
    v_mul_f32 v70, v10, v70
    v_mfma_f32_16x16x32_bf16 v[24:27], v[160:163], a[108:111], v[24:27]
    v_mul_f32 v71, v10, v71
    v_fma_f32 v82, v70, v70, s50
    v_mfma_f32_16x16x32_bf16 v[28:31], v[164:167], a[108:111], v[28:31]
    v_fma_f32 v83, v71, v71, s50
    v_mul_f32 v82, v82, v70
    v_mfma_f32_16x16x32_bf16 v[32:35], v[168:171], a[108:111], v[32:35]
    s_waitcnt lgkmcnt(2)
    ds_read_b128 a[100:103], v4 offset:14336
    v_mul_f32 v83, v83, v71
    v_mfma_f32_16x16x32_bf16 v[24:27], v[232:235], a[112:115], v[24:27]
    v_exp_f32 v82, v82
    v_mfma_f32_16x16x32_bf16 v[28:31], v[236:239], a[112:115], v[28:31]
    v_exp_f32 v83, v83
    v_mfma_f32_16x16x32_bf16 v[32:35], v[240:243], a[112:115], v[32:35]
    s_waitcnt lgkmcnt(2)
    ds_read_b128 a[104:107], v4 offset:19456
    v_add_u32 v4, s65, v4
    v_mfma_f32_16x16x32_bf16 v[24:27], a[196:199], a[116:119], v[24:27]
    v_add_f32 v82, 1.0, v82
    v_add_f32 v83, 1.0, v83
    v_mfma_f32_16x16x32_bf16 v[28:31], a[200:203], a[116:119], v[28:31]
    v_rcp_f32 v82, v82
    v_mfma_f32_16x16x32_bf16 v[32:35], a[204:207], a[116:119], v[32:35]
    s_waitcnt lgkmcnt(2)
    v_rcp_f32 v83, v83
    v_mfma_f32_16x16x32_bf16 v[24:27], v[100:103], a[120:123], v[24:27]
    v_mul_f32 v70, v70, v82
    v_mul_f32 v71, v71, v83
    v_mfma_f32_16x16x32_bf16 v[28:31], v[104:107], a[120:123], v[28:31]
    s_waitcnt lgkmcnt(0)
    s_barrier
    ds_read_b128 a[108:111], v5 offset:0
.p2align 6
L_p2:
    v_mfma_f32_16x16x32_bf16 v[32:35], v[108:111], a[120:123], v[32:35]
    s_waitcnt lgkmcnt(2)
    ds_read_b128 a[112:115], v5 offset:2048
    v_cvt_pk_bf16_f32 v67, v70, v71
    v_mfma_f32_16x16x32_bf16 v[24:27], v[172:175], a[100:103], v[24:27]
    s_add_u32 m0, s63, s74
    ds_read_b128 a[124:127], v8 offset:0
    ds_write_b128 v6, v[64:67] offset:8192
    v_mfma_f32_16x16x32_bf16 v[28:31], v[176:179], a[100:103], v[28:31]
    ds_read_b128 a[128:131], v8 offset:2048
    v_mul_f32 v72, v10, v72
    v_mfma_f32_16x16x32_bf16 v[32:35], v[180:183], a[100:103], v[32:35]
    s_waitcnt lgkmcnt(5)
    ds_read_b128 a[116:119], v5 offset:4096
    v_mul_f32 v73, v10, v73
    v_mfma_f32_16x16x32_bf16 v[24:27], v[244:247], a[104:107], v[24:27]
    ds_read_b128 a[132:135], v8 offset:4096
    v_fma_f32 v80, v72, v72, s50
    v_mfma_f32_16x16x32_bf16 v[28:31], v[248:251], a[104:107], v[28:31]
    buffer_load_dwordx4 v1, s[12:15], s56 offen offset:0  lds
    v_add_u32 v8, s59, v8
    v_mfma_f32_16x16x32_bf16 v[32:35], v[252:255], a[104:107], v[32:35]
    s_waitcnt lgkmcnt(6)
    ds_read_b128 a[120:123], v5 offset:6144
    v_fma_f32 v81, v73, v73, s50
    v_mfma_f32_16x16x32_bf16 v[24:27], a[136:139], a[108:111], v[24:27]
    v_mul_f32 v80, v80, v72
    v_mul_f32 v81, v81, v73
    v_mfma_f32_16x16x32_bf16 v[28:31], a[140:143], a[108:111], v[28:31]
    v_exp_f32 v80, v80
    v_mfma_f32_16x16x32_bf16 v[32:35], a[144:147], a[108:111], v[32:35]
    s_waitcnt lgkmcnt(6)
    ds_read_b128 a[100:103], v3 offset:0
    v_mfma_f32_16x16x32_bf16 v[24:27], a[208:211], a[112:115], v[24:27]
    buffer_load_dwordx4 v1, s[12:15], s56 offen offset:1024  lds
    v_mfma_f32_16x16x32_bf16 v[28:31], a[212:215], a[112:115], v[28:31]
    v_exp_f32 v81, v81
    v_mfma_f32_16x16x32_bf16 v[32:35], a[216:219], a[112:115], v[32:35]
    s_waitcnt lgkmcnt(3)
    ds_read_b128 a[104:107], v3 offset:2048
    v_mfma_f32_16x16x32_bf16 v[24:27], v[112:115], a[116:119], v[24:27]
    v_add_f32 v80, 1.0, v80
    v_add_f32 v81, 1.0, v81
    v_mfma_f32_16x16x32_bf16 v[28:31], v[116:119], a[116:119], v[28:31]
    v_rcp_f32 v80, v80
    v_mfma_f32_16x16x32_bf16 v[32:35], v[120:123], a[116:119], v[32:35]
    s_waitcnt lgkmcnt(2)
    ds_read_b128 a[108:111], v3 offset:4096
    v_mfma_f32_16x16x32_bf16 v[24:27], v[184:187], a[120:123], v[24:27]
    v_rcp_f32 v81, v81
    v_mfma_f32_16x16x32_bf16 v[28:31], v[188:191], a[120:123], v[28:31]
    buffer_load_dwordx4 v1, s[12:15], s56 offen offset:2048  lds
    v_mfma_f32_16x16x32_bf16 v[32:35], v[192:195], a[120:123], v[32:35]
    s_waitcnt lgkmcnt(2)
    ds_read_b128 a[112:115], v2 offset:0
    v_mul_f32 v72, v72, v80
    v_mfma_f32_16x16x32_bf16 v[48:51], a[12:15], a[100:103], 0
    v_mul_f32 v73, v73, v81
    v_cvt_pk_bf16_f32 v72, v72, v73
    v_mfma_f32_16x16x32_bf16 v[52:55], a[36:39], a[100:103], 0
    s_waitcnt lgkmcnt(2)
    ds_read_b128 a[116:119], v2 offset:2048
    v_mul_f32 v74, v10, v74
    v_mfma_f32_16x16x32_bf16 v[48:51], a[16:19], a[104:107], v[48:51]
    v_mul_f32 v75, v10, v75
    v_fma_f32 v82, v74, v74, s50
    v_mfma_f32_16x16x32_bf16 v[52:55], a[40:43], a[104:107], v[52:55]
    s_waitcnt lgkmcnt(2)
    ds_read_b128 a[120:123], v2 offset:4096
    v_cvt_pk_bf16_f32 v24, v24, v25
    v_cvt_pk_bf16_f32 v25, v26, v27
    v_mfma_f32_16x16x32_bf16 v[48:51], a[20:23], a[108:111], v[48:51]
    ds_write_b64 v7, v[24:25] offset:0
    v_cvt_pk_bf16_f32 v28, v28, v29
    v_cvt_pk_bf16_f32 v29, v30, v31
    v_mfma_f32_16x16x32_bf16 v[52:55], a[44:47], a[108:111], v[52:55]
    s_waitcnt lgkmcnt(3)
    ds_read_b128 a[100:103], v4 offset:0
    v_cvt_pk_bf16_f32 v32, v32, v33
    v_cvt_pk_bf16_f32 v33, v34, v35
    v_mfma_f32_16x16x32_bf16 v[48:51], a[0:3], a[112:115], v[48:51]
    ds_write_b64 v7, v[28:29] offset:2048
    v_mfma_f32_16x16x32_bf16 v[52:55], a[24:27], a[112:115], v[52:55]
    ds_write_b64 v7, v[32:33] offset:4096
    v_mfma_f32_16x16x32_bf16 v[24:27], a[96:99], a[112:115], v[12:15]
    s_waitcnt lgkmcnt(5)
    ds_read_b128 a[104:107], v4 offset:4096
    v_fma_f32 v83, v75, v75, s50
    v_mfma_f32_16x16x32_bf16 v[48:51], a[4:7], a[116:119], v[48:51]
    ds_read_b32 v86, v9 offset:128
    v_mul_f32 v82, v82, v74
    v_mfma_f32_16x16x32_bf16 v[52:55], a[28:31], a[116:119], v[52:55]
    buffer_load_dwordx4 v1, s[12:15], s56 offen offset:3072  lds
    v_mfma_f32_16x16x32_bf16 v[28:31], a[96:99], a[116:119], v[16:19]
    s_waitcnt lgkmcnt(6)
    ds_read_b128 a[108:111], v4 offset:8192
    v_mul_f32 v83, v83, v75
    v_mfma_f32_16x16x32_bf16 v[48:51], a[8:11], a[120:123], v[48:51]
    s_add_u32 m0, m0, 4096
    v_exp_f32 v82, v82
    v_mfma_f32_16x16x32_bf16 v[52:55], a[32:35], a[120:123], v[52:55]
    s_add_u32 s52, s56, 4096
    v_exp_f32 v83, v83
    v_mfma_f32_16x16x32_bf16 v[32:35], a[96:99], a[120:123], v[20:23]
    s_waitcnt lgkmcnt(5)
    ds_read_b128 a[112:115], v4 offset:12288
    v_mfma_f32_16x16x32_bf16 v[36:39], a[160:163], a[100:103], v[36:39]
    s_waitcnt lgkmcnt(2)
    buffer_load_dwordx4 v1, s[12:15], s52 offen offset:0  lds
    v_mfma_f32_16x16x32_bf16 v[40:43], a[164:167], a[100:103], v[40:43]
    v_add_f32 v82, 1.0, v82
    v_mfma_f32_16x16x32_bf16 v[44:47], a[168:171], a[100:103], v[44:47]
    s_waitcnt lgkmcnt(3)
    ds_read_b128 a[116:119], v4 offset:1024
    v_add_f32 v83, 1.0, v83
    v_mfma_f32_16x16x32_bf16 v[36:39], a[232:235], a[104:107], v[36:39]
    s_add_u32 m0, s62, 0
    v_rcp_f32 v82, v82
    v_mfma_f32_16x16x32_bf16 v[40:43], a[236:239], a[104:107], v[40:43]
    s_add_u32 s76, s76, 1
    v_rcp_f32 v83, v83
    v_mfma_f32_16x16x32_bf16 v[44:47], a[240:243], a[104:107], v[44:47]
    s_waitcnt lgkmcnt(2)
    ds_read_b128 a[120:123], v4 offset:5120
    v_mfma_f32_16x16x32_bf16 v[36:39], v[136:139], a[108:111], v[36:39]
    s_cmp_eq_u32 s76, 4
    v_mul_f32 v74, v74, v82
    v_mul_f32 v75, v75, v83
    v_mfma_f32_16x16x32_bf16 v[40:43], v[140:143], a[108:111], v[40:43]
    s_cselect_b32 s65, 0xffff1000, s78
    v_cvt_pk_bf16_f32 v73, v74, v75
    v_mul_f32 v76, v10, v76
    v_mfma_f32_16x16x32_bf16 v[44:47], v[144:147], a[108:111], v[44:47]
    s_waitcnt lgkmcnt(2)
    ds_read_b128 a[100:103], v4 offset:9216
    v_mul_f32 v77, v10, v77
    v_mfma_f32_16x16x32_bf16 v[36:39], v[208:211], a[112:115], v[36:39]
    s_cselect_b32 s76, 0, s76
    v_fma_f32 v80, v76, v76, s50
    v_fma_f32 v81, v77, v77, s50
    v_mfma_f32_16x16x32_bf16 v[40:43], v[212:215], a[112:115], v[40:43]
    s_add_u32 s66, s66, 1
    v_add_u32 v9, 128, v9
    v_mul_f32 v80, v80, v76
    v_mfma_f32_16x16x32_bf16 v[44:47], v[216:219], a[112:115], v[44:47]
    s_waitcnt lgkmcnt(2)
    ds_read_b128 a[104:107], v4 offset:13312
    v_mul_f32 v81, v81, v77
    v_mfma_f32_16x16x32_bf16 v[36:39], a[172:175], a[116:119], v[36:39]
    s_and_b32 s66, s66, 3
    v_exp_f32 v80, v80
    v_mfma_f32_16x16x32_bf16 v[40:43], a[176:179], a[116:119], v[40:43]
    s_sub_u32 s54, s54, 1
    v_exp_f32 v81, v81
    v_mfma_f32_16x16x32_bf16 v[44:47], a[180:183], a[116:119], v[44:47]
    s_waitcnt lgkmcnt(2)
    ds_read_b128 a[108:111], v4 offset:2048
    v_add_f32 v80, 1.0, v80
    v_mfma_f32_16x16x32_bf16 v[36:39], a[244:247], a[120:123], v[36:39]
    s_waitcnt lgkmcnt(15)
    buffer_load_dwordx4 v0, s[4:7], s55 offen offset:0  lds
    v_add_f32 v81, 1.0, v81
    v_mfma_f32_16x16x32_bf16 v[40:43], a[248:251], a[120:123], v[40:43]
    s_add_u32 m0, s62, 1920
    v_rcp_f32 v80, v80
    v_mfma_f32_16x16x32_bf16 v[44:47], a[252:255], a[120:123], v[44:47]
    s_waitcnt lgkmcnt(2)
    ds_read_b128 a[112:115], v4 offset:6144
    v_mfma_f32_16x16x32_bf16 v[36:39], v[148:151], a[100:103], v[36:39]
    buffer_load_dwordx4 v0, s[4:7], s55 offen offset:128  lds
    v_mfma_f32_16x16x32_bf16 v[40:43], v[152:155], a[100:103], v[40:43]
    s_add_u32 m0, s62, 3840
    v_rcp_f32 v81, v81
    v_mfma_f32_16x16x32_bf16 v[44:47], v[156:159], a[100:103], v[44:47]
    s_waitcnt lgkmcnt(2)
    ds_read_b128 a[116:119], v4 offset:10240
    v_mul_f32 v76, v76, v80
    v_mfma_f32_16x16x32_bf16 v[36:39], v[220:223], a[104:107], v[36:39]
    buffer_load_dwordx4 v0, s[4:7], s55 offen offset:256  lds
    v_mfma_f32_16x16x32_bf16 v[40:43], v[224:227], a[104:107], v[40:43]
    s_add_u32 s56, s56, 36864
    v_mul_f32 v77, v77, v81
    v_cvt_pk_bf16_f32 v74, v76, v77
    v_mfma_f32_16x16x32_bf16 v[44:47], v[228:231], a[104:107], v[44:47]
    s_waitcnt lgkmcnt(2)
    ds_read_b128 a[120:123], v4 offset:14336
    v_mul_f32 v78, v10, v78
    v_mfma_f32_16x16x32_bf16 v[36:39], a[184:187], a[108:111], v[36:39]
    s_add_u32 s67, s67, 1
    v_mul_f32 v79, v10, v79
    v_fma_f32 v82, v78, v78, s50
    v_mfma_f32_16x16x32_bf16 v[40:43], a[188:191], a[108:111], v[40:43]
    s_cmp_eq_u32 s67, 4
    v_fma_f32 v83, v79, v79, s50
    v_mul_f32 v82, v82, v78
    v_mfma_f32_16x16x32_bf16 v[44:47], a[192:195], a[108:111], v[44:47]
    s_waitcnt lgkmcnt(2)
    ds_read_b128 a[100:103], v4 offset:3072
    v_mul_f32 v83, v83, v79
    v_mfma_f32_16x16x32_bf16 v[36:39], v[88:91], a[112:115], v[36:39]
    s_cselect_b32 s64, 0xffff1000, s78
    v_exp_f32 v82, v82
    v_mfma_f32_16x16x32_bf16 v[40:43], v[92:95], a[112:115], v[40:43]
    s_cselect_b32 s67, 0, s67
    v_exp_f32 v83, v83
    v_mfma_f32_16x16x32_bf16 v[44:47], v[96:99], a[112:115], v[44:47]
    s_waitcnt lgkmcnt(2)
    ds_read_b128 a[104:107], v4 offset:7168
    v_add_f32 v82, 1.0, v82
    v_mfma_f32_16x16x32_bf16 v[36:39], v[160:163], a[116:119], v[36:39]
    s_add_u32 s63, s63, s64
    v_add_f32 v83, 1.0, v83
    v_rcp_f32 v82, v82
    v_mfma_f32_16x16x32_bf16 v[40:43], v[164:167], a[116:119], v[40:43]
    s_add_u32 s62, s62, s59
    v_rcp_f32 v83, v83
    v_mfma_f32_16x16x32_bf16 v[44:47], v[168:171], a[116:119], v[44:47]
    s_waitcnt lgkmcnt(2)
    ds_read_b128 a[108:111], v4 offset:11264
    v_mul_f32 v78, v78, v82
    v_mfma_f32_16x16x32_bf16 v[36:39], v[232:235], a[120:123], v[36:39]
    s_add_u32 s55, s55, 12288
    v_mul_f32 v79, v79, v83
    v_cvt_pk_bf16_f32 v75, v78, v79
    v_mfma_f32_16x16x32_bf16 v[40:43], v[236:239], a[120:123], v[40:43]
    ds_write_b128 v6, v[72:75] offset:9216
    v_mfma_f32_16x16x32_bf16 v[44:47], v[240:243], a[120:123], v[44:47]
    s_waitcnt lgkmcnt(3)
    ds_read_b128 a[112:115], v4 offset:15360
    v_add_u32 v4, s65, v4
    v_mfma_f32_16x16x32_bf16 v[36:39], a[196:199], a[100:103], v[36:39]
    v_mul_f32 v48, v86, v48
    v_mfma_f32_16x16x32_bf16 v[40:43], a[200:203], a[100:103], v[40:43]
    v_mul_f32 v49, v86, v49
    v_mfma_f32_16x16x32_bf16 v[44:47], a[204:207], a[100:103], v[44:47]
    s_waitcnt lgkmcnt(3)
    v_fma_f32 v80, v48, v48, s50
    v_mfma_f32_16x16x32_bf16 v[36:39], v[100:103], a[104:107], v[36:39]
    v_fma_f32 v81, v49, v49, s50
    v_mfma_f32_16x16x32_bf16 v[40:43], v[104:107], a[104:107], v[40:43]
    s_waitcnt vmcnt(18) lgkmcnt(0)
    s_barrier
    ds_read_b128 a[116:119], v5 offset:8192
    v_mfma_f32_16x16x32_bf16 v[44:47], v[108:111], a[104:107], v[44:47]
    s_waitcnt lgkmcnt(3)
    ds_read_b128 a[120:123], v5 offset:10240
    v_mfma_f32_16x16x32_bf16 v[36:39], v[172:175], a[108:111], v[36:39]
    s_add_u32 m0, s63, s75
    v_mul_f32 v80, v80, v48
    v_mfma_f32_16x16x32_bf16 v[40:43], v[176:179], a[108:111], v[40:43]
    buffer_load_dwordx4 v1, s[12:15], s57 offen offset:0  lds
    v_mfma_f32_16x16x32_bf16 v[44:47], v[180:183], a[108:111], v[44:47]
    s_waitcnt lgkmcnt(2)
    ds_read_b128 a[100:103], v5 offset:12288
    v_mul_f32 v81, v81, v49
    v_mfma_f32_16x16x32_bf16 v[36:39], v[244:247], a[112:115], v[36:39]
    v_exp_f32 v80, v80
    v_mfma_f32_16x16x32_bf16 v[40:43], v[248:251], a[112:115], v[40:43]
    v_exp_f32 v81, v81
    v_mfma_f32_16x16x32_bf16 v[44:47], v[252:255], a[112:115], v[44:47]
    s_waitcnt lgkmcnt(2)
    ds_read_b128 a[104:107], v5 offset:14336
    v_mfma_f32_16x16x32_bf16 v[36:39], a[136:139], a[116:119], v[36:39]
    v_add_f32 v80, 1.0, v80
    v_add_f32 v81, 1.0, v81
    v_mfma_f32_16x16x32_bf16 v[40:43], a[140:143], a[116:119], v[40:43]
    v_rcp_f32 v80, v80
    v_mfma_f32_16x16x32_bf16 v[44:47], a[144:147], a[116:119], v[44:47]
    s_waitcnt lgkmcnt(2)
    ds_read_b128 a[108:111], v5 offset:9216
    v_mfma_f32_16x16x32_bf16 v[36:39], a[208:211], a[120:123], v[36:39]
    v_rcp_f32 v81, v81
    v_mfma_f32_16x16x32_bf16 v[40:43], a[212:215], a[120:123], v[40:43]
    v_mul_f32 v48, v48, v80
    v_mul_f32 v49, v49, v81
    v_mfma_f32_16x16x32_bf16 v[44:47], a[216:219], a[120:123], v[44:47]
    s_waitcnt lgkmcnt(2)
    ds_read_b128 a[112:115], v5 offset:11264
    v_cvt_pk_bf16_f32 v48, v48, v49
    v_mfma_f32_16x16x32_bf16 v[36:39], v[112:115], a[100:103], v[36:39]
    v_mul_f32 v50, v86, v50
    v_mul_f32 v51, v86, v51
    v_mfma_f32_16x16x32_bf16 v[40:43], v[116:119], a[100:103], v[40:43]
    buffer_store_dwordx4 a[124:127], v0, s[8:11], s61 offen offset:0 nt
    v_fma_f32 v82, v50, v50, s50
    v_mfma_f32_16x16x32_bf16 v[44:47], v[120:123], a[100:103], v[44:47]
    s_waitcnt lgkmcnt(2)
    ds_read_b128 a[116:119], v5 offset:13312
    v_fma_f32 v83, v51, v51, s50
    v_mfma_f32_16x16x32_bf16 v[36:39], v[184:187], a[104:107], v[36:39]
    v_mul_f32 v82, v82, v50
    v_mul_f32 v83, v83, v51
    v_mfma_f32_16x16x32_bf16 v[40:43], v[188:191], a[104:107], v[40:43]
    v_exp_f32 v82, v82
    v_mfma_f32_16x16x32_bf16 v[44:47], v[192:195], a[104:107], v[44:47]
    s_waitcnt lgkmcnt(2)
    ds_read_b128 a[120:123], v5 offset:15360
    v_mfma_f32_16x16x32_bf16 v[36:39], a[148:151], a[108:111], v[36:39]
    v_exp_f32 v83, v83
    v_mfma_f32_16x16x32_bf16 v[40:43], a[152:155], a[108:111], v[40:43]
    v_add_f32 v82, 1.0, v82
    v_mfma_f32_16x16x32_bf16 v[44:47], a[156:159], a[108:111], v[44:47]
    s_waitcnt lgkmcnt(2)
    ds_read_b128 a[100:103], v3 offset:6144
    v_add_f32 v83, 1.0, v83
    v_mfma_f32_16x16x32_bf16 v[36:39], a[220:223], a[112:115], v[36:39]
    v_rcp_f32 v82, v82
    v_mfma_f32_16x16x32_bf16 v[40:43], a[224:227], a[112:115], v[40:43]
    v_rcp_f32 v83, v83
    v_mfma_f32_16x16x32_bf16 v[44:47], a[228:231], a[112:115], v[44:47]
    s_waitcnt lgkmcnt(2)
    ds_read_b128 a[104:107], v3 offset:8192
    v_mul_f32 v50, v50, v82
    v_mfma_f32_16x16x32_bf16 v[36:39], v[124:127], a[116:119], v[36:39]
    v_mul_f32 v51, v51, v83
    v_cvt_pk_bf16_f32 v49, v50, v51
    v_mfma_f32_16x16x32_bf16 v[40:43], v[128:131], a[116:119], v[40:43]
    v_mul_f32 v52, v86, v52
    v_mul_f32 v53, v86, v53
    v_mfma_f32_16x16x32_bf16 v[44:47], v[132:135], a[116:119], v[44:47]
    s_waitcnt lgkmcnt(2)
    ds_read_b128 a[108:111], v3 offset:10240
    v_fma_f32 v80, v52, v52, s50
    v_mfma_f32_16x16x32_bf16 v[36:39], v[196:199], a[120:123], v[36:39]
    buffer_load_dwordx4 v1, s[12:15], s57 offen offset:1024  lds
    v_mfma_f32_16x16x32_bf16 v[40:43], v[200:203], a[120:123], v[40:43]
    v_fma_f32 v81, v53, v53, s50
    v_mul_f32 v80, v80, v52
    v_mfma_f32_16x16x32_bf16 v[44:47], v[204:207], a[120:123], v[44:47]
    s_waitcnt lgkmcnt(2)
    ds_read_b128 a[112:115], v2 offset:6144
    v_mul_f32 v81, v81, v53
    s_cmp_eq_u32 s54, 0
    s_cbranch_scc1 L_out
    v_mfma_f32_16x16x32_bf16 v[64:67], a[12:15], a[100:103], 0
    v_exp_f32 v80, v80
    v_mfma_f32_16x16x32_bf16 v[68:71], a[36:39], a[100:103], 0
    v_exp_f32 v81, v81
    v_mfma_f32_16x16x32_bf16 v[72:75], a[60:63], a[100:103], 0
    v_add_f32 v80, 1.0, v80
    v_mfma_f32_16x16x32_bf16 v[76:79], a[84:87], a[100:103], 0
    s_waitcnt lgkmcnt(2)
    ds_read_b128 a[116:119], v2 offset:8192
    v_cvt_pk_bf16_f32 v36, v36, v37
    v_cvt_pk_bf16_f32 v37, v38, v39
    v_mfma_f32_16x16x32_bf16 v[64:67], a[16:19], a[104:107], v[64:67]
    ds_write_b64 v7, v[36:37] offset:6144
    v_cvt_pk_bf16_f32 v40, v40, v41
    v_cvt_pk_bf16_f32 v41, v42, v43
    v_mfma_f32_16x16x32_bf16 v[68:71], a[40:43], a[104:107], v[68:71]
    v_cvt_pk_bf16_f32 v44, v44, v45
    v_cvt_pk_bf16_f32 v45, v46, v47
    v_mfma_f32_16x16x32_bf16 v[72:75], a[64:67], a[104:107], v[72:75]
    ds_write_b64 v7, v[40:41] offset:8192
    v_mfma_f32_16x16x32_bf16 v[76:79], a[88:91], a[104:107], v[76:79]
    s_waitcnt lgkmcnt(4)
    ds_read_b128 a[120:123], v2 offset:10240
    v_add_f32 v81, 1.0, v81
    v_mfma_f32_16x16x32_bf16 v[64:67], a[20:23], a[108:111], v[64:67]
    ds_write_b64 v7, v[44:45] offset:10240
    v_mfma_f32_16x16x32_bf16 v[68:71], a[44:47], a[108:111], v[68:71]
    v_rcp_f32 v80, v80
    v_mfma_f32_16x16x32_bf16 v[72:75], a[68:71], a[108:111], v[72:75]
    v_rcp_f32 v81, v81
    v_mfma_f32_16x16x32_bf16 v[76:79], a[92:95], a[108:111], v[76:79]
    s_waitcnt lgkmcnt(5)
    ds_read_b128 a[100:103], v4 offset:0
    v_mfma_f32_16x16x32_bf16 v[64:67], a[0:3], a[112:115], v[64:67]
    buffer_store_dwordx4 a[128:131], v0, s[8:11], s61 offen offset:128 nt
    v_mfma_f32_16x16x32_bf16 v[68:71], a[24:27], a[112:115], v[68:71]
    v_mul_f32 v52, v52, v80
    v_mul_f32 v53, v53, v81
    v_mfma_f32_16x16x32_bf16 v[72:75], a[48:51], a[112:115], v[72:75]
    v_cvt_pk_bf16_f32 v50, v52, v53
    v_mul_f32 v54, v86, v54
    v_mfma_f32_16x16x32_bf16 v[76:79], a[72:75], a[112:115], v[76:79]
    v_mul_f32 v55, v86, v55
    v_fma_f32 v82, v54, v54, s50
    v_mfma_f32_16x16x32_bf16 v[36:39], a[96:99], a[112:115], v[12:15]
    s_waitcnt lgkmcnt(5)
    ds_read_b128 a[104:107], v4 offset:5120
    v_fma_f32 v83, v55, v55, s50
    v_mfma_f32_16x16x32_bf16 v[64:67], a[4:7], a[116:119], v[64:67]
    v_mul_f32 v82, v82, v54
    v_mul_f32 v83, v83, v55
    v_mfma_f32_16x16x32_bf16 v[68:71], a[28:31], a[116:119], v[68:71]
    v_exp_f32 v82, v82
    v_mfma_f32_16x16x32_bf16 v[72:75], a[52:55], a[116:119], v[72:75]
    ds_read_b32 v10, v9 offset:64
    v_mfma_f32_16x16x32_bf16 v[76:79], a[76:79], a[116:119], v[76:79]
    v_exp_f32 v83, v83
    v_mfma_f32_16x16x32_bf16 v[40:43], a[96:99], a[116:119], v[16:19]
    s_waitcnt lgkmcnt(4)
    ds_read_b128 a[108:111], v4 offset:10240
    v_mfma_f32_16x16x32_bf16 v[64:67], a[8:11], a[120:123], v[64:67]
    v_add_f32 v82, 1.0, v82
    v_add_f32 v83, 1.0, v83
    v_mfma_f32_16x16x32_bf16 v[68:71], a[32:35], a[120:123], v[68:71]
    v_rcp_f32 v82, v82
    v_mfma_f32_16x16x32_bf16 v[72:75], a[56:59], a[120:123], v[72:75]
    buffer_load_dwordx4 v1, s[12:15], s57 offen offset:2048  lds
    v_mfma_f32_16x16x32_bf16 v[76:79], a[80:83], a[120:123], v[76:79]
    v_rcp_f32 v83, v83
    v_mfma_f32_16x16x32_bf16 v[44:47], a[96:99], a[120:123], v[20:23]
    s_waitcnt lgkmcnt(3)
    ds_read_b128 a[112:115], v4 offset:15360
    v_mul_f32 v54, v54, v82
    v_mfma_f32_16x16x32_bf16 v[24:27], a[148:151], a[100:103], v[24:27]
    s_waitcnt lgkmcnt(2)
    v_mul_f32 v55, v55, v83
    v_cvt_pk_bf16_f32 v51, v54, v55
    v_mfma_f32_16x16x32_bf16 v[28:31], a[152:155], a[100:103], v[28:31]
    ds_write_b128 v6, v[48:51] offset:0
    v_mfma_f32_16x16x32_bf16 v[32:35], a[156:159], a[100:103], v[32:35]
    s_waitcnt lgkmcnt(4)
    ds_read_b128 a[116:119], v4 offset:1024
    v_mul_f32 v64, v10, v64
    v_mfma_f32_16x16x32_bf16 v[24:27], a[220:223], a[104:107], v[24:27]
    v_mul_f32 v65, v10, v65
    v_fma_f32 v80, v64, v64, s50
    v_mfma_f32_16x16x32_bf16 v[28:31], a[224:227], a[104:107], v[28:31]
    s_add_u32 s76, s76, 1
    v_fma_f32 v81, v65, v65, s50
    v_mul_f32 v80, v80, v64
    v_mfma_f32_16x16x32_bf16 v[32:35], a[228:231], a[104:107], v[32:35]
    s_waitcnt lgkmcnt(3)
    ds_read_b128 a[120:123], v4 offset:6144
    v_mul_f32 v81, v81, v65
    v_mfma_f32_16x16x32_bf16 v[24:27], v[124:127], a[108:111], v[24:27]
    s_cmp_eq_u32 s76, 4
    v_exp_f32 v80, v80
    v_mfma_f32_16x16x32_bf16 v[28:31], v[128:131], a[108:111], v[28:31]
    s_cselect_b32 s65, 0xffff1000, s78
    v_exp_f32 v81, v81
    v_mfma_f32_16x16x32_bf16 v[32:35], v[132:135], a[108:111], v[32:35]
    s_waitcnt lgkmcnt(3)
    ds_read_b128 a[100:103], v4 offset:11264
    v_mfma_f32_16x16x32_bf16 v[24:27], v[196:199], a[112:115], v[24:27]
    s_cselect_b32 s76, 0, s76
    v_add_f32 v80, 1.0, v80
    v_add_f32 v81, 1.0, v81
    v_mfma_f32_16x16x32_bf16 v[28:31], v[200:203], a[112:115], v[28:31]
    s_cmp_eq_u32 s66, 3
    v_rcp_f32 v80, v80
    v_mfma_f32_16x16x32_bf16 v[32:35], v[204:207], a[112:115], v[32:35]
    s_waitcnt lgkmcnt(2)
    ds_read_b128 a[104:107], v4 offset:16384
    v_mfma_f32_16x16x32_bf16 v[24:27], a[160:163], a[116:119], v[24:27]
    s_cselect_b32 s53, 0xffff7000, s79
    buffer_store_dwordx4 a[132:135], v0, s[8:11], s61 offen offset:256 nt
    v_rcp_f32 v81, v81
    v_mul_f32 v64, v64, v80
    v_mul_f32 v65, v65, v81
    v_cvt_pk_bf16_f32 v64, v64, v65
    v_mul_f32 v66, v10, v66
    v_mfma_f32_16x16x32_bf16 v[28:31], a[164:167], a[116:119], v[28:31]
    s_cmp_eq_u32 s66, 0
    v_mul_f32 v67, v10, v67
    v_fma_f32 v82, v66, v66, s50
    v_mfma_f32_16x16x32_bf16 v[32:35], a[168:171], a[116:119], v[32:35]
    s_waitcnt lgkmcnt(2)
    ds_read_b128 a[108:111], v4 offset:2048
    v_fma_f32 v83, v67, v67, s50
    v_mfma_f32_16x16x32_bf16 v[24:27], a[232:235], a[120:123], v[24:27]
    s_cselect_b32 s59, 0xffff7000, s79
    v_mul_f32 v82, v82, v66
    v_mul_f32 v83, v83, v67
    v_mfma_f32_16x16x32_bf16 v[28:31], a[236:239], a[120:123], v[28:31]
    v_add_u32 v2, s53, v2
    v_add_u32 v3, s53, v3
    v_mfma_f32_16x16x32_bf16 v[32:35], a[240:243], a[120:123], v[32:35]
    s_waitcnt lgkmcnt(2)
    ds_read_b128 a[112:115], v4 offset:7168
    v_add_u32 v7, s59, v7
    v_mfma_f32_16x16x32_bf16 v[24:27], v[136:139], a[100:103], v[24:27]
    v_exp_f32 v82, v82
    v_mfma_f32_16x16x32_bf16 v[28:31], v[140:143], a[100:103], v[28:31]
    v_exp_f32 v83, v83
    v_mfma_f32_16x16x32_bf16 v[32:35], v[144:147], a[100:103], v[32:35]
    s_waitcnt lgkmcnt(2)
    ds_read_b128 a[116:119], v4 offset:12288
    v_mfma_f32_16x16x32_bf16 v[24:27], v[208:211], a[104:107], v[24:27]
    v_add_f32 v82, 1.0, v82
    v_add_f32 v83, 1.0, v83
    v_mfma_f32_16x16x32_bf16 v[28:31], v[212:215], a[104:107], v[28:31]
    v_rcp_f32 v82, v82
    v_mfma_f32_16x16x32_bf16 v[32:35], v[216:219], a[104:107], v[32:35]
    s_waitcnt lgkmcnt(2)
    ds_read_b128 a[120:123], v4 offset:17408
    v_mfma_f32_16x16x32_bf16 v[24:27], a[172:175], a[108:111], v[24:27]
    v_rcp_f32 v83, v83
    v_mfma_f32_16x16x32_bf16 v[28:31], a[176:179], a[108:111], v[28:31]
    buffer_load_dwordx4 v1, s[12:15], s57 offen offset:3072  lds
    v_mul_f32 v66, v66, v82
    v_mfma_f32_16x16x32_bf16 v[32:35], a[180:183], a[108:111], v[32:35]
    s_waitcnt lgkmcnt(2)
    ds_read_b128 a[100:103], v4 offset:3072
    v_mul_f32 v67, v67, v83
    v_mfma_f32_16x16x32_bf16 v[24:27], a[244:247], a[112:115], v[24:27]
    s_add_u32 s57, s57, 36864
    v_cvt_pk_bf16_f32 v65, v66, v67
    v_mul_f32 v68, v10, v68
    v_mfma_f32_16x16x32_bf16 v[28:31], a[248:251], a[112:115], v[28:31]
    s_add_u32 s67, s67, 1
    v_mul_f32 v69, v10, v69
    v_fma_f32 v80, v68, v68, s50
    v_mfma_f32_16x16x32_bf16 v[32:35], a[252:255], a[112:115], v[32:35]
    s_waitcnt lgkmcnt(2)
    ds_read_b128 a[104:107], v4 offset:8192
    v_fma_f32 v81, v69, v69, s50
    v_mfma_f32_16x16x32_bf16 v[24:27], v[148:151], a[116:119], v[24:27]
    s_cmp_eq_u32 s67, 4
    v_mul_f32 v80, v80, v68
    v_mul_f32 v81, v81, v69
    v_mfma_f32_16x16x32_bf16 v[28:31], v[152:155], a[116:119], v[28:31]
    s_cselect_b32 s64, 0xffff1000, s78
    v_exp_f32 v80, v80
    v_mfma_f32_16x16x32_bf16 v[32:35], v[156:159], a[116:119], v[32:35]
    s_waitcnt lgkmcnt(2)
    ds_read_b128 a[108:111], v4 offset:13312
    v_mfma_f32_16x16x32_bf16 v[24:27], v[220:223], a[120:123], v[24:27]
    s_cselect_b32 s67, 0, s67
    v_exp_f32 v81, v81
    v_mfma_f32_16x16x32_bf16 v[28:31], v[224:227], a[120:123], v[28:31]
    s_add_u32 s63, s63, s64
    v_add_f32 v80, 1.0, v80
    v_mfma_f32_16x16x32_bf16 v[32:35], v[228:231], a[120:123], v[32:35]
    s_waitcnt lgkmcnt(2)
    ds_read_b128 a[112:115], v4 offset:18432
    v_add_f32 v81, 1.0, v81
    v_mfma_f32_16x16x32_bf16 v[24:27], a[184:187], a[100:103], v[24:27]
    s_add_u32 s61, s61, 12288
    v_rcp_f32 v80, v80
    v_mfma_f32_16x16x32_bf16 v[28:31], a[188:191], a[100:103], v[28:31]
    s_mov_b32 s10, 221184
    v_rcp_f32 v81, v81
    v_mfma_f32_16x16x32_bf16 v[32:35], a[192:195], a[100:103], v[32:35]
    s_waitcnt lgkmcnt(2)
    ds_read_b128 a[116:119], v4 offset:4096
    v_mfma_f32_16x16x32_bf16 v[24:27], v[88:91], a[104:107], v[24:27]
    v_mul_f32 v68, v68, v80
    v_mfma_f32_16x16x32_bf16 v[28:31], v[92:95], a[104:107], v[28:31]
    v_mul_f32 v69, v69, v81
    v_cvt_pk_bf16_f32 v66, v68, v69
    v_mfma_f32_16x16x32_bf16 v[32:35], v[96:99], a[104:107], v[32:35]
    s_waitcnt lgkmcnt(2)
    ds_read_b128 a[120:123], v4 offset:9216
    v_mul_f32 v70, v10, v70
    v_mfma_f32_16x16x32_bf16 v[24:27], v[160:163], a[108:111], v[24:27]
    v_mul_f32 v71, v10, v71
    v_fma_f32 v82, v70, v70, s50
    v_mfma_f32_16x16x32_bf16 v[28:31], v[164:167], a[108:111], v[28:31]
    v_fma_f32 v83, v71, v71, s50
    v_mul_f32 v82, v82, v70
    v_mfma_f32_16x16x32_bf16 v[32:35], v[168:171], a[108:111], v[32:35]
    s_waitcnt lgkmcnt(2)
    ds_read_b128 a[100:103], v4 offset:14336
    v_mul_f32 v83, v83, v71
    v_mfma_f32_16x16x32_bf16 v[24:27], v[232:235], a[112:115], v[24:27]
    v_exp_f32 v82, v82
    v_mfma_f32_16x16x32_bf16 v[28:31], v[236:239], a[112:115], v[28:31]
    v_exp_f32 v83, v83
    v_mfma_f32_16x16x32_bf16 v[32:35], v[240:243], a[112:115], v[32:35]
    s_waitcnt lgkmcnt(2)
    ds_read_b128 a[104:107], v4 offset:19456
    v_add_u32 v4, s65, v4
    v_mfma_f32_16x16x32_bf16 v[24:27], a[196:199], a[116:119], v[24:27]
    v_add_f32 v82, 1.0, v82
    v_add_f32 v83, 1.0, v83
    v_mfma_f32_16x16x32_bf16 v[28:31], a[200:203], a[116:119], v[28:31]
    v_rcp_f32 v82, v82
    v_mfma_f32_16x16x32_bf16 v[32:35], a[204:207], a[116:119], v[32:35]
    s_waitcnt lgkmcnt(2)
    v_rcp_f32 v83, v83
    v_mfma_f32_16x16x32_bf16 v[24:27], v[100:103], a[120:123], v[24:27]
    v_mul_f32 v70, v70, v82
    v_mul_f32 v71, v71, v83
    v_mfma_f32_16x16x32_bf16 v[28:31], v[104:107], a[120:123], v[28:31]
    s_waitcnt vmcnt(15) lgkmcnt(0)
    s_barrier
    ds_read_b128 a[108:111], v5 offset:0
    s_branch L_p2
L_out:
    buffer_store_dwordx4 a[128:131], v0, s[8:11], s61 offen offset:128 nt
    buffer_store_dwordx4 a[132:135], v0, s[8:11], s61 offen offset:256 nt
    s_add_u32 s61, s61, 12288
    s_nop 4
    v_cvt_pk_bf16_f32 v36, v36, v37
    v_cvt_pk_bf16_f32 v37, v38, v39
    v_cvt_pk_bf16_f32 v40, v40, v41
    v_cvt_pk_bf16_f32 v41, v42, v43
    v_cvt_pk_bf16_f32 v44, v44, v45
    v_cvt_pk_bf16_f32 v45, v46, v47
    ds_write_b64 v7, v[36:37] offset:6144
    ds_write_b64 v7, v[40:41] offset:8192
    ds_write_b64 v7, v[44:45] offset:10240
    s_waitcnt lgkmcnt(0)
    s_barrier
    ds_read_b128 a[100:103], v8 offset:0
    ds_read_b128 a[104:107], v8 offset:2048
    ds_read_b128 a[108:111], v8 offset:4096
    s_waitcnt lgkmcnt(2)
    buffer_store_dwordx4 a[100:103], v0, s[8:11], s61 offen offset:0 nt
    s_waitcnt lgkmcnt(1)
    buffer_store_dwordx4 a[104:107], v0, s[8:11], s61 offen offset:128 nt
    s_waitcnt lgkmcnt(0)
    buffer_store_dwordx4 a[108:111], v0, s[8:11], s61 offen offset:256 nt
    s_waitcnt vmcnt(0)
L_end:
    s_endpgm
L_j1a:
    s_lshl_b32 s53, s72, 6
    v_lshl_add_u32 v22, v251, 4, s53
    v_xor_b32 v23, 64, v22
    buffer_load_dwordx4 v[60:63], v22, s[24:27], 0 offen offset:0
    buffer_load_dwordx4 v[64:67], v22, s[24:27], 0 offen offset:128
    buffer_load_dwordx4 v[68:71], v22, s[24:27], 0 offen offset:256
    buffer_load_dwordx4 v[72:75], v23, s[24:27], 0 offen offset:0
    buffer_load_dwordx4 v[76:79], v23, s[24:27], 0 offen offset:128
    buffer_load_dwordx4 v[80:83], v23, s[24:27], 0 offen offset:256
    s_branch L_j1a_ret
L_j1b:
    v_mov_b32 v12, 0x3f803f80
    v_mov_b32 v13, 0x3f803f80
    v_mov_b32 v14, 0x3f803f80
    v_mov_b32 v15, 0x3f803f80
    s_bfe_u32 s52, s2, 0x20001
    s_waitcnt vmcnt(38) lgkmcnt(0)
    s_cmp_eq_u32 s52, 1
    s_cbranch_scc1 L_job1
    s_cmp_eq_u32 s52, 2
    s_cbranch_scc1 L_job2
    s_cmp_eq_u32 s52, 3
    s_cbranch_scc1 L_job3
L_job0:
    v_mfma_f32_16x16x32_bf16 v[16:19], v[12:15], a[0:3], 0
    v_mfma_f32_16x16x32_bf16 v[16:19], v[12:15], a[4:7], v[16:19]
    v_mfma_f32_16x16x32_bf16 v[16:19], v[12:15], a[8:11], v[16:19]
    v_mfma_f32_16x16x32_bf16 v[16:19], v[12:15], a[12:15], v[16:19]
    v_mfma_f32_16x16x32_bf16 v[16:19], v[12:15], a[16:19], v[16:19]
    v_mfma_f32_16x16x32_bf16 v[16:19], v[12:15], a[20:23], v[16:19]
    v_accvgpr_read_b32 v88, a0
    v_accvgpr_read_b32 v89, a1
    v_accvgpr_read_b32 v90, a2
    v_accvgpr_read_b32 v91, a3
    v_accvgpr_read_b32 v92, a4
    v_accvgpr_read_b32 v93, a5
    v_accvgpr_read_b32 v94, a6
    v_accvgpr_read_b32 v95, a7
    v_accvgpr_read_b32 v96, a8
    v_accvgpr_read_b32 v97, a9
    v_accvgpr_read_b32 v98, a10
    v_accvgpr_read_b32 v99, a11
    v_accvgpr_read_b32 v100, a12
    v_accvgpr_read_b32 v101, a13
    v_accvgpr_read_b32 v102, a14
    v_accvgpr_read_b32 v103, a15
    v_accvgpr_read_b32 v104, a16
    v_accvgpr_read_b32 v105, a17
    v_accvgpr_read_b32 v106, a18
    v_accvgpr_read_b32 v107, a19
    v_accvgpr_read_b32 v108, a20
    v_accvgpr_read_b32 v109, a21
    v_accvgpr_read_b32 v110, a22
    v_accvgpr_read_b32 v111, a23
    s_branch L_job_go
L_job1:
    v_mfma_f32_16x16x32_bf16 v[16:19], v[12:15], a[24:27], 0
    v_mfma_f32_16x16x32_bf16 v[16:19], v[12:15], a[28:31], v[16:19]
    v_mfma_f32_16x16x32_bf16 v[16:19], v[12:15], a[32:35], v[16:19]
    v_mfma_f32_16x16x32_bf16 v[16:19], v[12:15], a[36:39], v[16:19]
    v_mfma_f32_16x16x32_bf16 v[16:19], v[12:15], a[40:43], v[16:19]
    v_mfma_f32_16x16x32_bf16 v[16:19], v[12:15], a[44:47], v[16:19]
    v_accvgpr_read_b32 v88, a24
    v_accvgpr_read_b32 v89, a25
    v_accvgpr_read_b32 v90, a26
    v_accvgpr_read_b32 v91, a27
    v_accvgpr_read_b32 v92, a28
    v_accvgpr_read_b32 v93, a29
    v_accvgpr_read_b32 v94, a30
    v_accvgpr_read_b32 v95, a31
    v_accvgpr_read_b32 v96, a32
    v_accvgpr_read_b32 v97, a33
    v_accvgpr_read_b32 v98, a34
    v_accvgpr_read_b32 v99, a35
    v_accvgpr_read_b32 v100, a36
    v_accvgpr_read_b32 v101, a37
    v_accvgpr_read_b32 v102, a38
    v_accvgpr_read_b32 v103, a39
    v_accvgpr_read_b32 v104, a40
    v_accvgpr_read_b32 v105, a41
    v_accvgpr_read_b32 v106, a42
    v_accvgpr_read_b32 v107, a43
    v_accvgpr_read_b32 v108, a44
    v_accvgpr_read_b32 v109, a45
    v_accvgpr_read_b32 v110, a46
    v_accvgpr_read_b32 v111, a47
    s_branch L_job_go
L_job2:
    v_mfma_f32_16x16x32_bf16 v[16:19], v[12:15], a[48:51], 0
    v_mfma_f32_16x16x32_bf16 v[16:19], v[12:15], a[52:55], v[16:19]
    v_mfma_f32_16x16x32_bf16 v[16:19], v[12:15], a[56:59], v[16:19]
    v_mfma_f32_16x16x32_bf16 v[16:19], v[12:15], a[60:63], v[16:19]
    v_mfma_f32_16x16x32_bf16 v[16:19], v[12:15], a[64:67], v[16:19]
    v_mfma_f32_16x16x32_bf16 v[16:19], v[12:15], a[68:71], v[16:19]
    v_accvgpr_read_b32 v88, a48
    v_accvgpr_read_b32 v89, a49
    v_accvgpr_read_b32 v90, a50
    v_accvgpr_read_b32 v91, a51
    v_accvgpr_read_b32 v92, a52
    v_accvgpr_read_b32 v93, a53
    v_accvgpr_read_b32 v94, a54
    v_accvgpr_read_b32 v95, a55
    v_accvgpr_read_b32 v96, a56
    v_accvgpr_read_b32 v97, a57
    v_accvgpr_read_b32 v98, a58
    v_accvgpr_read_b32 v99, a59
    v_accvgpr_read_b32 v100, a60
    v_accvgpr_read_b32 v101, a61
    v_accvgpr_read_b32 v102, a62
    v_accvgpr_read_b32 v103, a63
    v_accvgpr_read_b32 v104, a64
    v_accvgpr_read_b32 v105, a65
    v_accvgpr_read_b32 v106, a66
    v_accvgpr_read_b32 v107, a67
    v_accvgpr_read_b32 v108, a68
    v_accvgpr_read_b32 v109, a69
    v_accvgpr_read_b32 v110, a70
    v_accvgpr_read_b32 v111, a71
    s_branch L_job_go
L_job3:
    v_mfma_f32_16x16x32_bf16 v[16:19], v[12:15], a[72:75], 0
    v_mfma_f32_16x16x32_bf16 v[16:19], v[12:15], a[76:79], v[16:19]
    v_mfma_f32_16x16x32_bf16 v[16:19], v[12:15], a[80:83], v[16:19]
    v_mfma_f32_16x16x32_bf16 v[16:19], v[12:15], a[84:87], v[16:19]
    v_mfma_f32_16x16x32_bf16 v[16:19], v[12:15], a[88:91], v[16:19]
    v_mfma_f32_16x16x32_bf16 v[16:19], v[12:15], a[92:95], v[16:19]
    v_accvgpr_read_b32 v88, a72
    v_accvgpr_read_b32 v89, a73
    v_accvgpr_read_b32 v90, a74
    v_accvgpr_read_b32 v91, a75
    v_accvgpr_read_b32 v92, a76
    v_accvgpr_read_b32 v93, a77
    v_accvgpr_read_b32 v94, a78
    v_accvgpr_read_b32 v95, a79
    v_accvgpr_read_b32 v96, a80
    v_accvgpr_read_b32 v97, a81
    v_accvgpr_read_b32 v98, a82
    v_accvgpr_read_b32 v99, a83
    v_accvgpr_read_b32 v100, a84
    v_accvgpr_read_b32 v101, a85
    v_accvgpr_read_b32 v102, a86
    v_accvgpr_read_b32 v103, a87
    v_accvgpr_read_b32 v104, a88
    v_accvgpr_read_b32 v105, a89
    v_accvgpr_read_b32 v106, a90
    v_accvgpr_read_b32 v107, a91
    v_accvgpr_read_b32 v108, a92
    v_accvgpr_read_b32 v109, a93
    v_accvgpr_read_b32 v110, a94
    v_accvgpr_read_b32 v111, a95
L_job_go:
    v_mul_f32 v16, 0xbbaaaaab, v16
    s_mul_i32 s52, s52, 6144
    s_add_u32 s52, s52, s81
    v_lshlrev_b32 v216, 16, v60
    v_and_b32 v217, s77, v60
    v_lshlrev_b32 v218, 16, v61
    v_and_b32 v219, s77, v61
    v_lshlrev_b32 v220, 16, v62
    v_and_b32 v221, s77, v62
    v_lshlrev_b32 v222, 16, v63
    v_and_b32 v223, s77, v63
    v_lshlrev_b32 v224, 16, v88
    v_and_b32 v225, s77, v88
    v_lshlrev_b32 v226, 16, v89
    v_and_b32 v227, s77, v89
    v_lshlrev_b32 v228, 16, v90
    v_and_b32 v229, s77, v90
    v_lshlrev_b32 v230, 16, v91
    v_and_b32 v231, s77, v91
    v_pk_add_f32 v[224:225], v[224:225], v[16:17] op_sel_hi:[1,0]
    v_pk_add_f32 v[226:227], v[226:227], v[16:17] op_sel_hi:[1,0]
    v_pk_add_f32 v[228:229], v[228:229], v[16:17] op_sel_hi:[1,0]
    v_pk_add_f32 v[230:231], v[230:231], v[16:17] op_sel_hi:[1,0]
    v_pk_mul_f32 v[224:225], v[224:225], v[216:217]
    v_pk_mul_f32 v[226:227], v[226:227], v[218:219]
    v_pk_mul_f32 v[228:229], v[228:229], v[220:221]
    v_pk_mul_f32 v[230:231], v[230:231], v[222:223]
    v_cvt_pk_bf16_f32 v60, v224, v225
    v_cvt_pk_bf16_f32 v61, v226, v227
    v_cvt_pk_bf16_f32 v62, v228, v229
    v_cvt_pk_bf16_f32 v63, v230, v231
    buffer_store_dwordx4 v[60:63], v1, s[16:19], s52 offen offset:0 sc1
    v_lshlrev_b32 v216, 16, v64
    v_and_b32 v217, s77, v64
    v_lshlrev_b32 v218, 16, v65
    v_and_b32 v219, s77, v65
    v_lshlrev_b32 v220, 16, v66
    v_and_b32 v221, s77, v66
    v_lshlrev_b32 v222, 16, v67
    v_and_b32 v223, s77, v67
    v_lshlrev_b32 v224, 16, v92
    v_and_b32 v225, s77, v92
    v_lshlrev_b32 v226, 16, v93
    v_and_b32 v227, s77, v93
    v_lshlrev_b32 v228, 16, v94
    v_and_b32 v229, s77, v94
    v_lshlrev_b32 v230, 16, v95
    v_and_b32 v231, s77, v95
    v_pk_add_f32 v[224:225], v[224:225], v[16:17] op_sel_hi:[1,0]
    v_pk_add_f32 v[226:227], v[226:227], v[16:17] op_sel_hi:[1,0]
    v_pk_add_f32 v[228:229], v[228:229], v[16:17] op_sel_hi:[1,0]
    v_pk_add_f32 v[230:231], v[230:231], v[16:17] op_sel_hi:[1,0]
    v_pk_mul_f32 v[224:225], v[224:225], v[216:217]
    v_pk_mul_f32 v[226:227], v[226:227], v[218:219]
    v_pk_mul_f32 v[228:229], v[228:229], v[220:221]
    v_pk_mul_f32 v[230:231], v[230:231], v[222:223]
    v_cvt_pk_bf16_f32 v64, v224, v225
    v_cvt_pk_bf16_f32 v65, v226, v227
    v_cvt_pk_bf16_f32 v66, v228, v229
    v_cvt_pk_bf16_f32 v67, v230, v231
    buffer_store_dwordx4 v[64:67], v1, s[16:19], s52 offen offset:1024 sc1
    v_lshlrev_b32 v216, 16, v68
    v_and_b32 v217, s77, v68
    v_lshlrev_b32 v218, 16, v69
    v_and_b32 v219, s77, v69
    v_lshlrev_b32 v220, 16, v70
    v_and_b32 v221, s77, v70
    v_lshlrev_b32 v222, 16, v71
    v_and_b32 v223, s77, v71
    v_lshlrev_b32 v224, 16, v96
    v_and_b32 v225, s77, v96
    v_lshlrev_b32 v226, 16, v97
    v_and_b32 v227, s77, v97
    v_lshlrev_b32 v228, 16, v98
    v_and_b32 v229, s77, v98
    v_lshlrev_b32 v230, 16, v99
    v_and_b32 v231, s77, v99
    v_pk_add_f32 v[224:225], v[224:225], v[16:17] op_sel_hi:[1,0]
    v_pk_add_f32 v[226:227], v[226:227], v[16:17] op_sel_hi:[1,0]
    v_pk_add_f32 v[228:229], v[228:229], v[16:17] op_sel_hi:[1,0]
    v_pk_add_f32 v[230:231], v[230:231], v[16:17] op_sel_hi:[1,0]
    v_pk_mul_f32 v[224:225], v[224:225], v[216:217]
    v_pk_mul_f32 v[226:227], v[226:227], v[218:219]
    v_pk_mul_f32 v[228:229], v[228:229], v[220:221]
    v_pk_mul_f32 v[230:231], v[230:231], v[222:223]
    v_cvt_pk_bf16_f32 v68, v224, v225
    v_cvt_pk_bf16_f32 v69, v226, v227
    v_cvt_pk_bf16_f32 v70, v228, v229
    v_cvt_pk_bf16_f32 v71, v230, v231
    buffer_store_dwordx4 v[68:71], v1, s[16:19], s52 offen offset:2048 sc1
    v_lshlrev_b32 v216, 16, v72
    v_and_b32 v217, s77, v72
    v_lshlrev_b32 v218, 16, v73
    v_and_b32 v219, s77, v73
    v_lshlrev_b32 v220, 16, v74
    v_and_b32 v221, s77, v74
    v_lshlrev_b32 v222, 16, v75
    v_and_b32 v223, s77, v75
    v_lshlrev_b32 v224, 16, v100
    v_and_b32 v225, s77, v100
    v_lshlrev_b32 v226, 16, v101
    v_and_b32 v227, s77, v101
    v_lshlrev_b32 v228, 16, v102
    v_and_b32 v229, s77, v102
    v_lshlrev_b32 v230, 16, v103
    v_and_b32 v231, s77, v103
    v_pk_add_f32 v[224:225], v[224:225], v[16:17] op_sel_hi:[1,0]
    v_pk_add_f32 v[226:227], v[226:227], v[16:17] op_sel_hi:[1,0]
    v_pk_add_f32 v[228:229], v[228:229], v[16:17] op_sel_hi:[1,0]
    v_pk_add_f32 v[230:231], v[230:231], v[16:17] op_sel_hi:[1,0]
    v_pk_mul_f32 v[224:225], v[224:225], v[216:217]
    v_pk_mul_f32 v[226:227], v[226:227], v[218:219]
    v_pk_mul_f32 v[228:229], v[228:229], v[220:221]
    v_pk_mul_f32 v[230:231], v[230:231], v[222:223]
    v_cvt_pk_bf16_f32 v72, v224, v225
    v_cvt_pk_bf16_f32 v73, v226, v227
    v_cvt_pk_bf16_f32 v74, v228, v229
    v_cvt_pk_bf16_f32 v75, v230, v231
    buffer_store_dwordx4 v[72:75], v1, s[16:19], s52 offen offset:3072 sc1
    v_lshlrev_b32 v216, 16, v76
    v_and_b32 v217, s77, v76
    v_lshlrev_b32 v218, 16, v77
    v_and_b32 v219, s77, v77
    v_lshlrev_b32 v220, 16, v78
    v_and_b32 v221, s77, v78
    v_lshlrev_b32 v222, 16, v79
    v_and_b32 v223, s77, v79
    v_lshlrev_b32 v224, 16, v104
    v_and_b32 v225, s77, v104
    v_lshlrev_b32 v226, 16, v105
    v_and_b32 v227, s77, v105
    v_lshlrev_b32 v228, 16, v106
    v_and_b32 v229, s77, v106
    v_lshlrev_b32 v230, 16, v107
    v_and_b32 v231, s77, v107
    v_pk_add_f32 v[224:225], v[224:225], v[16:17] op_sel_hi:[1,0]
    v_pk_add_f32 v[226:227], v[226:227], v[16:17] op_sel_hi:[1,0]
    v_pk_add_f32 v[228:229], v[228:229], v[16:17] op_sel_hi:[1,0]
    v_pk_add_f32 v[230:231], v[230:231], v[16:17] op_sel_hi:[1,0]
    v_pk_mul_f32 v[224:225], v[224:225], v[216:217]
    v_pk_mul_f32 v[226:227], v[226:227], v[218:219]
    v_pk_mul_f32 v[228:229], v[228:229], v[220:221]
    v_pk_mul_f32 v[230:231], v[230:231], v[222:223]
    v_cvt_pk_bf16_f32 v76, v224, v225
    v_cvt_pk_bf16_f32 v77, v226, v227
    v_cvt_pk_bf16_f32 v78, v228, v229
    v_cvt_pk_bf16_f32 v79, v230, v231
    s_add_u32 s52, s52, 4096
    buffer_store_dwordx4 v[76:79], v1, s[16:19], s52 offen offset:0 sc1
    v_lshlrev_b32 v216, 16, v80
    v_and_b32 v217, s77, v80
    v_lshlrev_b32 v218, 16, v81
    v_and_b32 v219, s77, v81
    v_lshlrev_b32 v220, 16, v82
    v_and_b32 v221, s77, v82
    v_lshlrev_b32 v222, 16, v83
    v_and_b32 v223, s77, v83
    v_lshlrev_b32 v224, 16, v108
    v_and_b32 v225, s77, v108
    v_lshlrev_b32 v226, 16, v109
    v_and_b32 v227, s77, v109
    v_lshlrev_b32 v228, 16, v110
    v_and_b32 v229, s77, v110
    v_lshlrev_b32 v230, 16, v111
    v_and_b32 v231, s77, v111
    v_pk_add_f32 v[224:225], v[224:225], v[16:17] op_sel_hi:[1,0]
    v_pk_add_f32 v[226:227], v[226:227], v[16:17] op_sel_hi:[1,0]
    v_pk_add_f32 v[228:229], v[228:229], v[16:17] op_sel_hi:[1,0]
    v_pk_add_f32 v[230:231], v[230:231], v[16:17] op_sel_hi:[1,0]
    v_pk_mul_f32 v[224:225], v[224:225], v[216:217]
    v_pk_mul_f32 v[226:227], v[226:227], v[218:219]
    v_pk_mul_f32 v[228:229], v[228:229], v[220:221]
    v_pk_mul_f32 v[230:231], v[230:231], v[222:223]
    v_cvt_pk_bf16_f32 v80, v224, v225
    v_cvt_pk_bf16_f32 v81, v226, v227
    v_cvt_pk_bf16_f32 v82, v228, v229
    v_cvt_pk_bf16_f32 v83, v230, v231
    buffer_store_dwordx4 v[80:83], v1, s[16:19], s52 offen offset:1024 sc1
    s_branch L_j1b_ret
L_flagf:
    s_mov_b32 s101, 65536
L_flagf_l:
    ds_read_b32 v248, v249 offset:51584
    s_sub_u32 s101, s101, 1
    s_cmp_eq_u32 s101, 0
    s_cbranch_scc1 L_flagf_x
    s_waitcnt lgkmcnt(0)
    v_cmp_lt_u32 vcc, v248, v253
    s_nop 4
    s_cbranch_vccnz L_flagf_l
L_flagf_x:
    s_waitcnt lgkmcnt(0)
    s_branch L_flagf_ret
L_flag0:
    s_mov_b32 s101, 65536
L_flag0_l:
    ds_read_b32 v248, v249 offset:51584
    s_sub_u32 s101, s101, 1
    s_cmp_eq_u32 s101, 0
    s_cbranch_scc1 L_flag0_x
    s_waitcnt lgkmcnt(0)
    v_cmp_lt_u32 vcc, v248, v253
    s_nop 4
    s_cbranch_vccnz L_flag0_l
L_flag0_x:
    s_waitcnt lgkmcnt(0)
    s_branch L_flag0_ret
L_flag1:
    s_mov_b32 s101, 65536
L_flag1_l:
    ds_read_b32 v248, v249 offset:51584
    s_sub_u32 s101, s101, 1
    s_cmp_eq_u32 s101, 0
    s_cbranch_scc1 L_flag1_x
    s_waitcnt lgkmcnt(0)
    v_cmp_lt_u32 vcc, v248, v253
    s_nop 4
    s_cbranch_vccnz L_flag1_l
L_flag1_x:
    s_waitcnt lgkmcnt(0)
    s_branch L_flag1_ret
L_init_spin:
    buffer_load_dword v7, v1, s[24:27], 0 offen sc1
    s_waitcnt vmcnt(0)
    v_readfirstlane_b32 s52, v7
    s_sub_u32 s54, s54, 1
    s_cmp_lg_u32 s54, 0
    s_cbranch_scc1 L_init
    s_branch L_init_ok
L_fin:
    s_endpgm
.section .rodata,"a"
.p2align 6
.amdhsa_kernel standalone__modern_conv_block_convnext_v2__vision_kernel
  .amdhsa_next_free_vgpr 512
  .amdhsa_next_free_sgpr 102
  .amdhsa_accum_offset 256
  .amdhsa_group_segment_fixed_size 0
  .amdhsa_kernarg_size 72
  .amdhsa_user_sgpr_count 2
  .amdhsa_user_sgpr_kernarg_segment_ptr 1
  .amdhsa_system_sgpr_workgroup_id_x 1
  .amdhsa_float_denorm_mode_32 3
.end_amdhsa_kernel
```
